```python
import torch

def _softmax(x, axis=-1):
    return torch.softmax(x, dim=axis)
def _gelu(x):
    return torch.nn.functional.gelu(x, approximate="tanh")
def _silu(x):
    return torch.nn.functional.silu(x)
def _sigmoid(x):
    return torch.sigmoid(x)
def _layernorm(x, axis=-1, eps=1e-5):
    m = x.mean(dim=axis, keepdim=True)
    v = x.var(dim=axis, keepdim=True, unbiased=False)
    return (x - m) / torch.sqrt(v + eps)
def _scatter_add(tgt, idx, src, axis=0):
    return tgt.clone().index_add_(axis, idx, src)
def _segment_sum(src, seg, n):
    out = torch.zeros((n,) + src.shape[1:], dtype=src.dtype)
    return out.index_add_(0, seg, src)
def _pad(x, pw):
    flat = tuple(v for pair in reversed(pw) for v in pair)
    return torch.nn.functional.pad(x, flat)

kernel_name = 'sequential_preLN__grouped_kv_mqa__dense_activation_squared_relu__prompt'

def setup_inputs():

    _w = (lambda a: (lambda t: t.to(torch.bfloat16) if t.is_floating_point() else t)(torch.as_tensor(a)))
    def _A_setup():
        B, S, D, H = 1, 2048, 512, 32
        Dh = D // H
        return {
            "x": _w((lambda *s: torch.randn(*s, dtype=torch.bfloat16) * 0.05)(B, S, D)),
            "wq": _w((lambda *s: torch.randn(*s, dtype=torch.bfloat16) * 0.05)(D, H * Dh)),
            "wk": _w((lambda *s: torch.randn(*s, dtype=torch.bfloat16) * 0.05)(D, Dh)),
            "wv": _w((lambda *s: torch.randn(*s, dtype=torch.bfloat16) * 0.05)(D, Dh)),
            "wo": _w((lambda *s: torch.randn(*s, dtype=torch.bfloat16) * 0.05)(H * Dh, D)),
        }
    _A_in = _A_setup()

    def _B_setup():
        B, S, D, F = 1, 2048, 512, 1792
        return {
            "x": _w((lambda *s: torch.randn(*s, dtype=torch.bfloat16) * 0.05)(B, S, D)),
            "w1": _w((lambda *s: torch.randn(*s, dtype=torch.bfloat16) * 0.05)(D, F)),
            "b1": _w((lambda *s: torch.randn(*s, dtype=torch.bfloat16) * 0.4)(F)),
            "w2": _w((lambda *s: torch.randn(*s, dtype=torch.bfloat16) * 0.05)(F, D)),
            "b2": _w((lambda *s: torch.randn(*s, dtype=torch.bfloat16) * 1.6)(D)),
        }
    _B_in = _B_setup()

    return {
        "A_x": _A_in["x"],
        "A_wq": _A_in["wq"],
        "A_wk": _A_in["wk"],
        "A_wv": _A_in["wv"],
        "A_wo": _A_in["wo"],
        "B_x": _B_in["x"],
        "B_w1": _B_in["w1"],
        "B_b1": _B_in["b1"],
        "B_w2": _B_in["w2"],
        "B_b2": _B_in["b2"],
    }

def reference(A_x, A_wq, A_wk, A_wv, A_wo, B_x, B_w1, B_b1, B_w2, B_b2):
    def _A_ref(x, wq, wk, wv, wo):
        B, S, D = x.shape
        H = 32
        Dh = D // H
        q = (lambda x, *d: x.permute(*d))((x @ wq).reshape(B, S, H, Dh), 0, 2, 1, 3)
        k = x @ wk
        v = x @ wv
        scores = torch.einsum("bhqd,bkd->bhqk", q, k) * (Dh ** -0.5)
        p = _softmax(scores, axis=-1)
        o = torch.einsum("bhqk,bkd->bhqd", p, v)
        return (lambda x, *d: x.permute(*d))(o, 0, 2, 1, 3).reshape(B, S, H * Dh) @ wo

    def _B_ref(x, w1, b1, w2, b2):
        h = torch.einsum("bsd,df->bsf", x, w1) + b1
        zero = torch.zeros_like(h)
        r = torch.where(h > zero, h, zero)
        h = r * r
        out = torch.einsum("bsf,fd->bsd", h, w2) + b2
        return out

    x = A_x
    h = x + _A_ref(_layernorm(x, axis=-1), A_wq, A_wk, A_wv, A_wo)
    h2 = h + _B_ref(_layernorm(h, axis=-1), B_w1, B_b1, B_w2, B_b2)
    return h2
```

```asm
; @launch grid=(256,1,1) block=(512,1,1) lds=163840
.amdgcn_target "amdgcn-amd-amdhsa--gfx950"
.text
.globl sequential_preLN__grouped_kv_mqa__dense_activation_squared_relu__prompt_kernel
.p2align 8
.type sequential_preLN__grouped_kv_mqa__dense_activation_squared_relu__prompt_kernel,@function
sequential_preLN__grouped_kv_mqa__dense_activation_squared_relu__prompt_kernel:
  s_cmp_ge_u32 s2, 256
  s_cbranch_scc1 L_end
  s_load_dwordx16 s[28:43], s[0:1], 0
  s_load_dwordx8 s[44:51], s[0:1], 64
  s_load_dwordx2 s[52:53], s[0:1], 96
  v_lshrrev_b32 v2, 6, v0
  v_and_b32 v1, 63, v0
  s_and_b32 s4, s2, 7
  v_readfirstlane_b32 s6, v2
  s_lshl_b32 s4, s4, 2
  s_lshr_b32 s3, s2, 3
  s_and_b32 s3, s3, 3
  s_or_b32 s4, s4, s3
  s_lshr_b32 s5, s2, 5
  s_mov_b32 s27, 0
  s_getreg_b32 s91, hwreg(HW_REG_XCC_ID, 0, 4)
  s_and_b32 s24, s6, 1
  s_lshr_b32 s26, s6, 1
  s_and_b32 s26, s26, 1
  s_lshr_b32 s25, s6, 2
  v_lshlrev_b32 v2, 4, v1
  s_lshr_b32 s93, s2, 3
  s_and_b32 s93, s93, 15
  s_cmp_lt_u32 s6, 4
  s_cbranch_scc1 L_f_bulk
  s_cmp_lt_u32 s6, 6
  s_cbranch_scc0 L_f_bulk
  v_mov_b32 v72, 0x3f803f80
  v_mov_b32 v73, 0x3f803f80
  v_mov_b32 v74, 0x3f803f80
  v_mov_b32 v75, 0x3f803f80
  v_mov_b32 v76, 0x3f803f80
  v_mov_b32 v77, 0x3f803f80
  v_mov_b32 v78, 0x3f803f80
  v_mov_b32 v79, 0x3f803f80
  v_mov_b32 v80, 0x3f803f80
  v_mov_b32 v81, 0x3f803f80
  v_mov_b32 v82, 0x3f803f80
  v_mov_b32 v83, 0x3f803f80
  v_mov_b32 v84, 0x3f803f80
  v_mov_b32 v85, 0x3f803f80
  v_mov_b32 v86, 0x3f803f80
  v_mov_b32 v87, 0x3f803f80
  v_mov_b32 v88, 0x3f803f80
  v_mov_b32 v89, 0x3f803f80
  v_mov_b32 v90, 0x3f803f80
  v_mov_b32 v91, 0x3f803f80
  v_mov_b32 v92, 0x3f803f80
  v_mov_b32 v93, 0x3f803f80
  v_mov_b32 v94, 0x3f803f80
  v_mov_b32 v95, 0x3f803f80
  v_mov_b32 v96, 0x3f803f80
  v_mov_b32 v97, 0x3f803f80
  v_mov_b32 v98, 0x3f803f80
  v_mov_b32 v99, 0x3f803f80
  v_mov_b32 v100, 0x3f803f80
  v_mov_b32 v101, 0x3f803f80
  v_mov_b32 v102, 0x3f803f80
  v_mov_b32 v103, 0x3f803f80
  v_mov_b32 v104, 0x3f803f80
  v_mov_b32 v105, 0x3f803f80
  v_mov_b32 v106, 0x3f803f80
  v_mov_b32 v107, 0x3f803f80
  v_mov_b32 v108, 0x3f803f80
  v_mov_b32 v109, 0x3f803f80
  v_mov_b32 v110, 0x3f803f80
  v_mov_b32 v111, 0x3f803f80
  v_mov_b32 v112, 0x3f803f80
  v_mov_b32 v113, 0x3f803f80
  v_mov_b32 v114, 0x3f803f80
  v_mov_b32 v115, 0x3f803f80
  v_mov_b32 v116, 0x3f803f80
  v_mov_b32 v117, 0x3f803f80
  v_mov_b32 v118, 0x3f803f80
  v_mov_b32 v119, 0x3f803f80
  v_mov_b32 v120, 0x3f803f80
  v_mov_b32 v121, 0x3f803f80
  v_mov_b32 v122, 0x3f803f80
  v_mov_b32 v123, 0x3f803f80
  v_mov_b32 v124, 0x3f803f80
  v_mov_b32 v125, 0x3f803f80
  v_mov_b32 v126, 0x3f803f80
  v_mov_b32 v127, 0x3f803f80
  v_mov_b32 v128, 0x3f803f80
  v_mov_b32 v129, 0x3f803f80
  v_mov_b32 v130, 0x3f803f80
  v_mov_b32 v131, 0x3f803f80
  v_mov_b32 v132, 0x3f803f80
  v_mov_b32 v133, 0x3f803f80
  v_mov_b32 v134, 0x3f803f80
  v_mov_b32 v135, 0x3f803f80
  v_and_b32 v6, 15, v1
  v_lshrrev_b32 v7, 4, v1
  v_lshlrev_b32 v3, 10, v6
  v_lshl_add_u32 v3, v7, 4, v3
  s_lshl_b32 s54, s4, 3
  s_add_u32 s54, s54, s5
  s_lshl_b32 s54, s54, 13
  s_waitcnt lgkmcnt(0)
  s_mov_b32 s12, s28
  s_mov_b32 s13, s29
  s_mov_b32 s14, 2097152
  s_mov_b32 s15, 0x20000
  s_cmp_eq_u32 s6, 4
  s_cselect_b32 s20, s32, s34
  s_cselect_b32 s21, s33, s35
  s_mov_b32 s22, 16384
  s_mov_b32 s23, 0x20000
  s_mov_b32 exec_lo, 0xff00ff
  s_mov_b32 exec_hi, 0xff00ff
  buffer_load_dwordx4 v[72:75], v3, s[12:15], s54 offen offset:0
  buffer_load_dwordx4 v[76:79], v3, s[12:15], s54 offen offset:64
  buffer_load_dwordx4 v[80:83], v3, s[12:15], s54 offen offset:128
  buffer_load_dwordx4 v[84:87], v3, s[12:15], s54 offen offset:192
  buffer_load_dwordx4 v[88:91], v3, s[12:15], s54 offen offset:256
  buffer_load_dwordx4 v[92:95], v3, s[12:15], s54 offen offset:320
  buffer_load_dwordx4 v[96:99], v3, s[12:15], s54 offen offset:384
  buffer_load_dwordx4 v[100:103], v3, s[12:15], s54 offen offset:448
  buffer_load_dwordx4 v[104:107], v3, s[12:15], s54 offen offset:512
  buffer_load_dwordx4 v[108:111], v3, s[12:15], s54 offen offset:576
  buffer_load_dwordx4 v[112:115], v3, s[12:15], s54 offen offset:640
  buffer_load_dwordx4 v[116:119], v3, s[12:15], s54 offen offset:704
  buffer_load_dwordx4 v[120:123], v3, s[12:15], s54 offen offset:768
  buffer_load_dwordx4 v[124:127], v3, s[12:15], s54 offen offset:832
  buffer_load_dwordx4 v[128:131], v3, s[12:15], s54 offen offset:896
  buffer_load_dwordx4 v[132:135], v3, s[12:15], s54 offen offset:960
  s_mov_b64 exec, -1
  s_lshl_b32 s55, s24, 14
  s_add_u32 s55, s55, 131072
  s_add_u32 s56, s93, 0
  s_and_b32 s56, s56, 15
  s_lshl_b32 s56, s56, 10
  s_add_u32 m0, s55, s56
  s_nop 0
  buffer_load_dwordx4 v2, s[20:23], s56 offen lds
  s_add_u32 s56, s93, 1
  s_and_b32 s56, s56, 15
  s_lshl_b32 s56, s56, 10
  s_add_u32 m0, s55, s56
  s_nop 0
  buffer_load_dwordx4 v2, s[20:23], s56 offen lds
  s_add_u32 s56, s93, 2
  s_and_b32 s56, s56, 15
  s_lshl_b32 s56, s56, 10
  s_add_u32 m0, s55, s56
  s_nop 0
  buffer_load_dwordx4 v2, s[20:23], s56 offen lds
  s_add_u32 s56, s93, 3
  s_and_b32 s56, s56, 15
  s_lshl_b32 s56, s56, 10
  s_add_u32 m0, s55, s56
  s_nop 0
  buffer_load_dwordx4 v2, s[20:23], s56 offen lds
  s_add_u32 s56, s93, 4
  s_and_b32 s56, s56, 15
  s_lshl_b32 s56, s56, 10
  s_add_u32 m0, s55, s56
  s_nop 0
  buffer_load_dwordx4 v2, s[20:23], s56 offen lds
  s_add_u32 s56, s93, 5
  s_and_b32 s56, s56, 15
  s_lshl_b32 s56, s56, 10
  s_add_u32 m0, s55, s56
  s_nop 0
  buffer_load_dwordx4 v2, s[20:23], s56 offen lds
  s_add_u32 s56, s93, 6
  s_and_b32 s56, s56, 15
  s_lshl_b32 s56, s56, 10
  s_add_u32 m0, s55, s56
  s_nop 0
  buffer_load_dwordx4 v2, s[20:23], s56 offen lds
  s_add_u32 s56, s93, 7
  s_and_b32 s56, s56, 15
  s_lshl_b32 s56, s56, 10
  s_add_u32 m0, s55, s56
  s_nop 0
  buffer_load_dwordx4 v2, s[20:23], s56 offen lds
  s_add_u32 s56, s93, 8
  s_and_b32 s56, s56, 15
  s_lshl_b32 s56, s56, 10
  s_add_u32 m0, s55, s56
  s_nop 0
  buffer_load_dwordx4 v2, s[20:23], s56 offen lds
  s_add_u32 s56, s93, 9
  s_and_b32 s56, s56, 15
  s_lshl_b32 s56, s56, 10
  s_add_u32 m0, s55, s56
  s_nop 0
  buffer_load_dwordx4 v2, s[20:23], s56 offen lds
  s_add_u32 s56, s93, 10
  s_and_b32 s56, s56, 15
  s_lshl_b32 s56, s56, 10
  s_add_u32 m0, s55, s56
  s_nop 0
  buffer_load_dwordx4 v2, s[20:23], s56 offen lds
  s_add_u32 s56, s93, 11
  s_and_b32 s56, s56, 15
  s_lshl_b32 s56, s56, 10
  s_add_u32 m0, s55, s56
  s_nop 0
  buffer_load_dwordx4 v2, s[20:23], s56 offen lds
  s_add_u32 s56, s93, 12
  s_and_b32 s56, s56, 15
  s_lshl_b32 s56, s56, 10
  s_add_u32 m0, s55, s56
  s_nop 0
  buffer_load_dwordx4 v2, s[20:23], s56 offen lds
  s_add_u32 s56, s93, 13
  s_and_b32 s56, s56, 15
  s_lshl_b32 s56, s56, 10
  s_add_u32 m0, s55, s56
  s_nop 0
  buffer_load_dwordx4 v2, s[20:23], s56 offen lds
  s_add_u32 s56, s93, 14
  s_and_b32 s56, s56, 15
  s_lshl_b32 s56, s56, 10
  s_add_u32 m0, s55, s56
  s_nop 0
  buffer_load_dwordx4 v2, s[20:23], s56 offen lds
  s_add_u32 s56, s93, 15
  s_and_b32 s56, s56, 15
  s_lshl_b32 s56, s56, 10
  s_add_u32 m0, s55, s56
  s_nop 0
  buffer_load_dwordx4 v2, s[20:23], s56 offen lds
  s_barrier
  s_load_dword s7, s[52:53], 0
  s_mov_b32 s8, s52
  s_mov_b32 s9, s53
  s_mov_b32 s10, 23068672
  s_mov_b32 s11, 0x20000
  s_cmp_eq_u32 s6, 4
  s_cbranch_scc0 L_f_v
  v_lshrrev_b32 v7, 4, v1
  v_and_b32 v6, 15, v1
  v_lshlrev_b32 v9, 8, v7
  v_lshl_add_u32 v9, v6, 3, v9
  v_add_u32 v9, 131072, v9
  s_waitcnt vmcnt(0) lgkmcnt(0)
  ds_read_b64_tr_b16 v[136:137], v9 offset:0
  ds_read_b64_tr_b16 v[138:139], v9 offset:128
  ds_read_b64_tr_b16 v[140:141], v9 offset:1024
  ds_read_b64_tr_b16 v[142:143], v9 offset:1152
  ds_read_b64_tr_b16 v[144:145], v9 offset:2048
  ds_read_b64_tr_b16 v[146:147], v9 offset:2176
  ds_read_b64_tr_b16 v[148:149], v9 offset:3072
  ds_read_b64_tr_b16 v[150:151], v9 offset:3200
  ds_read_b64_tr_b16 v[152:153], v9 offset:4096
  ds_read_b64_tr_b16 v[154:155], v9 offset:4224
  ds_read_b64_tr_b16 v[156:157], v9 offset:5120
  ds_read_b64_tr_b16 v[158:159], v9 offset:5248
  ds_read_b64_tr_b16 v[160:161], v9 offset:6144
  ds_read_b64_tr_b16 v[162:163], v9 offset:6272
  s_waitcnt lgkmcnt(12)
  v_mfma_f32_16x16x32_bf16 v[20:23], v[136:139], v[72:75], 0
  v_mfma_f32_16x16x32_bf16 v[24:27], v[72:75], v[72:75], 0
  ds_read_b64_tr_b16 v[164:165], v9 offset:7168
  ds_read_b64_tr_b16 v[166:167], v9 offset:7296
  s_waitcnt lgkmcnt(12)
  v_mfma_f32_16x16x32_bf16 v[20:23], v[140:143], v[76:79], v[20:23]
  v_mfma_f32_16x16x32_bf16 v[24:27], v[76:79], v[76:79], v[24:27]
  ds_read_b64_tr_b16 v[168:169], v9 offset:8192
  ds_read_b64_tr_b16 v[170:171], v9 offset:8320
  s_waitcnt lgkmcnt(12)
  v_mfma_f32_16x16x32_bf16 v[20:23], v[144:147], v[80:83], v[20:23]
  v_mfma_f32_16x16x32_bf16 v[24:27], v[80:83], v[80:83], v[24:27]
  ds_read_b64_tr_b16 v[172:173], v9 offset:9216
  ds_read_b64_tr_b16 v[174:175], v9 offset:9344
  s_waitcnt lgkmcnt(12)
  v_mfma_f32_16x16x32_bf16 v[20:23], v[148:151], v[84:87], v[20:23]
  v_mfma_f32_16x16x32_bf16 v[24:27], v[84:87], v[84:87], v[24:27]
  ds_read_b64_tr_b16 v[176:177], v9 offset:10240
  ds_read_b64_tr_b16 v[178:179], v9 offset:10368
  s_waitcnt lgkmcnt(12)
  v_mfma_f32_16x16x32_bf16 v[20:23], v[152:155], v[88:91], v[20:23]
  v_mfma_f32_16x16x32_bf16 v[24:27], v[88:91], v[88:91], v[24:27]
  ds_read_b64_tr_b16 v[180:181], v9 offset:11264
  ds_read_b64_tr_b16 v[182:183], v9 offset:11392
  s_waitcnt lgkmcnt(12)
  v_mfma_f32_16x16x32_bf16 v[20:23], v[156:159], v[92:95], v[20:23]
  v_mfma_f32_16x16x32_bf16 v[24:27], v[92:95], v[92:95], v[24:27]
  ds_read_b64_tr_b16 v[184:185], v9 offset:12288
  ds_read_b64_tr_b16 v[186:187], v9 offset:12416
  s_waitcnt lgkmcnt(12)
  v_mfma_f32_16x16x32_bf16 v[20:23], v[160:163], v[96:99], v[20:23]
  v_mfma_f32_16x16x32_bf16 v[24:27], v[96:99], v[96:99], v[24:27]
  ds_read_b64_tr_b16 v[188:189], v9 offset:13312
  ds_read_b64_tr_b16 v[190:191], v9 offset:13440
  s_waitcnt lgkmcnt(12)
  v_mfma_f32_16x16x32_bf16 v[20:23], v[164:167], v[100:103], v[20:23]
  v_mfma_f32_16x16x32_bf16 v[24:27], v[100:103], v[100:103], v[24:27]
  ds_read_b64_tr_b16 v[192:193], v9 offset:14336
  ds_read_b64_tr_b16 v[194:195], v9 offset:14464
  s_waitcnt lgkmcnt(12)
  v_mfma_f32_16x16x32_bf16 v[20:23], v[168:171], v[104:107], v[20:23]
  v_mfma_f32_16x16x32_bf16 v[24:27], v[104:107], v[104:107], v[24:27]
  ds_read_b64_tr_b16 v[196:197], v9 offset:15360
  ds_read_b64_tr_b16 v[198:199], v9 offset:15488
  s_waitcnt lgkmcnt(12)
  v_mfma_f32_16x16x32_bf16 v[20:23], v[172:175], v[108:111], v[20:23]
  v_mfma_f32_16x16x32_bf16 v[24:27], v[108:111], v[108:111], v[24:27]
  s_waitcnt lgkmcnt(10)
  v_mfma_f32_16x16x32_bf16 v[20:23], v[176:179], v[112:115], v[20:23]
  v_mfma_f32_16x16x32_bf16 v[24:27], v[112:115], v[112:115], v[24:27]
  s_waitcnt lgkmcnt(8)
  v_mfma_f32_16x16x32_bf16 v[20:23], v[180:183], v[116:119], v[20:23]
  v_mfma_f32_16x16x32_bf16 v[24:27], v[116:119], v[116:119], v[24:27]
  s_waitcnt lgkmcnt(6)
  v_mfma_f32_16x16x32_bf16 v[20:23], v[184:187], v[120:123], v[20:23]
  v_mfma_f32_16x16x32_bf16 v[24:27], v[120:123], v[120:123], v[24:27]
  s_waitcnt lgkmcnt(4)
  v_mfma_f32_16x16x32_bf16 v[20:23], v[188:191], v[124:127], v[20:23]
  v_mfma_f32_16x16x32_bf16 v[24:27], v[124:127], v[124:127], v[24:27]
  s_waitcnt lgkmcnt(2)
  v_mfma_f32_16x16x32_bf16 v[20:23], v[192:195], v[128:131], v[20:23]
  v_mfma_f32_16x16x32_bf16 v[24:27], v[128:131], v[128:131], v[24:27]
  s_waitcnt lgkmcnt(0)
  v_mfma_f32_16x16x32_bf16 v[20:23], v[196:199], v[132:135], v[20:23]
  v_mfma_f32_16x16x32_bf16 v[24:27], v[132:135], v[132:135], v[24:27]
  v_mov_b32 v28, 0
  s_mov_b32 s56, 0x100001
  s_mov_b32 s57, 0x10000100
  s_nop 4
  v_cndmask_b32 v28, v28, v24, s[56:57]
  s_mov_b32 s56, 0x200002
  s_mov_b32 s57, 0x20000200
  v_cndmask_b32 v28, v28, v25, s[56:57]
  s_mov_b32 s56, 0x400004
  s_mov_b32 s57, 0x40000400
  v_cndmask_b32 v28, v28, v26, s[56:57]
  s_mov_b32 s56, 0x800008
  s_mov_b32 s57, 0x80000800
  v_cndmask_b32 v28, v28, v27, s[56:57]
  v_mov_b32 v29, v28
  s_nop 1
  v_permlane16_swap_b32 v28, v29
  v_add_f32 v28, v28, v29
  v_mov_b32 v29, v28
  s_nop 1
  v_permlane32_swap_b32 v28, v29
  v_add_f32 v28, v28, v29
  v_mov_b32 v29, v24
  v_mov_b32 v30, v24
  s_nop 1
  v_permlane32_swap_b32 v29, v30
  v_mul_f32 v32, 0x3b000000, v30
  v_mul_f32 v29, 0x3b000000, v28
  v_fma_f32 v29, -v32, v32, v29
  v_max_f32 v29, 0, v29
  v_cvt_pk_bf16_f32 v32, v32, v29
  v_and_b32 v29, 0xffff0000, v32
  v_lshlrev_b32 v32, 16, v32
  v_add_f32 v29, 0x3727c5ac, v29
  v_cvt_pk_bf16_f32 v29, v29, v29
  v_lshlrev_b32 v29, 16, v29
  v_sqrt_f32 v29, v29
  s_nop 0
  v_cvt_pk_bf16_f32 v29, v29, v29
  v_lshlrev_b32 v34, 16, v29
  v_rcp_f32 v33, v34
  s_lshl_b32 s54, s4, 3
  s_add_u32 s54, s54, s5
  v_sub_f32 v35, 0, v32
  s_nop 1
  v_fmac_f32_dpp v20, v20, v35 row_ror:8 row_mask:0xf bank_mask:0xf
  v_fmac_f32_dpp v21, v21, v35 row_ror:8 row_mask:0xf bank_mask:0xf
  v_fmac_f32_dpp v22, v22, v35 row_ror:8 row_mask:0xf bank_mask:0xf
  v_fmac_f32_dpp v23, v23, v35 row_ror:8 row_mask:0xf bank_mask:0xf
  v_mul_f32 v20, v20, v33
  v_mul_f32 v21, v21, v33
  v_mul_f32 v22, v22, v33
  v_mul_f32 v23, v23, v33
  v_mov_b32 v12, 0
  s_mov_b32 exec_lo, 0xff00ff
  s_mov_b32 exec_hi, 0xff00ff
  v_mul_f32 v12, v20, v20
  v_fmac_f32 v12, v21, v21
  v_fmac_f32 v12, v22, v22
  v_fmac_f32 v12, v23, v23
  v_cvt_pk_bf16_f32 v20, v20, v21
  v_cvt_pk_bf16_f32 v21, v22, v23
  s_lshr_b32 s57, s54, 2
  s_lshl_b32 s57, s57, 10
  s_and_b32 s58, s54, 3
  s_lshl_b32 s58, s58, 7
  s_add_u32 s57, s57, s58
  s_add_u32 s57, s57, 65536
  v_and_b32 v13, 1, v7
  v_lshlrev_b32 v13, 9, v13
  v_lshl_add_u32 v13, v6, 4, v13
  v_lshrrev_b32 v14, 1, v7
  v_lshl_add_u32 v13, v14, 3, v13
  buffer_store_dwordx2 v[20:21], v13, s[8:11], s57 offen sc1
  v_lshrrev_b32 v37, 16, v32
  v_or_b32 v37, v34, v37
  s_add_u32 s7, s7, 0x9e3779b9
  v_mov_b32 v36, s7
  v_lshlrev_b32 v14, 3, v6
  s_lshl_b32 s58, s54, 6
  s_add_u32 s58, s58, 12288
  s_mov_b64 exec, 0xff
  buffer_store_dwordx2 v[36:37], v14, s[8:11], s58 offen sc1
  s_mov_b64 exec, -1
  v_mov_b32 v10, v12
  s_nop 1
  v_permlane16_swap_b32 v12, v10
  v_add_f32 v12, v12, v10
  v_mov_b32 v10, v12
  s_nop 1
  v_permlane32_swap_b32 v12, v10
  v_add_f32 v12, v12, v10
  s_nop 1
  v_max_f32_dpp v12, v12, v12 row_ror:8 row_mask:0xf bank_mask:0xf
  s_nop 1
  v_max_f32_dpp v12, v12, v12 row_ror:4 row_mask:0xf bank_mask:0xf
  s_nop 1
  v_max_f32_dpp v12, v12, v12 row_ror:2 row_mask:0xf bank_mask:0xf
  s_nop 1
  v_max_f32_dpp v12, v12, v12 row_ror:1 row_mask:0xf bank_mask:0xf
  v_mov_b32 v37, v12
  s_lshl_b32 s58, s54, 4
  s_add_u32 s58, s58, 4096
  v_mov_b32 v14, 0
  s_waitcnt vmcnt(0)
  s_mov_b64 exec, 1
  buffer_store_dwordx2 v[36:37], v14, s[8:11], s58 offen sc1
  s_mov_b64 exec, -1
  s_barrier
  s_branch L_f_help
L_f_v:
  v_lshrrev_b32 v7, 4, v1
  v_and_b32 v6, 15, v1
  v_lshlrev_b32 v9, 8, v7
  v_lshl_add_u32 v9, v6, 3, v9
  v_add_u32 v9, 147456, v9
  s_waitcnt vmcnt(0) lgkmcnt(0)
  ds_read_b64_tr_b16 v[136:137], v9 offset:0
  ds_read_b64_tr_b16 v[138:139], v9 offset:128
  ds_read_b64_tr_b16 v[140:141], v9 offset:1024
  ds_read_b64_tr_b16 v[142:143], v9 offset:1152
  ds_read_b64_tr_b16 v[144:145], v9 offset:2048
  ds_read_b64_tr_b16 v[146:147], v9 offset:2176
  ds_read_b64_tr_b16 v[148:149], v9 offset:3072
  ds_read_b64_tr_b16 v[150:151], v9 offset:3200
  ds_read_b64_tr_b16 v[152:153], v9 offset:4096
  ds_read_b64_tr_b16 v[154:155], v9 offset:4224
  ds_read_b64_tr_b16 v[156:157], v9 offset:5120
  ds_read_b64_tr_b16 v[158:159], v9 offset:5248
  ds_read_b64_tr_b16 v[160:161], v9 offset:6144
  ds_read_b64_tr_b16 v[162:163], v9 offset:6272
  s_waitcnt lgkmcnt(12)
  v_mfma_f32_16x16x32_bf16 v[20:23], v[72:75], v[136:139], 0
  v_mfma_f32_16x16x32_bf16 v[24:27], v[72:75], v[72:75], 0
  ds_read_b64_tr_b16 v[164:165], v9 offset:7168
  ds_read_b64_tr_b16 v[166:167], v9 offset:7296
  s_waitcnt lgkmcnt(12)
  v_mfma_f32_16x16x32_bf16 v[20:23], v[76:79], v[140:143], v[20:23]
  v_mfma_f32_16x16x32_bf16 v[24:27], v[76:79], v[76:79], v[24:27]
  ds_read_b64_tr_b16 v[168:169], v9 offset:8192
  ds_read_b64_tr_b16 v[170:171], v9 offset:8320
  s_waitcnt lgkmcnt(12)
  v_mfma_f32_16x16x32_bf16 v[20:23], v[80:83], v[144:147], v[20:23]
  v_mfma_f32_16x16x32_bf16 v[24:27], v[80:83], v[80:83], v[24:27]
  ds_read_b64_tr_b16 v[172:173], v9 offset:9216
  ds_read_b64_tr_b16 v[174:175], v9 offset:9344
  s_waitcnt lgkmcnt(12)
  v_mfma_f32_16x16x32_bf16 v[20:23], v[84:87], v[148:151], v[20:23]
  v_mfma_f32_16x16x32_bf16 v[24:27], v[84:87], v[84:87], v[24:27]
  ds_read_b64_tr_b16 v[176:177], v9 offset:10240
  ds_read_b64_tr_b16 v[178:179], v9 offset:10368
  s_waitcnt lgkmcnt(12)
  v_mfma_f32_16x16x32_bf16 v[20:23], v[88:91], v[152:155], v[20:23]
  v_mfma_f32_16x16x32_bf16 v[24:27], v[88:91], v[88:91], v[24:27]
  ds_read_b64_tr_b16 v[180:181], v9 offset:11264
  ds_read_b64_tr_b16 v[182:183], v9 offset:11392
  s_waitcnt lgkmcnt(12)
  v_mfma_f32_16x16x32_bf16 v[20:23], v[92:95], v[156:159], v[20:23]
  v_mfma_f32_16x16x32_bf16 v[24:27], v[92:95], v[92:95], v[24:27]
  ds_read_b64_tr_b16 v[184:185], v9 offset:12288
  ds_read_b64_tr_b16 v[186:187], v9 offset:12416
  s_waitcnt lgkmcnt(12)
  v_mfma_f32_16x16x32_bf16 v[20:23], v[96:99], v[160:163], v[20:23]
  v_mfma_f32_16x16x32_bf16 v[24:27], v[96:99], v[96:99], v[24:27]
  ds_read_b64_tr_b16 v[188:189], v9 offset:13312
  ds_read_b64_tr_b16 v[190:191], v9 offset:13440
  s_waitcnt lgkmcnt(12)
  v_mfma_f32_16x16x32_bf16 v[20:23], v[100:103], v[164:167], v[20:23]
  v_mfma_f32_16x16x32_bf16 v[24:27], v[100:103], v[100:103], v[24:27]
  ds_read_b64_tr_b16 v[192:193], v9 offset:14336
  ds_read_b64_tr_b16 v[194:195], v9 offset:14464
  s_waitcnt lgkmcnt(12)
  v_mfma_f32_16x16x32_bf16 v[20:23], v[104:107], v[168:171], v[20:23]
  v_mfma_f32_16x16x32_bf16 v[24:27], v[104:107], v[104:107], v[24:27]
  ds_read_b64_tr_b16 v[196:197], v9 offset:15360
  ds_read_b64_tr_b16 v[198:199], v9 offset:15488
  s_waitcnt lgkmcnt(12)
  v_mfma_f32_16x16x32_bf16 v[20:23], v[108:111], v[172:175], v[20:23]
  v_mfma_f32_16x16x32_bf16 v[24:27], v[108:111], v[108:111], v[24:27]
  s_waitcnt lgkmcnt(10)
  v_mfma_f32_16x16x32_bf16 v[20:23], v[112:115], v[176:179], v[20:23]
  v_mfma_f32_16x16x32_bf16 v[24:27], v[112:115], v[112:115], v[24:27]
  s_waitcnt lgkmcnt(8)
  v_mfma_f32_16x16x32_bf16 v[20:23], v[116:119], v[180:183], v[20:23]
  v_mfma_f32_16x16x32_bf16 v[24:27], v[116:119], v[116:119], v[24:27]
  s_waitcnt lgkmcnt(6)
  v_mfma_f32_16x16x32_bf16 v[20:23], v[120:123], v[184:187], v[20:23]
  v_mfma_f32_16x16x32_bf16 v[24:27], v[120:123], v[120:123], v[24:27]
  s_waitcnt lgkmcnt(4)
  v_mfma_f32_16x16x32_bf16 v[20:23], v[124:127], v[188:191], v[20:23]
  v_mfma_f32_16x16x32_bf16 v[24:27], v[124:127], v[124:127], v[24:27]
  s_waitcnt lgkmcnt(2)
  v_mfma_f32_16x16x32_bf16 v[20:23], v[128:131], v[192:195], v[20:23]
  v_mfma_f32_16x16x32_bf16 v[24:27], v[128:131], v[128:131], v[24:27]
  s_waitcnt lgkmcnt(0)
  v_mfma_f32_16x16x32_bf16 v[20:23], v[132:135], v[196:199], v[20:23]
  v_mfma_f32_16x16x32_bf16 v[24:27], v[132:135], v[132:135], v[24:27]
  v_mov_b32 v28, 0
  s_mov_b32 s56, 0x100001
  s_mov_b32 s57, 0x10000100
  s_nop 4
  v_cndmask_b32 v28, v28, v24, s[56:57]
  s_mov_b32 s56, 0x200002
  s_mov_b32 s57, 0x20000200
  v_cndmask_b32 v28, v28, v25, s[56:57]
  s_mov_b32 s56, 0x400004
  s_mov_b32 s57, 0x40000400
  v_cndmask_b32 v28, v28, v26, s[56:57]
  s_mov_b32 s56, 0x800008
  s_mov_b32 s57, 0x80000800
  v_cndmask_b32 v28, v28, v27, s[56:57]
  v_mov_b32 v29, v28
  s_nop 1
  v_permlane16_swap_b32 v28, v29
  v_add_f32 v28, v28, v29
  v_mov_b32 v29, v28
  s_nop 1
  v_permlane32_swap_b32 v28, v29
  v_add_f32 v28, v28, v29
  v_mov_b32 v29, v24
  v_mov_b32 v30, v24
  s_nop 1
  v_permlane32_swap_b32 v29, v30
  v_mul_f32 v32, 0x3b000000, v30
  v_mul_f32 v29, 0x3b000000, v28
  v_fma_f32 v29, -v32, v32, v29
  v_max_f32 v29, 0, v29
  v_cvt_pk_bf16_f32 v32, v32, v29
  v_and_b32 v29, 0xffff0000, v32
  v_lshlrev_b32 v32, 16, v32
  v_add_f32 v29, 0x3727c5ac, v29
  v_cvt_pk_bf16_f32 v29, v29, v29
  v_lshlrev_b32 v29, 16, v29
  v_sqrt_f32 v29, v29
  s_nop 0
  v_cvt_pk_bf16_f32 v29, v29, v29
  v_lshlrev_b32 v34, 16, v29
  v_rcp_f32 v33, v34
  s_lshl_b32 s54, s4, 3
  s_add_u32 s54, s54, s5
  v_mov_b32 v29, v20
  v_mov_b32 v30, v20
  s_nop 1
  v_permlane32_swap_b32 v29, v30
  v_mov_b32_dpp v40, v32 row_newbcast:0 row_mask:0x1 bank_mask:0xf
  s_nop 1
  v_mov_b32_dpp v40, v32 row_newbcast:4 row_mask:0x2 bank_mask:0xf
  v_mov_b32_dpp v44, v33 row_newbcast:0 row_mask:0x1 bank_mask:0xf
  s_nop 1
  v_mov_b32_dpp v44, v33 row_newbcast:4 row_mask:0x2 bank_mask:0xf
  v_mov_b32_dpp v41, v32 row_newbcast:1 row_mask:0x1 bank_mask:0xf
  s_nop 1
  v_mov_b32_dpp v41, v32 row_newbcast:5 row_mask:0x2 bank_mask:0xf
  v_mov_b32_dpp v45, v33 row_newbcast:1 row_mask:0x1 bank_mask:0xf
  s_nop 1
  v_mov_b32_dpp v45, v33 row_newbcast:5 row_mask:0x2 bank_mask:0xf
  v_mov_b32_dpp v42, v32 row_newbcast:2 row_mask:0x1 bank_mask:0xf
  s_nop 1
  v_mov_b32_dpp v42, v32 row_newbcast:6 row_mask:0x2 bank_mask:0xf
  v_mov_b32_dpp v46, v33 row_newbcast:2 row_mask:0x1 bank_mask:0xf
  s_nop 1
  v_mov_b32_dpp v46, v33 row_newbcast:6 row_mask:0x2 bank_mask:0xf
  v_mov_b32_dpp v43, v32 row_newbcast:3 row_mask:0x1 bank_mask:0xf
  s_nop 1
  v_mov_b32_dpp v43, v32 row_newbcast:7 row_mask:0x2 bank_mask:0xf
  v_mov_b32_dpp v47, v33 row_newbcast:3 row_mask:0x1 bank_mask:0xf
  s_nop 1
  v_mov_b32_dpp v47, v33 row_newbcast:7 row_mask:0x2 bank_mask:0xf
  v_fma_f32 v20, -v40, v30, v20
  v_fma_f32 v21, -v41, v30, v21
  v_fma_f32 v22, -v42, v30, v22
  v_fma_f32 v23, -v43, v30, v23
  v_mul_f32 v20, v20, v44
  v_mul_f32 v21, v21, v45
  v_mul_f32 v22, v22, v46
  v_mul_f32 v23, v23, v47
  v_cvt_pk_bf16_f32 v20, v20, v21
  v_cvt_pk_bf16_f32 v21, v22, v23
  s_lshr_b32 s57, s54, 1
  s_lshl_b32 s57, s57, 9
  s_and_b32 s58, s54, 1
  s_lshl_b32 s58, s58, 8
  s_add_u32 s57, s57, s58
  s_add_u32 s57, s57, 131072
  v_lshlrev_b32 v13, 4, v6
  v_lshl_add_u32 v13, v7, 3, v13
  s_mov_b32 exec_lo, 0xffffffff
  s_mov_b32 exec_hi, 0x0
  buffer_store_dwordx2 v[20:21], v13, s[8:11], s57 offen sc1
  s_mov_b64 exec, -1
  s_add_u32 s7, s7, 0x9e3779b9
  v_mov_b32 v36, s7
  v_mov_b32 v37, s91
  s_lshl_b32 s58, s54, 4
  s_add_u32 s58, s58, 4104
  v_mov_b32 v14, 0
  s_waitcnt vmcnt(0)
  s_mov_b64 exec, 1
  buffer_store_dwordx2 v[36:37], v14, s[8:11], s58 offen sc1
  s_mov_b64 exec, -1
  s_barrier
  s_branch L_f_help
L_f_bulk:
  v_lshrrev_b32 v3, 3, v1
  v_lshlrev_b32 v3, 10, v3
  v_and_b32 v4, 7, v1
  v_lshrrev_b32 v5, 2, v1
  v_and_b32 v5, 4, v5
  v_xor_b32 v4, v4, v5
  v_lshl_add_u32 v3, v4, 4, v3
  s_lshl_b32 s3, s5, 7
  v_add_u32 v3, s3, v3
  s_cmp_lt_u32 s6, 4
  s_cselect_b32 s60, 0, 2
  s_sub_u32 s60, s6, s60
  s_and_b32 s58, s4, 3
  s_lshl_b32 s58, s58, 4
  s_add_u32 s58, s58, s60
  s_lshl_b32 s54, s4, 16
  s_add_u32 s59, s5, 1
  s_lshl_b32 s59, s59, 3
  s_add_u32 s59, s59, s60
  s_waitcnt lgkmcnt(0)
  s_mov_b32 s12, s28
  s_mov_b32 s13, s29
  s_mov_b32 s14, 2097152
  s_mov_b32 s15, 0x20000
  s_mov_b32 s16, s30
  s_mov_b32 s17, s31
  s_mov_b32 s18, 524288
  s_mov_b32 s19, 0x20000
  s_barrier
  s_add_u32 s56, s58, 0
  s_and_b32 s56, s56, 63
  s_lshl_b32 s57, s56, 13
  s_lshl_b32 s56, s56, 10
  s_add_u32 m0, s56, 65536
  s_nop 0
  buffer_load_dwordx4 v3, s[16:19], s57 offen lds
  s_add_u32 s56, s58, 6
  s_and_b32 s56, s56, 63
  s_lshl_b32 s57, s56, 13
  s_lshl_b32 s56, s56, 10
  s_add_u32 m0, s56, 65536
  s_nop 0
  buffer_load_dwordx4 v3, s[16:19], s57 offen lds
  s_add_u32 s56, s58, 12
  s_and_b32 s56, s56, 63
  s_lshl_b32 s57, s56, 13
  s_lshl_b32 s56, s56, 10
  s_add_u32 m0, s56, 65536
  s_nop 0
  buffer_load_dwordx4 v3, s[16:19], s57 offen lds
  s_add_u32 s56, s59, 0
  s_and_b32 s56, s56, 63
  s_and_b32 s61, s56, 15
  s_lshl_b32 s61, s61, 4
  v_xor_b32 v5, s61, v2
  s_lshl_b32 m0, s56, 10
  s_add_u32 s57, s54, m0
  buffer_load_dwordx4 v5, s[12:15], s57 offen lds
  s_add_u32 s56, s59, 6
  s_and_b32 s56, s56, 63
  s_and_b32 s61, s56, 15
  s_lshl_b32 s61, s61, 4
  v_xor_b32 v5, s61, v2
  s_lshl_b32 m0, s56, 10
  s_add_u32 s57, s54, m0
  buffer_load_dwordx4 v5, s[12:15], s57 offen lds
  s_add_u32 s56, s59, 12
  s_and_b32 s56, s56, 63
  s_and_b32 s61, s56, 15
  s_lshl_b32 s61, s61, 4
  v_xor_b32 v5, s61, v2
  s_lshl_b32 m0, s56, 10
  s_add_u32 s57, s54, m0
  buffer_load_dwordx4 v5, s[12:15], s57 offen lds
  s_add_u32 s56, s59, 18
  s_and_b32 s56, s56, 63
  s_and_b32 s61, s56, 15
  s_lshl_b32 s61, s61, 4
  v_xor_b32 v5, s61, v2
  s_lshl_b32 m0, s56, 10
  s_add_u32 s57, s54, m0
  buffer_load_dwordx4 v5, s[12:15], s57 offen lds
  s_add_u32 s56, s59, 24
  s_and_b32 s56, s56, 63
  s_and_b32 s61, s56, 15
  s_lshl_b32 s61, s61, 4
  v_xor_b32 v5, s61, v2
  s_lshl_b32 m0, s56, 10
  s_add_u32 s57, s54, m0
  buffer_load_dwordx4 v5, s[12:15], s57 offen lds
  s_add_u32 s56, s59, 30
  s_and_b32 s56, s56, 63
  s_and_b32 s61, s56, 15
  s_lshl_b32 s61, s61, 4
  v_xor_b32 v5, s61, v2
  s_lshl_b32 m0, s56, 10
  s_add_u32 s57, s54, m0
  buffer_load_dwordx4 v5, s[12:15], s57 offen lds
  s_add_u32 s56, s59, 36
  s_and_b32 s56, s56, 63
  s_and_b32 s61, s56, 15
  s_lshl_b32 s61, s61, 4
  v_xor_b32 v5, s61, v2
  s_lshl_b32 m0, s56, 10
  s_add_u32 s57, s54, m0
  buffer_load_dwordx4 v5, s[12:15], s57 offen lds
  s_add_u32 s56, s59, 42
  s_and_b32 s56, s56, 63
  s_and_b32 s61, s56, 15
  s_lshl_b32 s61, s61, 4
  v_xor_b32 v5, s61, v2
  s_lshl_b32 m0, s56, 10
  s_add_u32 s57, s54, m0
  buffer_load_dwordx4 v5, s[12:15], s57 offen lds
  s_add_u32 s56, s59, 48
  s_and_b32 s56, s56, 63
  s_and_b32 s61, s56, 15
  s_lshl_b32 s61, s61, 4
  v_xor_b32 v5, s61, v2
  s_lshl_b32 m0, s56, 10
  s_add_u32 s57, s54, m0
  buffer_load_dwordx4 v5, s[12:15], s57 offen lds
  s_add_u32 s56, s59, 54
  s_and_b32 s56, s56, 63
  s_and_b32 s61, s56, 15
  s_lshl_b32 s61, s61, 4
  v_xor_b32 v5, s61, v2
  s_lshl_b32 m0, s56, 10
  s_add_u32 s57, s54, m0
  buffer_load_dwordx4 v5, s[12:15], s57 offen lds
  s_add_u32 s56, s60, 60
  s_cmp_ge_u32 s56, 64
  s_cbranch_scc1 L_sk_14
  s_add_u32 s56, s59, 60
  s_and_b32 s56, s56, 63
  s_and_b32 s61, s56, 15
  s_lshl_b32 s61, s61, 4
  v_xor_b32 v5, s61, v2
  s_lshl_b32 m0, s56, 10
  s_add_u32 s57, s54, m0
  buffer_load_dwordx4 v5, s[12:15], s57 offen lds
L_sk_14:
  s_add_u32 s56, s58, 18
  s_and_b32 s56, s56, 63
  s_lshl_b32 s57, s56, 13
  s_lshl_b32 s56, s56, 10
  s_add_u32 m0, s56, 65536
  s_nop 0
  buffer_load_dwordx4 v3, s[16:19], s57 offen lds
  s_add_u32 s56, s58, 24
  s_and_b32 s56, s56, 63
  s_lshl_b32 s57, s56, 13
  s_lshl_b32 s56, s56, 10
  s_add_u32 m0, s56, 65536
  s_nop 0
  buffer_load_dwordx4 v3, s[16:19], s57 offen lds
  s_add_u32 s56, s58, 30
  s_and_b32 s56, s56, 63
  s_lshl_b32 s57, s56, 13
  s_lshl_b32 s56, s56, 10
  s_add_u32 m0, s56, 65536
  s_nop 0
  buffer_load_dwordx4 v3, s[16:19], s57 offen lds
  s_add_u32 s56, s58, 36
  s_and_b32 s56, s56, 63
  s_lshl_b32 s57, s56, 13
  s_lshl_b32 s56, s56, 10
  s_add_u32 m0, s56, 65536
  s_nop 0
  buffer_load_dwordx4 v3, s[16:19], s57 offen lds
  s_add_u32 s56, s58, 42
  s_and_b32 s56, s56, 63
  s_lshl_b32 s57, s56, 13
  s_lshl_b32 s56, s56, 10
  s_add_u32 m0, s56, 65536
  s_nop 0
  buffer_load_dwordx4 v3, s[16:19], s57 offen lds
  s_add_u32 s56, s58, 48
  s_and_b32 s56, s56, 63
  s_lshl_b32 s57, s56, 13
  s_lshl_b32 s56, s56, 10
  s_add_u32 m0, s56, 65536
  s_nop 0
  buffer_load_dwordx4 v3, s[16:19], s57 offen lds
  s_add_u32 s56, s58, 54
  s_and_b32 s56, s56, 63
  s_lshl_b32 s57, s56, 13
  s_lshl_b32 s56, s56, 10
  s_add_u32 m0, s56, 65536
  s_nop 0
  buffer_load_dwordx4 v3, s[16:19], s57 offen lds
  s_add_u32 s56, s60, 60
  s_cmp_ge_u32 s56, 64
  s_cbranch_scc1 L_sk_22
  s_add_u32 s56, s58, 60
  s_and_b32 s56, s56, 63
  s_lshl_b32 s57, s56, 13
  s_lshl_b32 s56, s56, 10
  s_add_u32 m0, s56, 65536
  s_nop 0
  buffer_load_dwordx4 v3, s[16:19], s57 offen lds
L_sk_22:
  s_load_dword s7, s[52:53], 0
  s_mov_b32 s8, s52
  s_mov_b32 s9, s53
  s_mov_b32 s10, 23068672
  s_mov_b32 s11, 0x20000
  s_mov_b32 s12, s28
  s_mov_b32 s13, s29
  s_mov_b32 s14, 2097152
  s_mov_b32 s15, 0x20000
  s_cmp_lt_u32 s6, 4
  s_cbranch_scc1 L_f_gemm
  s_waitcnt vmcnt(0) lgkmcnt(0)
  s_add_u32 s7, s7, 0x9e3779b9
  s_barrier
L_f_help:
  s_cmp_eq_u32 s6, 7
  s_cbranch_scc1 L_f_norp
  s_and_b32 s3, s6, 3
  s_mov_b32 s96, s3
  s_and_b32 s94, s96, 1
  s_lshr_b32 s95, s96, 1
  s_mov_b32 s58, s96
  v_lshrrev_b32 v12, 2, v1
  v_and_b32 v13, 3, v1
  v_lshlrev_b32 v13, 4, v13
  v_mul_u32_u24 v14, 3584, v12
  v_add_u32 v14, v14, v13
  v_lshl_add_u32 v15, v12, 10, v13
  s_lshl_b32 s55, s58, 12
  s_add_u32 m0, s55, 139264
  s_mov_b32 s16, s40
  s_mov_b32 s17, s41
  s_mov_b32 s18, 1835008
  s_mov_b32 s19, 0x20000
  s_mul_i32 s56, s4, 16*3584
  s_mul_i32 s57, s5, 448
  s_add_u32 s56, s56, s57
  s_lshl_b32 s57, s58, 6
  s_add_u32 s56, s56, s57
  buffer_load_dwordx4 v14, s[16:19], s56 offen lds
  s_add_u32 m0, m0, 1024
  s_cmp_eq_u32 s58, 3
  s_cbranch_scc1 L_rpwo_23
  s_add_u32 s56, s56, 256
  buffer_load_dwordx4 v14, s[16:19], s56 offen lds
  s_branch L_rpw2_24
L_rpwo_23:
  s_mov_b32 s16, s36
  s_mov_b32 s17, s37
  s_mov_b32 s18, 524288
  s_mov_b32 s19, 0x20000
  s_lshl_b32 s56, s4, 14
  s_lshl_b32 s57, s5, 7
  s_add_u32 s56, s56, s57
  buffer_load_dwordx4 v15, s[16:19], s56 offen lds
  s_add_u32 s56, s56, 64
  s_add_u32 m0, m0, 3072
  s_nop 0
  buffer_load_dwordx4 v15, s[16:19], s56 offen lds
  s_sub_u32 m0, m0, 3072
L_rpw2_24:
  s_mov_b32 s16, s44
  s_mov_b32 s17, s45
  s_mov_b32 s18, 1835008
  s_mov_b32 s19, 0x20000
  s_lshl_b32 s60, s4, 2
  s_mul_i32 s61, s4, 3
  s_add_u32 s61, s61, 16
  s_cmp_lt_u32 s4, 16
  s_cselect_b32 s56, s60, s61
  s_cselect_b32 s60, 3, 2
  s_add_u32 s61, s95, 0
  s_min_u32 s61, s61, s60
  s_add_u32 s56, s56, s61
  s_lshl_b32 s56, s56, 14
  s_lshl_b32 s57, s5, 7
  s_add_u32 s56, s56, s57
  s_lshl_b32 s57, s94, 6
  s_add_u32 s56, s56, s57
  s_add_u32 m0, m0, 1024
  s_nop 0
  buffer_load_dwordx4 v15, s[16:19], s56 offen lds
  s_lshl_b32 s60, s4, 2
  s_mul_i32 s61, s4, 3
  s_add_u32 s61, s61, 16
  s_cmp_lt_u32 s4, 16
  s_cselect_b32 s56, s60, s61
  s_cselect_b32 s60, 3, 2
  s_add_u32 s61, s95, 2
  s_min_u32 s61, s61, s60
  s_add_u32 s56, s56, s61
  s_lshl_b32 s56, s56, 14
  s_lshl_b32 s57, s5, 7
  s_add_u32 s56, s56, s57
  s_lshl_b32 s57, s94, 6
  s_add_u32 s56, s56, s57
  s_add_u32 m0, m0, 1024
  s_nop 0
  buffer_load_dwordx4 v15, s[16:19], s56 offen lds
  s_cmp_eq_u32 s6, 4
  s_cbranch_scc0 L_f_norp
  s_mov_b32 s96, 3
  s_and_b32 s94, s96, 1
  s_lshr_b32 s95, s96, 1
  s_mov_b32 s58, s96
  v_lshrrev_b32 v12, 2, v1
  v_and_b32 v13, 3, v1
  v_lshlrev_b32 v13, 4, v13
  v_mul_u32_u24 v14, 3584, v12
  v_add_u32 v14, v14, v13
  v_lshl_add_u32 v15, v12, 10, v13
  s_lshl_b32 s55, s58, 12
  s_add_u32 m0, s55, 139264
  s_mov_b32 s16, s40
  s_mov_b32 s17, s41
  s_mov_b32 s18, 1835008
  s_mov_b32 s19, 0x20000
  s_mul_i32 s56, s4, 16*3584
  s_mul_i32 s57, s5, 448
  s_add_u32 s56, s56, s57
  s_lshl_b32 s57, s58, 6
  s_add_u32 s56, s56, s57
  buffer_load_dwordx4 v14, s[16:19], s56 offen lds
  s_add_u32 m0, m0, 1024
  s_cmp_eq_u32 s58, 3
  s_cbranch_scc1 L_rpwo_25
  s_add_u32 s56, s56, 256
  buffer_load_dwordx4 v14, s[16:19], s56 offen lds
  s_branch L_rpw2_26
L_rpwo_25:
  s_mov_b32 s16, s36
  s_mov_b32 s17, s37
  s_mov_b32 s18, 524288
  s_mov_b32 s19, 0x20000
  s_lshl_b32 s56, s4, 14
  s_lshl_b32 s57, s5, 7
  s_add_u32 s56, s56, s57
  buffer_load_dwordx4 v15, s[16:19], s56 offen lds
  s_add_u32 s56, s56, 64
  s_add_u32 m0, m0, 3072
  s_nop 0
  buffer_load_dwordx4 v15, s[16:19], s56 offen lds
  s_sub_u32 m0, m0, 3072
L_rpw2_26:
  s_mov_b32 s16, s44
  s_mov_b32 s17, s45
  s_mov_b32 s18, 1835008
  s_mov_b32 s19, 0x20000
  s_lshl_b32 s60, s4, 2
  s_mul_i32 s61, s4, 3
  s_add_u32 s61, s61, 16
  s_cmp_lt_u32 s4, 16
  s_cselect_b32 s56, s60, s61
  s_cselect_b32 s60, 3, 2
  s_add_u32 s61, s95, 0
  s_min_u32 s61, s61, s60
  s_add_u32 s56, s56, s61
  s_lshl_b32 s56, s56, 14
  s_lshl_b32 s57, s5, 7
  s_add_u32 s56, s56, s57
  s_lshl_b32 s57, s94, 6
  s_add_u32 s56, s56, s57
  s_add_u32 m0, m0, 1024
  s_nop 0
  buffer_load_dwordx4 v15, s[16:19], s56 offen lds
  s_lshl_b32 s60, s4, 2
  s_mul_i32 s61, s4, 3
  s_add_u32 s61, s61, 16
  s_cmp_lt_u32 s4, 16
  s_cselect_b32 s56, s60, s61
  s_cselect_b32 s60, 3, 2
  s_add_u32 s61, s95, 2
  s_min_u32 s61, s61, s60
  s_add_u32 s56, s56, s61
  s_lshl_b32 s56, s56, 14
  s_lshl_b32 s57, s5, 7
  s_add_u32 s56, s56, s57
  s_lshl_b32 s57, s94, 6
  s_add_u32 s56, s56, s57
  s_add_u32 m0, m0, 1024
  s_nop 0
  buffer_load_dwordx4 v15, s[16:19], s56 offen lds
L_f_norp:
  v_mov_b32 v18, 0x3f803f80
  v_mov_b32 v19, 0x3f803f80
  v_and_b32 v15, 255, v0
  v_lshlrev_b32 v15, 3, v15
  v_add_u32 v15, 131072, v15
  ds_write_b64 v15, v[18:19] offset:0
  ds_write_b64 v15, v[18:19] offset:2048
  ds_write_b64 v15, v[18:19] offset:4096
  ds_write_b64 v15, v[18:19] offset:6144
  v_mov_b32 v16, 0
  v_mov_b32 v17, 0
  v_mov_b32 v14, 161472
  ds_write_b64 v14, v[16:17]
  ds_write2_b32 v14, v16, v17 offset0:3 offset1:4
  ds_write_b32 v14, v16 offset:20
  ds_write_b32 v14, v16 offset:32
  ds_write2_b32 v14, v16, v17 offset0:9 offset1:10
  ds_write2_b32 v14, v16, v17 offset0:11 offset1:12
  ds_write_b32 v14, v16 offset:52
  v_and_b32 v12, 15, v1
  v_lshrrev_b32 v15, 5, v1
  v_lshrrev_b32 v13, 2, v12
  v_lshlrev_b32 v13, 7, v13
  v_lshl_add_u32 v13, v15, 10, v13
  v_lshrrev_b32 v14, 4, v1
  v_and_b32 v14, 1, v14
  v_lshlrev_b32 v14, 1, v14
  v_bfe_u32 v15, v12, 1, 1
  v_add_u32 v14, v14, v15
  s_lshl_b32 s57, s24, 2
  v_add_u32 v14, s57, v14
  v_lshrrev_b32 v15, 1, v12
  v_and_b32 v15, 4, v15
  v_xor_b32 v14, v14, v15
  v_lshl_add_u32 v13, v14, 4, v13
  v_and_b32 v15, 1, v12
  v_lshl_add_u32 v13, v15, 3, v13
  v_add_u32 v18, 65536, v13
  s_lshl_b32 s57, s26, 15
  v_add_u32 v18, s57, v18
  s_waitcnt lgkmcnt(0)
  ds_read_b64_tr_b16 v[108:109], v18 offset:0
  ds_read_b64_tr_b16 v[110:111], v18 offset:512
  ds_read_b64_tr_b16 v[112:113], v18 offset:2048
  ds_read_b64_tr_b16 v[114:115], v18 offset:2560
  ds_read_b64_tr_b16 v[116:117], v18 offset:4096
  ds_read_b64_tr_b16 v[118:119], v18 offset:4608
  ds_read_b64_tr_b16 v[120:121], v18 offset:6144
  ds_read_b64_tr_b16 v[122:123], v18 offset:6656
  ds_read_b64_tr_b16 v[124:125], v18 offset:8192
  ds_read_b64_tr_b16 v[126:127], v18 offset:8704
  ds_read_b64_tr_b16 v[128:129], v18 offset:10240
  ds_read_b64_tr_b16 v[130:131], v18 offset:10752
  v_and_b32 v20, 15, v1
  v_bfe_u32 v21, v1, 4, 1
  v_cmp_eq_u32 vcc, v20, v21
  v_mov_b32 v21, 0x3f803f80
  s_nop 0
  v_cndmask_b32 v68, 0, v21, vcc
  v_cndmask_b32 v69, 0, v21, vcc
  v_cndmask_b32 v70, 0, v21, vcc
  v_cndmask_b32 v71, 0, v21, vcc
  ds_read_b64_tr_b16 v[132:133], v18 offset:12288
  ds_read_b64_tr_b16 v[134:135], v18 offset:12800
  s_waitcnt lgkmcnt(12)
  v_mfma_f32_16x16x32_bf16 v[72:75], v[108:111], v[68:71], 0
  ds_read_b64_tr_b16 v[136:137], v18 offset:14336
  ds_read_b64_tr_b16 v[138:139], v18 offset:14848
  s_waitcnt lgkmcnt(12)
  v_mfma_f32_16x16x32_bf16 v[72:75], v[112:115], v[68:71], v[72:75]
  ds_read_b64_tr_b16 v[140:141], v18 offset:16384
  ds_read_b64_tr_b16 v[142:143], v18 offset:16896
  s_waitcnt lgkmcnt(12)
  v_mfma_f32_16x16x32_bf16 v[72:75], v[116:119], v[68:71], v[72:75]
  ds_read_b64_tr_b16 v[144:145], v18 offset:18432
  ds_read_b64_tr_b16 v[146:147], v18 offset:18944
  s_waitcnt lgkmcnt(12)
  v_mfma_f32_16x16x32_bf16 v[72:75], v[120:123], v[68:71], v[72:75]
  ds_read_b64_tr_b16 v[148:149], v18 offset:20480
  ds_read_b64_tr_b16 v[150:151], v18 offset:20992
  s_waitcnt lgkmcnt(12)
  v_mfma_f32_16x16x32_bf16 v[72:75], v[124:127], v[68:71], v[72:75]
  ds_read_b64_tr_b16 v[152:153], v18 offset:22528
  ds_read_b64_tr_b16 v[154:155], v18 offset:23040
  s_waitcnt lgkmcnt(12)
  v_mfma_f32_16x16x32_bf16 v[72:75], v[128:131], v[68:71], v[72:75]
  ds_read_b64_tr_b16 v[156:157], v18 offset:24576
  ds_read_b64_tr_b16 v[158:159], v18 offset:25088
  s_waitcnt lgkmcnt(12)
  v_mfma_f32_16x16x32_bf16 v[72:75], v[132:135], v[68:71], v[72:75]
  ds_read_b64_tr_b16 v[160:161], v18 offset:26624
  ds_read_b64_tr_b16 v[162:163], v18 offset:27136
  s_waitcnt lgkmcnt(12)
  v_mfma_f32_16x16x32_bf16 v[72:75], v[136:139], v[68:71], v[72:75]
  ds_read_b64_tr_b16 v[164:165], v18 offset:28672
  ds_read_b64_tr_b16 v[166:167], v18 offset:29184
  s_waitcnt lgkmcnt(12)
  v_mfma_f32_16x16x32_bf16 v[72:75], v[140:143], v[68:71], v[72:75]
  ds_read_b64_tr_b16 v[168:169], v18 offset:30720
  ds_read_b64_tr_b16 v[170:171], v18 offset:31232
  s_waitcnt lgkmcnt(12)
  v_mfma_f32_16x16x32_bf16 v[72:75], v[144:147], v[68:71], v[72:75]
  s_waitcnt lgkmcnt(10)
  v_mfma_f32_16x16x32_bf16 v[72:75], v[148:151], v[68:71], v[72:75]
  s_waitcnt lgkmcnt(8)
  v_mfma_f32_16x16x32_bf16 v[72:75], v[152:155], v[68:71], v[72:75]
  s_waitcnt lgkmcnt(6)
  v_mfma_f32_16x16x32_bf16 v[72:75], v[156:159], v[68:71], v[72:75]
  s_waitcnt lgkmcnt(4)
  v_mfma_f32_16x16x32_bf16 v[72:75], v[160:163], v[68:71], v[72:75]
  s_waitcnt lgkmcnt(2)
  v_mfma_f32_16x16x32_bf16 v[72:75], v[164:167], v[68:71], v[72:75]
  s_waitcnt lgkmcnt(0)
  v_mfma_f32_16x16x32_bf16 v[72:75], v[168:171], v[68:71], v[72:75]
  s_lshl_b32 s56, s24, 8
  s_lshl_b32 s57, s26, 7
  s_add_u32 s56, s56, s57
  s_add_u32 s56, s56, 162048
  v_lshrrev_b32 v14, 4, v1
  v_lshlrev_b32 v14, 4, v14
  v_lshl_add_u32 v14, v20, 6, v14
  v_add_u32 v14, s56, v14
  s_mov_b32 exec_lo, 0x30003
  s_mov_b32 exec_hi, 0x30003
  ds_write_b128 v14, v[72:75]
  s_mov_b64 exec, -1
  s_cmp_eq_u32 s6, 7
  s_cbranch_scc0 L_f_b2
  s_mov_b32 s59, 16384
  s_lshl_b32 s58, s4, 9
  s_add_u32 s58, s58, 12288
  v_lshlrev_b32 v14, 3, v1
  s_mov_b32 s56, 4096
L_kv_poll:
  buffer_load_dwordx4 v[20:23], v2, s[8:11], s56 offen offset:0 sc1
  buffer_load_dwordx4 v[24:27], v2, s[8:11], s56 offen offset:1024 sc1
  buffer_load_dwordx4 v[28:31], v2, s[8:11], s56 offen offset:2048 sc1
  buffer_load_dwordx4 v[32:35], v2, s[8:11], s56 offen offset:3072 sc1
  buffer_load_dwordx2 v[36:37], v14, s[8:11], s58 offen sc1
  s_waitcnt vmcnt(0)
  v_xor_b32 v38, s7, v36
  v_xor_b32 v39, s7, v20
  v_xor_b32 v40, s7, v22
  v_or3_b32 v38, v38, v39, v40
  v_xor_b32 v39, s7, v24
  v_xor_b32 v40, s7, v26
  v_or3_b32 v38, v38, v39, v40
  v_xor_b32 v39, s7, v28
  v_xor_b32 v40, s7, v30
  v_or3_b32 v38, v38, v39, v40
  v_xor_b32 v39, s7, v32
  v_xor_b32 v40, s7, v34
  v_or3_b32 v38, v38, v39, v40
  v_cmp_ne_u32 vcc, 0, v38
  s_cbranch_vccz L_kv_ok
  s_sub_u32 s59, s59, 1
  s_cmp_lg_u32 s59, 0
  s_cbranch_scc1 L_kv_poll
  s_or_b32 s27, s27, 1
L_kv_ok:
  v_lshlrev_b32 v38, 16, v37
  v_and_b32 v39, 0xffff0000, v37
  v_rcp_f32 v39, v39
  v_add_u32 v14, 161536, v14
  ds_write_b64 v14, v[38:39]
  v_max3_f32 v21, v21, v25, v29
  v_max_f32 v21, v21, v33
  s_nop 1
  v_max_f32_dpp v21, v21, v21 row_ror:8 row_mask:0xf bank_mask:0xf
  s_nop 1
  v_max_f32_dpp v21, v21, v21 row_ror:4 row_mask:0xf bank_mask:0xf
  s_nop 1
  v_max_f32_dpp v21, v21, v21 row_ror:2 row_mask:0xf bank_mask:0xf
  s_nop 1
  v_max_f32_dpp v21, v21, v21 row_ror:1 row_mask:0xf bank_mask:0xf
  v_mov_b32 v22, v21
  s_nop 1
  v_permlane16_swap_b32 v21, v22
  v_max_f32 v21, v21, v22
  v_mov_b32 v22, v21
  s_nop 1
  v_permlane32_swap_b32 v21, v22
  v_max_f32 v21, v21, v22
  v_mov_b32 v22, 161480
  ds_write_b32 v22, v21
  v_lshrrev_b32 v41, 3, v1
  s_mov_b64 s[60:61], 0
  v_add_u32 v42, 0, v41
  v_cmp_eq_u32 s[56:57], s4, v42
  v_cmp_ne_u32 vcc, s91, v23
  s_nop 0
  s_and_b64 vcc, vcc, s[56:57]
  s_or_b64 s[60:61], s[60:61], vcc
  v_add_u32 v42, 8, v41
  v_cmp_eq_u32 s[56:57], s4, v42
  v_cmp_ne_u32 vcc, s91, v27
  s_nop 0
  s_and_b64 vcc, vcc, s[56:57]
  s_or_b64 s[60:61], s[60:61], vcc
  v_add_u32 v42, 16, v41
  v_cmp_eq_u32 s[56:57], s4, v42
  v_cmp_ne_u32 vcc, s91, v31
  s_nop 0
  s_and_b64 vcc, vcc, s[56:57]
  s_or_b64 s[60:61], s[60:61], vcc
  v_add_u32 v42, 24, v41
  v_cmp_eq_u32 s[56:57], s4, v42
  v_cmp_ne_u32 vcc, s91, v35
  s_nop 0
  s_and_b64 vcc, vcc, s[56:57]
  s_or_b64 s[60:61], s[60:61], vcc
  s_cmp_eq_u64 s[60:61], 0
  s_cselect_b32 s56, 1, 0
  v_mov_b32 v42, s56
  v_mov_b32 v41, 161496
  ds_write_b32 v41, v42
L_f_b2:
  s_waitcnt lgkmcnt(0)
  s_barrier
  s_and_b32 s54, s6, 3
  s_add_u32 s57, s54, s93
  s_and_b32 s57, s57, 15
  s_lshl_b32 s57, s57, 12
  s_add_u32 s57, s57, 65536
  s_lshl_b32 m0, s54, 12
  s_nop 0
  buffer_load_dwordx4 v2, s[8:11], s57 offen offset:0 sc1 lds
  buffer_load_dwordx4 v2, s[8:11], s57 offen offset:1024 sc1 lds
  buffer_load_dwordx4 v2, s[8:11], s57 offen offset:2048 sc1 lds
  buffer_load_dwordx4 v2, s[8:11], s57 offen offset:3072 sc1 lds
  s_add_u32 s57, s57, 65536
  s_add_u32 m0, m0, 32768
  s_nop 0
  buffer_load_dwordx4 v2, s[8:11], s57 offen offset:0 sc1 lds
  buffer_load_dwordx4 v2, s[8:11], s57 offen offset:1024 sc1 lds
  buffer_load_dwordx4 v2, s[8:11], s57 offen offset:2048 sc1 lds
  buffer_load_dwordx4 v2, s[8:11], s57 offen offset:3072 sc1 lds
  s_cmp_eq_u32 s6, 7
  s_cbranch_scc1 L_f_w7rp
  s_waitcnt vmcnt(8)
  s_and_b32 s3, s6, 3
  s_mov_b32 s96, s3
  s_and_b32 s94, s96, 1
  s_lshr_b32 s95, s96, 1
  v_and_b32 v12, 15, v1
  v_lshrrev_b32 v13, 2, v12
  v_lshrrev_b32 v14, 5, v1
  v_lshl_add_u32 v13, v14, 2, v13
  v_lshlrev_b32 v13, 6, v13
  v_lshrrev_b32 v14, 4, v1
  v_and_b32 v14, 1, v14
  v_lshl_add_u32 v13, v14, 5, v13
  v_and_b32 v14, 3, v12
  v_lshl_add_u32 v13, v14, 3, v13
  s_lshl_b32 s55, s96, 12
  s_add_u32 s55, s55, 139264
  v_add_u32 v13, s55, v13
  ds_read_b64_tr_b16 v[96:97], v13 offset:0
  ds_read_b64_tr_b16 v[98:99], v13 offset:512
  ds_read_b64_tr_b16 v[100:101], v13 offset:1024
  ds_read_b64_tr_b16 v[102:103], v13 offset:1536
  ds_read_b64_tr_b16 v[104:105], v13 offset:2048
  ds_read_b64_tr_b16 v[106:107], v13 offset:2560
  ds_read_b64_tr_b16 v[108:109], v13 offset:3072
  ds_read_b64_tr_b16 v[110:111], v13 offset:3584
  ds_read_b64_tr_b16 v[112:113], v13 offset:4096
  ds_read_b64_tr_b16 v[114:115], v13 offset:4608
  s_mov_b32 s58, s96
  s_waitcnt lgkmcnt(0)
  s_mul_i32 s56, s5, 7
  s_add_u32 s56, s56, s58
  s_lshl_b32 s56, s56, 5
  s_add_u32 s56, s56, s4
  s_lshl_b32 s56, s56, 10
  s_add_u32 s56, s56, 1048576
  buffer_store_dwordx4 v[96:99], v2, s[8:11], s56 offen sc1
  s_cmp_eq_u32 s58, 3
  s_cbranch_scc1 L_rswo_27
  s_add_u32 s56, s56, 131072
  buffer_store_dwordx4 v[100:103], v2, s[8:11], s56 offen sc1
  s_branch L_rsw2_28
L_rswo_27:
  s_lshl_b32 s56, s5, 6
  s_add_u32 s56, s56, s4
  s_lshl_b32 s56, s56, 10
  s_add_u32 s56, s56, 5242880
  buffer_store_dwordx4 v[100:103], v2, s[8:11], s56 offen sc1
  s_add_u32 s56, s56, 32768
  buffer_store_dwordx4 v[112:115], v2, s[8:11], s56 offen sc1
L_rsw2_28:
  s_lshl_b32 s60, s4, 2
  s_mul_i32 s61, s4, 3
  s_add_u32 s61, s61, 16
  s_cmp_lt_u32 s4, 16
  s_cselect_b32 s56, s60, s61
  s_cselect_b32 s60, 3, 2
  s_add_u32 s61, s95, 0
  s_min_u32 s61, s61, s60
  s_add_u32 s56, s56, s61
  s_lshl_b32 s57, s5, 1
  s_add_u32 s57, s57, s94
  s_mul_i32 s57, s57, 112
  s_add_u32 s56, s56, s57
  s_lshl_b32 s56, s56, 10
  s_add_u32 s56, s56, 3145728
  buffer_store_dwordx4 v[104:107], v2, s[8:11], s56 offen sc1
  s_lshl_b32 s60, s4, 2
  s_mul_i32 s61, s4, 3
  s_add_u32 s61, s61, 16
  s_cmp_lt_u32 s4, 16
  s_cselect_b32 s56, s60, s61
  s_cselect_b32 s60, 3, 2
  s_add_u32 s61, s95, 2
  s_min_u32 s61, s61, s60
  s_add_u32 s56, s56, s61
  s_lshl_b32 s57, s5, 1
  s_add_u32 s57, s57, s94
  s_mul_i32 s57, s57, 112
  s_add_u32 s56, s56, s57
  s_lshl_b32 s56, s56, 10
  s_add_u32 s56, s56, 3145728
  buffer_store_dwordx4 v[108:111], v2, s[8:11], s56 offen sc1
  s_cmp_eq_u32 s6, 4
  s_cbranch_scc1 L_f_w4rp
  s_waitcnt vmcnt(4)
  s_branch L_f_q0
L_f_w4rp:
  s_mov_b32 s96, 3
  s_and_b32 s94, s96, 1
  s_lshr_b32 s95, s96, 1
  v_and_b32 v12, 15, v1
  v_lshrrev_b32 v13, 2, v12
  v_lshrrev_b32 v14, 5, v1
  v_lshl_add_u32 v13, v14, 2, v13
  v_lshlrev_b32 v13, 6, v13
  v_lshrrev_b32 v14, 4, v1
  v_and_b32 v14, 1, v14
  v_lshl_add_u32 v13, v14, 5, v13
  v_and_b32 v14, 3, v12
  v_lshl_add_u32 v13, v14, 3, v13
  s_lshl_b32 s55, s96, 12
  s_add_u32 s55, s55, 139264
  v_add_u32 v13, s55, v13
  ds_read_b64_tr_b16 v[96:97], v13 offset:0
  ds_read_b64_tr_b16 v[98:99], v13 offset:512
  ds_read_b64_tr_b16 v[100:101], v13 offset:1024
  ds_read_b64_tr_b16 v[102:103], v13 offset:1536
  ds_read_b64_tr_b16 v[104:105], v13 offset:2048
  ds_read_b64_tr_b16 v[106:107], v13 offset:2560
  ds_read_b64_tr_b16 v[108:109], v13 offset:3072
  ds_read_b64_tr_b16 v[110:111], v13 offset:3584
  ds_read_b64_tr_b16 v[112:113], v13 offset:4096
  ds_read_b64_tr_b16 v[114:115], v13 offset:4608
  s_mov_b32 s58, s96
  s_waitcnt lgkmcnt(0)
  s_mul_i32 s56, s5, 7
  s_add_u32 s56, s56, s58
  s_lshl_b32 s56, s56, 5
  s_add_u32 s56, s56, s4
  s_lshl_b32 s56, s56, 10
  s_add_u32 s56, s56, 1048576
  buffer_store_dwordx4 v[96:99], v2, s[8:11], s56 offen sc1
  s_cmp_eq_u32 s58, 3
  s_cbranch_scc1 L_rswo_29
  s_add_u32 s56, s56, 131072
  buffer_store_dwordx4 v[100:103], v2, s[8:11], s56 offen sc1
  s_branch L_rsw2_30
L_rswo_29:
  s_lshl_b32 s56, s5, 6
  s_add_u32 s56, s56, s4
  s_lshl_b32 s56, s56, 10
  s_add_u32 s56, s56, 5242880
  buffer_store_dwordx4 v[100:103], v2, s[8:11], s56 offen sc1
  s_add_u32 s56, s56, 32768
  buffer_store_dwordx4 v[112:115], v2, s[8:11], s56 offen sc1
L_rsw2_30:
  s_lshl_b32 s60, s4, 2
  s_mul_i32 s61, s4, 3
  s_add_u32 s61, s61, 16
  s_cmp_lt_u32 s4, 16
  s_cselect_b32 s56, s60, s61
  s_cselect_b32 s60, 3, 2
  s_add_u32 s61, s95, 0
  s_min_u32 s61, s61, s60
  s_add_u32 s56, s56, s61
  s_lshl_b32 s57, s5, 1
  s_add_u32 s57, s57, s94
  s_mul_i32 s57, s57, 112
  s_add_u32 s56, s56, s57
  s_lshl_b32 s56, s56, 10
  s_add_u32 s56, s56, 3145728
  buffer_store_dwordx4 v[104:107], v2, s[8:11], s56 offen sc1
  s_lshl_b32 s60, s4, 2
  s_mul_i32 s61, s4, 3
  s_add_u32 s61, s61, 16
  s_cmp_lt_u32 s4, 16
  s_cselect_b32 s56, s60, s61
  s_cselect_b32 s60, 3, 2
  s_add_u32 s61, s95, 2
  s_min_u32 s61, s61, s60
  s_add_u32 s56, s56, s61
  s_lshl_b32 s57, s5, 1
  s_add_u32 s57, s57, s94
  s_mul_i32 s57, s57, 112
  s_add_u32 s56, s56, s57
  s_lshl_b32 s56, s56, 10
  s_add_u32 s56, s56, 3145728
  buffer_store_dwordx4 v[108:111], v2, s[8:11], s56 offen sc1
  s_waitcnt vmcnt(9)
  s_branch L_f_q0
L_f_w7rp:
  s_waitcnt vmcnt(0)
L_f_q0:
  s_barrier
  s_and_b32 s56, s6, 3
  s_lshl_b32 s56, s56, 10
  s_add_u32 s56, s56, 156672
  v_add_u32 v14, s56, v2
  ds_read_b128 v[4:7], v14
  s_waitcnt lgkmcnt(0)
  s_branch L_f_done
L_f_gemm:
  v_and_b32 v6, 31, v1
  v_lshrrev_b32 v7, 5, v1
  s_lshl_b32 s57, s26, 5
  v_add_u32 v8, s57, v6
  v_lshlrev_b32 v8, 10, v8
  v_and_b32 v9, 15, v6
  v_xor_b32 v9, v9, v7
  v_lshl_add_u32 v8, v9, 4, v8
  v_xor_b32 v24, 0, v8
  v_xor_b32 v25, 32, v8
  v_xor_b32 v26, 64, v8
  v_xor_b32 v27, 96, v8
  v_xor_b32 v28, 128, v8
  v_xor_b32 v29, 160, v8
  v_xor_b32 v30, 192, v8
  v_xor_b32 v31, 224, v8
  v_and_b32 v12, 15, v1
  v_lshrrev_b32 v15, 5, v1
  v_lshrrev_b32 v13, 2, v12
  v_lshlrev_b32 v13, 7, v13
  v_lshl_add_u32 v13, v15, 10, v13
  v_lshrrev_b32 v14, 4, v1
  v_and_b32 v14, 1, v14
  v_lshlrev_b32 v14, 1, v14
  v_bfe_u32 v15, v12, 1, 1
  v_add_u32 v14, v14, v15
  s_lshl_b32 s57, s24, 2
  v_add_u32 v14, s57, v14
  v_lshrrev_b32 v15, 1, v12
  v_and_b32 v15, 4, v15
  v_xor_b32 v14, v14, v15
  v_lshl_add_u32 v13, v14, 4, v13
  v_and_b32 v15, 1, v12
  v_lshl_add_u32 v13, v15, 3, v13
  v_add_u32 v18, 65536, v13
  s_setprio 1
  s_waitcnt vmcnt(0) lgkmcnt(0)
  s_add_u32 s7, s7, 0x9e3779b9
  s_barrier
  ds_read_b128 v[36:39], v24 offset:0
  ds_read_b64_tr_b16 v[108:109], v18 offset:0
  ds_read_b64_tr_b16 v[110:111], v18 offset:512
  ds_read_b128 v[40:43], v25 offset:0
  ds_read_b64_tr_b16 v[112:113], v18 offset:2048
  ds_read_b64_tr_b16 v[114:115], v18 offset:2560
  ds_read_b128 v[44:47], v26 offset:0
  ds_read_b64_tr_b16 v[116:117], v18 offset:4096
  ds_read_b64_tr_b16 v[118:119], v18 offset:4608
  ds_read_b128 v[48:51], v27 offset:0
  ds_read_b64_tr_b16 v[120:121], v18 offset:6144
  ds_read_b64_tr_b16 v[122:123], v18 offset:6656
  ds_read_b128 v[52:55], v28 offset:0
  ds_read_b64_tr_b16 v[124:125], v18 offset:8192
  ds_read_b64_tr_b16 v[126:127], v18 offset:8704
  ds_read_b128 v[56:59], v29 offset:0
  ds_read_b64_tr_b16 v[128:129], v18 offset:10240
  ds_read_b64_tr_b16 v[130:131], v18 offset:10752
  ds_read_b128 v[60:63], v30 offset:0
  ds_read_b64_tr_b16 v[132:133], v18 offset:12288
  ds_read_b64_tr_b16 v[134:135], v18 offset:12800
  ds_read_b128 v[64:67], v31 offset:0
  ds_read_b64_tr_b16 v[136:137], v18 offset:14336
  ds_read_b64_tr_b16 v[138:139], v18 offset:14848
  s_waitcnt lgkmcnt(12)
  v_mfma_f32_32x32x16_bf16 v[72:87], v[108:111], v[36:39], 0
  v_mfma_f32_32x32x16_bf16 v[72:87], v[112:115], v[40:43], v[72:87]
  v_mfma_f32_32x32x16_bf16 v[72:87], v[116:119], v[44:47], v[72:87]
  v_mfma_f32_32x32x16_bf16 v[72:87], v[120:123], v[48:51], v[72:87]
  ds_read_b128 v[36:39], v24 offset:256
  ds_read_b64_tr_b16 v[108:109], v18 offset:16384
  ds_read_b64_tr_b16 v[110:111], v18 offset:16896
  ds_read_b128 v[40:43], v25 offset:256
  ds_read_b64_tr_b16 v[112:113], v18 offset:18432
  ds_read_b64_tr_b16 v[114:115], v18 offset:18944
  ds_read_b128 v[44:47], v26 offset:256
  ds_read_b64_tr_b16 v[116:117], v18 offset:20480
  ds_read_b64_tr_b16 v[118:119], v18 offset:20992
  ds_read_b128 v[48:51], v27 offset:256
  ds_read_b64_tr_b16 v[120:121], v18 offset:22528
  ds_read_b64_tr_b16 v[122:123], v18 offset:23040
  s_waitcnt lgkmcnt(12)
  v_mfma_f32_32x32x16_bf16 v[72:87], v[124:127], v[52:55], v[72:87]
  v_mfma_f32_32x32x16_bf16 v[72:87], v[128:131], v[56:59], v[72:87]
  v_mfma_f32_32x32x16_bf16 v[72:87], v[132:135], v[60:63], v[72:87]
  v_mfma_f32_32x32x16_bf16 v[72:87], v[136:139], v[64:67], v[72:87]
  ds_read_b128 v[52:55], v28 offset:256
  ds_read_b64_tr_b16 v[124:125], v18 offset:24576
  ds_read_b64_tr_b16 v[126:127], v18 offset:25088
  ds_read_b128 v[56:59], v29 offset:256
  ds_read_b64_tr_b16 v[128:129], v18 offset:26624
  ds_read_b64_tr_b16 v[130:131], v18 offset:27136
  ds_read_b128 v[60:63], v30 offset:256
  ds_read_b64_tr_b16 v[132:133], v18 offset:28672
  ds_read_b64_tr_b16 v[134:135], v18 offset:29184
  ds_read_b128 v[64:67], v31 offset:256
  ds_read_b64_tr_b16 v[136:137], v18 offset:30720
  ds_read_b64_tr_b16 v[138:139], v18 offset:31232
  s_waitcnt lgkmcnt(12)
  v_mfma_f32_32x32x16_bf16 v[72:87], v[108:111], v[36:39], v[72:87]
  v_mfma_f32_32x32x16_bf16 v[72:87], v[112:115], v[40:43], v[72:87]
  v_mfma_f32_32x32x16_bf16 v[72:87], v[116:119], v[44:47], v[72:87]
  v_mfma_f32_32x32x16_bf16 v[72:87], v[120:123], v[48:51], v[72:87]
  ds_read_b128 v[36:39], v24 offset:512
  ds_read_b64_tr_b16 v[108:109], v18 offset:32768
  ds_read_b64_tr_b16 v[110:111], v18 offset:33280
  ds_read_b128 v[40:43], v25 offset:512
  ds_read_b64_tr_b16 v[112:113], v18 offset:34816
  ds_read_b64_tr_b16 v[114:115], v18 offset:35328
  ds_read_b128 v[44:47], v26 offset:512
  ds_read_b64_tr_b16 v[116:117], v18 offset:36864
  ds_read_b64_tr_b16 v[118:119], v18 offset:37376
  ds_read_b128 v[48:51], v27 offset:512
  ds_read_b64_tr_b16 v[120:121], v18 offset:38912
  ds_read_b64_tr_b16 v[122:123], v18 offset:39424
  s_waitcnt lgkmcnt(12)
  v_mfma_f32_32x32x16_bf16 v[72:87], v[124:127], v[52:55], v[72:87]
  v_mfma_f32_32x32x16_bf16 v[72:87], v[128:131], v[56:59], v[72:87]
  v_mfma_f32_32x32x16_bf16 v[72:87], v[132:135], v[60:63], v[72:87]
  v_mfma_f32_32x32x16_bf16 v[72:87], v[136:139], v[64:67], v[72:87]
  ds_read_b128 v[52:55], v28 offset:512
  ds_read_b64_tr_b16 v[124:125], v18 offset:40960
  ds_read_b64_tr_b16 v[126:127], v18 offset:41472
  ds_read_b128 v[56:59], v29 offset:512
  ds_read_b64_tr_b16 v[128:129], v18 offset:43008
  ds_read_b64_tr_b16 v[130:131], v18 offset:43520
  ds_read_b128 v[60:63], v30 offset:512
  ds_read_b64_tr_b16 v[132:133], v18 offset:45056
  ds_read_b64_tr_b16 v[134:135], v18 offset:45568
  ds_read_b128 v[64:67], v31 offset:512
  ds_read_b64_tr_b16 v[136:137], v18 offset:47104
  ds_read_b64_tr_b16 v[138:139], v18 offset:47616
  s_waitcnt lgkmcnt(12)
  v_mfma_f32_32x32x16_bf16 v[72:87], v[108:111], v[36:39], v[72:87]
  v_mfma_f32_32x32x16_bf16 v[72:87], v[112:115], v[40:43], v[72:87]
  v_mfma_f32_32x32x16_bf16 v[72:87], v[116:119], v[44:47], v[72:87]
  v_mfma_f32_32x32x16_bf16 v[72:87], v[120:123], v[48:51], v[72:87]
  ds_read_b128 v[36:39], v24 offset:768
  ds_read_b64_tr_b16 v[108:109], v18 offset:49152
  ds_read_b64_tr_b16 v[110:111], v18 offset:49664
  ds_read_b128 v[40:43], v25 offset:768
  ds_read_b64_tr_b16 v[112:113], v18 offset:51200
  ds_read_b64_tr_b16 v[114:115], v18 offset:51712
  ds_read_b128 v[44:47], v26 offset:768
  ds_read_b64_tr_b16 v[116:117], v18 offset:53248
  ds_read_b64_tr_b16 v[118:119], v18 offset:53760
  ds_read_b128 v[48:51], v27 offset:768
  ds_read_b64_tr_b16 v[120:121], v18 offset:55296
  ds_read_b64_tr_b16 v[122:123], v18 offset:55808
  s_waitcnt lgkmcnt(12)
  v_mfma_f32_32x32x16_bf16 v[72:87], v[124:127], v[52:55], v[72:87]
  v_mfma_f32_32x32x16_bf16 v[72:87], v[128:131], v[56:59], v[72:87]
  v_mfma_f32_32x32x16_bf16 v[72:87], v[132:135], v[60:63], v[72:87]
  v_mfma_f32_32x32x16_bf16 v[72:87], v[136:139], v[64:67], v[72:87]
  ds_read_b128 v[52:55], v28 offset:768
  ds_read_b64_tr_b16 v[124:125], v18 offset:57344
  ds_read_b64_tr_b16 v[126:127], v18 offset:57856
  ds_read_b128 v[56:59], v29 offset:768
  ds_read_b64_tr_b16 v[128:129], v18 offset:59392
  ds_read_b64_tr_b16 v[130:131], v18 offset:59904
  ds_read_b128 v[60:63], v30 offset:768
  ds_read_b64_tr_b16 v[132:133], v18 offset:61440
  ds_read_b64_tr_b16 v[134:135], v18 offset:61952
  ds_read_b128 v[64:67], v31 offset:768
  ds_read_b64_tr_b16 v[136:137], v18 offset:63488
  ds_read_b64_tr_b16 v[138:139], v18 offset:64000
  s_waitcnt lgkmcnt(12)
  v_mfma_f32_32x32x16_bf16 v[72:87], v[108:111], v[36:39], v[72:87]
  v_mfma_f32_32x32x16_bf16 v[72:87], v[112:115], v[40:43], v[72:87]
  v_mfma_f32_32x32x16_bf16 v[72:87], v[116:119], v[44:47], v[72:87]
  v_mfma_f32_32x32x16_bf16 v[72:87], v[120:123], v[48:51], v[72:87]
  s_waitcnt lgkmcnt(0)
  v_mfma_f32_32x32x16_bf16 v[72:87], v[124:127], v[52:55], v[72:87]
  v_mfma_f32_32x32x16_bf16 v[72:87], v[128:131], v[56:59], v[72:87]
  v_mfma_f32_32x32x16_bf16 v[72:87], v[132:135], v[60:63], v[72:87]
  v_mfma_f32_32x32x16_bf16 v[72:87], v[136:139], v[64:67], v[72:87]
  s_barrier
  s_lshl_b32 s56, s24, 8
  s_add_u32 s56, s56, 162048
  v_lshlrev_b32 v14, 4, v7
  v_add_u32 v14, s56, v14
  ds_read_b128 v[36:39], v14 offset:0
  ds_read_b128 v[52:55], v14 offset:128
  ds_read_b128 v[40:43], v14 offset:32
  ds_read_b128 v[56:59], v14 offset:160
  ds_read_b128 v[44:47], v14 offset:64
  ds_read_b128 v[60:63], v14 offset:192
  ds_read_b128 v[48:51], v14 offset:96
  ds_read_b128 v[64:67], v14 offset:224
  s_lshl_b32 s56, s26, 8
  s_add_u32 s56, s56, 161536
  v_lshlrev_b32 v15, 3, v6
  v_add_u32 v15, s56, v15
  ds_read_b64 v[106:107], v15
  s_waitcnt lgkmcnt(0)
  v_mul_f32 v107, 0x3eb8aa3b, v107
  v_add_f32 v36, v36, v52
  v_add_f32 v37, v37, v53
  v_add_f32 v38, v38, v54
  v_add_f32 v39, v39, v55
  v_add_f32 v40, v40, v56
  v_add_f32 v41, v41, v57
  v_add_f32 v42, v42, v58
  v_add_f32 v43, v43, v59
  v_add_f32 v44, v44, v60
  v_add_f32 v45, v45, v61
  v_add_f32 v46, v46, v62
  v_add_f32 v47, v47, v63
  v_add_f32 v48, v48, v64
  v_add_f32 v49, v49, v65
  v_add_f32 v50, v50, v66
  v_add_f32 v51, v51, v67
  v_fma_f32 v72, -v106, v36, v72
  v_fma_f32 v73, -v106, v37, v73
  v_fma_f32 v74, -v106, v38, v74
  v_fma_f32 v75, -v106, v39, v75
  v_fma_f32 v76, -v106, v40, v76
  v_fma_f32 v77, -v106, v41, v77
  v_fma_f32 v78, -v106, v42, v78
  v_fma_f32 v79, -v106, v43, v79
  v_fma_f32 v80, -v106, v44, v80
  v_fma_f32 v81, -v106, v45, v81
  v_fma_f32 v82, -v106, v46, v82
  v_fma_f32 v83, -v106, v47, v83
  v_fma_f32 v84, -v106, v48, v84
  v_fma_f32 v85, -v106, v49, v85
  v_fma_f32 v86, -v106, v50, v86
  v_fma_f32 v87, -v106, v51, v87
  v_mul_f32 v72, v72, v107
  v_mul_f32 v73, v73, v107
  v_mul_f32 v74, v74, v107
  v_mul_f32 v75, v75, v107
  v_mul_f32 v76, v76, v107
  v_mul_f32 v77, v77, v107
  v_mul_f32 v78, v78, v107
  v_mul_f32 v79, v79, v107
  v_mul_f32 v80, v80, v107
  v_mul_f32 v81, v81, v107
  v_mul_f32 v82, v82, v107
  v_mul_f32 v83, v83, v107
  v_mul_f32 v84, v84, v107
  v_mul_f32 v85, v85, v107
  v_mul_f32 v86, v86, v107
  v_mul_f32 v87, v87, v107
  v_cvt_pk_bf16_f32 v20, v80, v81
  v_cvt_pk_bf16_f32 v21, v82, v83
  v_cvt_pk_bf16_f32 v22, v84, v85
  v_cvt_pk_bf16_f32 v23, v86, v87
  s_lshl_b32 s56, s6, 10
  s_add_u32 s56, s56, 156672
  v_add_u32 v14, s56, v2
  ds_write_b128 v14, v[20:23]
  v_cvt_pk_bf16_f32 v4, v72, v73
  v_cvt_pk_bf16_f32 v5, v74, v75
  v_cvt_pk_bf16_f32 v6, v76, v77
  v_cvt_pk_bf16_f32 v7, v78, v79
  s_waitcnt lgkmcnt(0)
  s_barrier
L_f_done:
  v_mov_b32 v96, 161480
  ds_read_b32 v98, v96
  ds_read_b32 v101, v96 offset:16
  v_mov_b32 v8, 0xdddddddd
  v_mov_b32 v9, v2
  v_mov_b32 v3, 0
  v_and_b32 v97, 15, v1
  v_lshrrev_b32 v99, 5, v1
  v_lshl_add_u32 v97, v99, 4, v97
  v_lshlrev_b32 v97, 4, v97
  v_and_b32 v99, 16, v1
  v_cmp_eq_u32 vcc, 0, v99
  v_add_u32 v100, 131072, v97
  v_add_u32 v99, 32768, v97
  v_cndmask_b32 v10, v100, v99, vcc
  v_mov_b32 v100, 0
  v_mov_b32 v99, 8192
  v_cndmask_b32 v11, v100, v99, vcc
  ds_read_b128 v[16:19], v9 offset:0
  ds_read_b128 v[20:23], v9 offset:1024
  ds_read_b128 v[24:27], v10 offset:0
  v_mov_b32 v80, 0
  v_mov_b32 v81, 0
  v_mov_b32 v82, 0
  v_mov_b32 v83, 0
  v_mov_b32 v84, 0
  v_mov_b32 v85, 0
  v_mov_b32 v86, 0
  v_mov_b32 v87, 0
  v_mov_b32 v88, 0
  v_mov_b32 v89, 0
  v_mov_b32 v90, 0
  v_mov_b32 v91, 0
  v_mov_b32 v92, 0
  v_mov_b32 v93, 0
  v_mov_b32 v94, 0
  v_mov_b32 v95, 0
  s_lshl_b32 s99, s4, 1
  s_add_u32 s99, s99, s26
  s_lshl_b32 s99, s99, 5
  s_lshl_b32 s3, s5, 2
  s_add_u32 s99, s99, s3
  s_lshl_b32 s3, s24, 1
  s_add_u32 s99, s99, s3
  s_add_u32 s99, s99, s25
  s_lshl_b32 s99, s99, 10
  s_lshl_b32 s100, s25, 1
  s_add_u32 s100, s100, s24
  s_mul_i32 s56, s5, 7
  s_add_u32 s56, s56, s6
  s_lshl_b32 s56, s56, 15
  s_add_u32 s96, s56, 1048576
  s_mul_i32 s56, s5, 224
  s_mul_i32 s57, s6, 14
  s_add_u32 s56, s56, s57
  s_lshl_b32 s56, s56, 10
  s_add_u32 s97, s56, 3145728
  s_lshl_b32 s56, s5, 16
  s_and_b32 s57, s6, 3
  s_lshl_b32 s57, s57, 14
  s_add_u32 s56, s56, s57
  s_add_u32 s98, s56, 5242880
  v_mov_b32 v99, 0
  v_dot2c_f32_bf16 v99, v4, v4
  v_dot2c_f32_bf16 v99, v5, v5
  v_dot2c_f32_bf16 v99, v6, v6
  v_dot2c_f32_bf16 v99, v7, v7
  s_nop 2
  v_mov_b32 v100, v99
  s_nop 1
  v_permlane32_swap_b32 v99, v100
  v_add_f32 v99, v99, v100
  s_waitcnt lgkmcnt(3)
  v_readfirstlane_b32 s90, v101
  v_mul_f32 v99, v99, v98
  v_sqrt_f32 v99, v99
  v_mov_b32 v100, 0x3c23d70a
  v_fmac_f32 v100, 0x3f8147ae, v99
  v_mov_b32 v97, 0x42200000
  v_cmp_nle_f32 vcc, v100, v97
  s_cbranch_vccz L_p2_fast
  v_mov_b32 v100, 0xff61b1e6
  s_mov_b32 s57, 65536
L_p2_maxloop:
  buffer_load_dwordx4 v[104:107], v2, s[8:11], s57 offen sc1
  s_waitcnt vmcnt(0)
  v_mfma_f32_32x32x16_bf16 v[48:63], v[104:107], v[4:7], 0
  s_nop 11
  v_max_f32 v100, v100, v48
  v_max_f32 v100, v100, v49
  v_max_f32 v100, v100, v50
  v_max_f32 v100, v100, v51
  v_max_f32 v100, v100, v52
  v_max_f32 v100, v100, v53
  v_max_f32 v100, v100, v54
  v_max_f32 v100, v100, v55
  v_max_f32 v100, v100, v56
  v_max_f32 v100, v100, v57
  v_max_f32 v100, v100, v58
  v_max_f32 v100, v100, v59
  v_max_f32 v100, v100, v60
  v_max_f32 v100, v100, v61
  v_max_f32 v100, v100, v62
  v_max_f32 v100, v100, v63
  s_add_u32 s57, s57, 1024
  s_cmp_lt_u32 s57, 131072
  s_cbranch_scc1 L_p2_maxloop
  v_mov_b32 v99, v100
  s_nop 1
  v_permlane32_swap_b32 v100, v99
  v_max_f32 v100, v100, v99
L_p2_fast:
  v_sub_f32 v32, 0, v100
  v_sub_f32 v33, 0, v100
  v_sub_f32 v34, 0, v100
  v_sub_f32 v35, 0, v100
  v_sub_f32 v36, 0, v100
  v_sub_f32 v37, 0, v100
  v_sub_f32 v38, 0, v100
  v_sub_f32 v39, 0, v100
  v_sub_f32 v40, 0, v100
  v_sub_f32 v41, 0, v100
  v_sub_f32 v42, 0, v100
  v_sub_f32 v43, 0, v100
  v_sub_f32 v44, 0, v100
  v_sub_f32 v45, 0, v100
  v_sub_f32 v46, 0, v100
  v_sub_f32 v47, 0, v100
  s_cmp_eq_u32 s25, 0
  s_cbranch_scc0 L_loop_B
  s_setprio 2
  s_and_b32 s56, s6, 3
  s_add_u32 s57, s56, 4
  s_add_u32 s57, s57, s93
  s_and_b32 s57, s57, 15
  s_lshl_b32 s57, s57, 12
  s_add_u32 s94, s57, 65536
  s_lshl_b32 s56, s56, 12
  s_add_u32 s95, s56, 16384
  s_waitcnt lgkmcnt(2)
  v_mfma_f32_32x32x16_bf16 v[48:63], v[16:19], v[4:7], v[32:47]
  ds_read_b128 v[16:19], v9 offset:2048
  s_nop 10
  v_exp_f32 v48, v48
  v_exp_f32 v49, v49
  v_exp_f32 v50, v50
  v_exp_f32 v51, v51
  ds_read_b128 v[28:31], v10 offset:512
  v_exp_f32 v52, v52
  v_exp_f32 v53, v53
  v_exp_f32 v54, v54
  v_exp_f32 v55, v55
  s_waitcnt lgkmcnt(3)
  v_mfma_f32_32x32x16_bf16 v[64:79], v[20:23], v[4:7], v[32:47]
  ds_read_b128 v[20:23], v9 offset:3072
  v_exp_f32 v56, v56
  v_exp_f32 v57, v57
  v_exp_f32 v58, v58
  v_exp_f32 v59, v59
  s_waitcnt lgkmcnt(3)
  v_smfmac_f32_32x32x32_bf16 v[80:95], v[24:27], v[48:55], v8
  ds_read_b128 v[24:27], v10 offset:1024
  v_exp_f32 v60, v60
  v_exp_f32 v61, v61
  v_exp_f32 v62, v62
  v_exp_f32 v63, v63
  s_mov_b32 m0, s95
  s_nop 0
  buffer_load_dwordx4 v2, s[8:11], s94 offen offset:0 sc1 lds
  buffer_load_dwordx4 v2, s[8:11], s94 offen offset:1024 sc1 lds
  v_exp_f32 v64, v64
  v_exp_f32 v65, v65
  v_exp_f32 v66, v66
  v_exp_f32 v67, v67
  s_waitcnt lgkmcnt(2)
  v_smfmac_f32_32x32x32_bf16 v[80:95], v[28:31], v[56:63], v8
  ds_read_b128 v[28:31], v10 offset:1536
  v_exp_f32 v68, v68
  v_exp_f32 v69, v69
  v_exp_f32 v70, v70
  v_exp_f32 v71, v71
  v_mfma_f32_32x32x16_bf16 v[48:63], v[16:19], v[4:7], v[32:47]
  ds_read_b128 v[16:19], v9 offset:4096
  v_exp_f32 v72, v72
  v_exp_f32 v73, v73
  v_exp_f32 v74, v74
  v_exp_f32 v75, v75
  s_waitcnt lgkmcnt(2)
  v_smfmac_f32_32x32x32_bf16 v[80:95], v[24:27], v[64:71], v8
  ds_read_b128 v[24:27], v10 offset:2048
  v_exp_f32 v76, v76
  v_exp_f32 v77, v77
  v_exp_f32 v78, v78
  v_exp_f32 v79, v79
  s_mov_b32 m0, s95
  s_nop 0
  buffer_load_dwordx4 v2, s[8:11], s94 offen offset:2048 sc1 lds
  buffer_load_dwordx4 v2, s[8:11], s94 offen offset:3072 sc1 lds
  v_exp_f32 v48, v48
  v_exp_f32 v49, v49
  v_exp_f32 v50, v50
  v_exp_f32 v51, v51
  s_waitcnt lgkmcnt(2)
  v_smfmac_f32_32x32x32_bf16 v[80:95], v[28:31], v[72:79], v8
  ds_read_b128 v[28:31], v10 offset:2560
  v_exp_f32 v52, v52
  v_exp_f32 v53, v53
  v_exp_f32 v54, v54
  v_exp_f32 v55, v55
  v_mfma_f32_32x32x16_bf16 v[64:79], v[20:23], v[4:7], v[32:47]
  ds_read_b128 v[20:23], v9 offset:5120
  v_exp_f32 v56, v56
  v_exp_f32 v57, v57
  v_exp_f32 v58, v58
  v_exp_f32 v59, v59
  s_waitcnt lgkmcnt(2)
  v_smfmac_f32_32x32x32_bf16 v[80:95], v[24:27], v[48:55], v8
  ds_read_b128 v[24:27], v10 offset:3072
  v_exp_f32 v60, v60
  v_exp_f32 v61, v61
  v_exp_f32 v62, v62
  v_exp_f32 v63, v63
  s_add_u32 m0, s95, 32768
  s_add_u32 s56, s94, 65536
  buffer_load_dwordx4 v2, s[8:11], s56 offen offset:0 sc1 lds
  buffer_load_dwordx4 v2, s[8:11], s56 offen offset:1024 sc1 lds
  v_exp_f32 v64, v64
  v_exp_f32 v65, v65
  v_exp_f32 v66, v66
  v_exp_f32 v67, v67
  s_waitcnt lgkmcnt(2)
  v_smfmac_f32_32x32x32_bf16 v[80:95], v[28:31], v[56:63], v8
  ds_read_b128 v[28:31], v10 offset:3584
  v_exp_f32 v68, v68
  v_exp_f32 v69, v69
  v_exp_f32 v70, v70
  v_exp_f32 v71, v71
  v_mfma_f32_32x32x16_bf16 v[48:63], v[16:19], v[4:7], v[32:47]
  ds_read_b128 v[16:19], v9 offset:6144
  v_exp_f32 v72, v72
  v_exp_f32 v73, v73
  v_exp_f32 v74, v74
  v_exp_f32 v75, v75
  s_waitcnt lgkmcnt(2)
  v_smfmac_f32_32x32x32_bf16 v[80:95], v[24:27], v[64:71], v8
  ds_read_b128 v[24:27], v10 offset:4096
  v_exp_f32 v76, v76
  v_exp_f32 v77, v77
  v_exp_f32 v78, v78
  v_exp_f32 v79, v79
  s_add_u32 m0, s95, 32768
  s_add_u32 s56, s94, 65536
  buffer_load_dwordx4 v2, s[8:11], s56 offen offset:2048 sc1 lds
  buffer_load_dwordx4 v2, s[8:11], s56 offen offset:3072 sc1 lds
  s_and_b32 s56, s6, 3
  s_add_u32 s57, s56, 8
  s_add_u32 s57, s57, s93
  s_and_b32 s57, s57, 15
  s_lshl_b32 s57, s57, 12
  s_add_u32 s94, s57, 65536
  s_lshl_b32 s56, s56, 12
  s_add_u32 s95, s56, 65536
  v_exp_f32 v48, v48
  v_exp_f32 v49, v49
  v_exp_f32 v50, v50
  v_exp_f32 v51, v51
  s_waitcnt lgkmcnt(2)
  v_smfmac_f32_32x32x32_bf16 v[80:95], v[28:31], v[72:79], v8
  ds_read_b128 v[28:31], v10 offset:4608
  v_exp_f32 v52, v52
  v_exp_f32 v53, v53
  v_exp_f32 v54, v54
  v_exp_f32 v55, v55
  v_mfma_f32_32x32x16_bf16 v[64:79], v[20:23], v[4:7], v[32:47]
  ds_read_b128 v[20:23], v9 offset:7168
  v_exp_f32 v56, v56
  v_exp_f32 v57, v57
  v_exp_f32 v58, v58
  v_exp_f32 v59, v59
  s_waitcnt lgkmcnt(2)
  v_smfmac_f32_32x32x32_bf16 v[80:95], v[24:27], v[48:55], v8
  ds_read_b128 v[24:27], v10 offset:5120
  v_exp_f32 v60, v60
  v_exp_f32 v61, v61
  v_exp_f32 v62, v62
  v_exp_f32 v63, v63
  s_mov_b32 m0, s95
  s_nop 0
  buffer_load_dwordx4 v2, s[8:11], s94 offen offset:0 sc1 lds
  buffer_load_dwordx4 v2, s[8:11], s94 offen offset:1024 sc1 lds
  v_exp_f32 v64, v64
  v_exp_f32 v65, v65
  v_exp_f32 v66, v66
  v_exp_f32 v67, v67
  s_waitcnt lgkmcnt(2)
  v_smfmac_f32_32x32x32_bf16 v[80:95], v[28:31], v[56:63], v8
  ds_read_b128 v[28:31], v10 offset:5632
  v_exp_f32 v68, v68
  v_exp_f32 v69, v69
  v_exp_f32 v70, v70
  v_exp_f32 v71, v71
  v_mfma_f32_32x32x16_bf16 v[48:63], v[16:19], v[4:7], v[32:47]
  ds_read_b128 v[16:19], v9 offset:8192
  v_exp_f32 v72, v72
  v_exp_f32 v73, v73
  v_exp_f32 v74, v74
  v_exp_f32 v75, v75
  s_waitcnt lgkmcnt(2)
  v_smfmac_f32_32x32x32_bf16 v[80:95], v[24:27], v[64:71], v8
  ds_read_b128 v[24:27], v10 offset:6144
  v_exp_f32 v76, v76
  v_exp_f32 v77, v77
  v_exp_f32 v78, v78
  v_exp_f32 v79, v79
  s_mov_b32 m0, s95
  s_nop 0
  buffer_load_dwordx4 v2, s[8:11], s94 offen offset:2048 sc1 lds
  buffer_load_dwordx4 v2, s[8:11], s94 offen offset:3072 sc1 lds
  v_exp_f32 v48, v48
  v_exp_f32 v49, v49
  v_exp_f32 v50, v50
  v_exp_f32 v51, v51
  s_waitcnt lgkmcnt(2)
  v_smfmac_f32_32x32x32_bf16 v[80:95], v[28:31], v[72:79], v8
  ds_read_b128 v[28:31], v10 offset:6656
  v_exp_f32 v52, v52
  v_exp_f32 v53, v53
  v_exp_f32 v54, v54
  v_exp_f32 v55, v55
  v_mfma_f32_32x32x16_bf16 v[64:79], v[20:23], v[4:7], v[32:47]
  ds_read_b128 v[20:23], v9 offset:9216
  v_exp_f32 v56, v56
  v_exp_f32 v57, v57
  v_exp_f32 v58, v58
  v_exp_f32 v59, v59
  s_waitcnt lgkmcnt(2)
  v_smfmac_f32_32x32x32_bf16 v[80:95], v[24:27], v[48:55], v8
  ds_read_b128 v[24:27], v10 offset:7168
  v_exp_f32 v60, v60
  v_exp_f32 v61, v61
  v_exp_f32 v62, v62
  v_exp_f32 v63, v63
  s_add_u32 m0, s95, 32768
  s_add_u32 s56, s94, 65536
  buffer_load_dwordx4 v2, s[8:11], s56 offen offset:0 sc1 lds
  buffer_load_dwordx4 v2, s[8:11], s56 offen offset:1024 sc1 lds
  v_exp_f32 v64, v64
  v_exp_f32 v65, v65
  v_exp_f32 v66, v66
  v_exp_f32 v67, v67
  s_waitcnt lgkmcnt(2)
  v_smfmac_f32_32x32x32_bf16 v[80:95], v[28:31], v[56:63], v8
  ds_read_b128 v[28:31], v10 offset:7680
  v_add_u32 v10, v10, v11
  v_exp_f32 v68, v68
  v_exp_f32 v69, v69
  v_exp_f32 v70, v70
  v_exp_f32 v71, v71
  v_mfma_f32_32x32x16_bf16 v[48:63], v[16:19], v[4:7], v[32:47]
  ds_read_b128 v[16:19], v9 offset:10240
  v_exp_f32 v72, v72
  v_exp_f32 v73, v73
  v_exp_f32 v74, v74
  v_exp_f32 v75, v75
  s_waitcnt lgkmcnt(2)
  v_smfmac_f32_32x32x32_bf16 v[80:95], v[24:27], v[64:71], v8
  ds_read_b128 v[24:27], v10 offset:0
  v_exp_f32 v76, v76
  v_exp_f32 v77, v77
  v_exp_f32 v78, v78
  v_exp_f32 v79, v79
  s_add_u32 m0, s95, 32768
  s_add_u32 s56, s94, 65536
  buffer_load_dwordx4 v2, s[8:11], s56 offen offset:2048 sc1 lds
  buffer_load_dwordx4 v2, s[8:11], s56 offen offset:3072 sc1 lds
  v_exp_f32 v48, v48
  v_exp_f32 v49, v49
  v_exp_f32 v50, v50
  v_exp_f32 v51, v51
  s_waitcnt lgkmcnt(2)
  v_smfmac_f32_32x32x32_bf16 v[80:95], v[28:31], v[72:79], v8
  ds_read_b128 v[28:31], v10 offset:512
  v_exp_f32 v52, v52
  v_exp_f32 v53, v53
  v_exp_f32 v54, v54
  v_exp_f32 v55, v55
  v_mfma_f32_32x32x16_bf16 v[64:79], v[20:23], v[4:7], v[32:47]
  ds_read_b128 v[20:23], v9 offset:11264
  v_exp_f32 v56, v56
  v_exp_f32 v57, v57
  v_exp_f32 v58, v58
  v_exp_f32 v59, v59
  s_waitcnt lgkmcnt(2)
  v_smfmac_f32_32x32x32_bf16 v[80:95], v[24:27], v[48:55], v8
  ds_read_b128 v[24:27], v10 offset:1024
  v_exp_f32 v60, v60
  v_exp_f32 v61, v61
  v_exp_f32 v62, v62
  v_exp_f32 v63, v63
  v_exp_f32 v64, v64
  v_exp_f32 v65, v65
  v_exp_f32 v66, v66
  v_exp_f32 v67, v67
  s_waitcnt lgkmcnt(2)
  v_smfmac_f32_32x32x32_bf16 v[80:95], v[28:31], v[56:63], v8
  ds_read_b128 v[28:31], v10 offset:1536
  v_exp_f32 v68, v68
  v_exp_f32 v69, v69
  v_exp_f32 v70, v70
  v_exp_f32 v71, v71
  v_mfma_f32_32x32x16_bf16 v[48:63], v[16:19], v[4:7], v[32:47]
  ds_read_b128 v[16:19], v9 offset:12288
  v_exp_f32 v72, v72
  v_exp_f32 v73, v73
  v_exp_f32 v74, v74
  v_exp_f32 v75, v75
  s_waitcnt lgkmcnt(2)
  v_smfmac_f32_32x32x32_bf16 v[80:95], v[24:27], v[64:71], v8
  ds_read_b128 v[24:27], v10 offset:2048
  v_exp_f32 v76, v76
  v_exp_f32 v77, v77
  v_exp_f32 v78, v78
  v_exp_f32 v79, v79
  v_exp_f32 v48, v48
  v_exp_f32 v49, v49
  v_exp_f32 v50, v50
  v_exp_f32 v51, v51
  s_waitcnt lgkmcnt(2)
  v_smfmac_f32_32x32x32_bf16 v[80:95], v[28:31], v[72:79], v8
  ds_read_b128 v[28:31], v10 offset:2560
  v_exp_f32 v52, v52
  v_exp_f32 v53, v53
  v_exp_f32 v54, v54
  v_exp_f32 v55, v55
  v_mfma_f32_32x32x16_bf16 v[64:79], v[20:23], v[4:7], v[32:47]
  ds_read_b128 v[20:23], v9 offset:13312
  v_exp_f32 v56, v56
  v_exp_f32 v57, v57
  v_exp_f32 v58, v58
  v_exp_f32 v59, v59
  s_waitcnt lgkmcnt(2)
  v_smfmac_f32_32x32x32_bf16 v[80:95], v[24:27], v[48:55], v8
  ds_read_b128 v[24:27], v10 offset:3072
  v_exp_f32 v60, v60
  v_exp_f32 v61, v61
  v_exp_f32 v62, v62
  v_exp_f32 v63, v63
  s_waitcnt vmcnt(0)
  v_mov_b32 v0, 161472
  s_mov_b64 exec, 2
  ds_add_u32 v0, v1
  s_mov_b64 exec, -1
  v_exp_f32 v64, v64
  v_exp_f32 v65, v65
  v_exp_f32 v66, v66
  v_exp_f32 v67, v67
  s_waitcnt lgkmcnt(2)
  v_smfmac_f32_32x32x32_bf16 v[80:95], v[28:31], v[56:63], v8
  ds_read_b128 v[28:31], v10 offset:3584
  v_exp_f32 v68, v68
  v_exp_f32 v69, v69
  v_exp_f32 v70, v70
  v_exp_f32 v71, v71
  v_mfma_f32_32x32x16_bf16 v[48:63], v[16:19], v[4:7], v[32:47]
  ds_read_b128 v[16:19], v9 offset:14336
  v_exp_f32 v72, v72
  v_exp_f32 v73, v73
  v_exp_f32 v74, v74
  v_exp_f32 v75, v75
  s_waitcnt lgkmcnt(2)
  v_smfmac_f32_32x32x32_bf16 v[80:95], v[24:27], v[64:71], v8
  ds_read_b128 v[24:27], v10 offset:4096
  v_exp_f32 v76, v76
  v_exp_f32 v77, v77
  v_exp_f32 v78, v78
  v_exp_f32 v79, v79
  v_exp_f32 v48, v48
  v_exp_f32 v49, v49
  v_exp_f32 v50, v50
  v_exp_f32 v51, v51
  s_waitcnt lgkmcnt(2)
  v_smfmac_f32_32x32x32_bf16 v[80:95], v[28:31], v[72:79], v8
  ds_read_b128 v[28:31], v10 offset:4608
  v_exp_f32 v52, v52
  v_exp_f32 v53, v53
  v_exp_f32 v54, v54
  v_exp_f32 v55, v55
  v_mfma_f32_32x32x16_bf16 v[64:79], v[20:23], v[4:7], v[32:47]
  ds_read_b128 v[20:23], v9 offset:15360
  v_exp_f32 v56, v56
  v_exp_f32 v57, v57
  v_exp_f32 v58, v58
  v_exp_f32 v59, v59
  s_waitcnt lgkmcnt(2)
  v_smfmac_f32_32x32x32_bf16 v[80:95], v[24:27], v[48:55], v8
  ds_read_b128 v[24:27], v10 offset:5120
  v_exp_f32 v60, v60
  v_exp_f32 v61, v61
  v_exp_f32 v62, v62
  v_exp_f32 v63, v63
  s_mov_b32 s59, 16384
L_lw_31:
  v_mov_b32 v0, 161472
  ds_read_b32 v0, v0
  s_waitcnt lgkmcnt(0)
  v_readfirstlane_b32 s61, v0
  s_nop 0
  s_cmp_ge_u32 s61, 4
  s_cbranch_scc0 L_lw_31_r
L_lw_31_ok:
  v_exp_f32 v64, v64
  v_exp_f32 v65, v65
  v_exp_f32 v66, v66
  v_exp_f32 v67, v67
  s_waitcnt lgkmcnt(2)
  v_smfmac_f32_32x32x32_bf16 v[80:95], v[28:31], v[56:63], v8
  ds_read_b128 v[28:31], v10 offset:5632
  v_exp_f32 v68, v68
  v_exp_f32 v69, v69
  v_exp_f32 v70, v70
  v_exp_f32 v71, v71
  v_mfma_f32_32x32x16_bf16 v[48:63], v[16:19], v[4:7], v[32:47]
  ds_read_b128 v[16:19], v9 offset:16384
  v_exp_f32 v72, v72
  v_exp_f32 v73, v73
  v_exp_f32 v74, v74
  v_exp_f32 v75, v75
  s_waitcnt lgkmcnt(2)
  v_smfmac_f32_32x32x32_bf16 v[80:95], v[24:27], v[64:71], v8
  ds_read_b128 v[24:27], v10 offset:6144
  v_exp_f32 v76, v76
  v_exp_f32 v77, v77
  v_exp_f32 v78, v78
  v_exp_f32 v79, v79
  s_mov_b32 s59, 16384
L_lw_32:
  v_mov_b32 v0, 161504
  ds_read_b32 v0, v0
  s_waitcnt lgkmcnt(0)
  v_readfirstlane_b32 s61, v0
  s_nop 0
  s_cmp_ge_u32 s61, 1
  s_cbranch_scc0 L_lw_32_r
L_lw_32_ok:
  v_exp_f32 v48, v48
  v_exp_f32 v49, v49
  v_exp_f32 v50, v50
  v_exp_f32 v51, v51
  s_waitcnt lgkmcnt(2)
  v_smfmac_f32_32x32x32_bf16 v[80:95], v[28:31], v[72:79], v8
  ds_read_b128 v[28:31], v10 offset:6656
  v_exp_f32 v52, v52
  v_exp_f32 v53, v53
  v_exp_f32 v54, v54
  v_exp_f32 v55, v55
  v_mfma_f32_32x32x16_bf16 v[64:79], v[20:23], v[4:7], v[32:47]
  ds_read_b128 v[20:23], v9 offset:17408
  v_exp_f32 v56, v56
  v_exp_f32 v57, v57
  v_exp_f32 v58, v58
  v_exp_f32 v59, v59
  s_waitcnt lgkmcnt(2)
  v_smfmac_f32_32x32x32_bf16 v[80:95], v[24:27], v[48:55], v8
  ds_read_b128 v[24:27], v10 offset:7168
  v_exp_f32 v60, v60
  v_exp_f32 v61, v61
  v_exp_f32 v62, v62
  v_exp_f32 v63, v63
  buffer_load_dwordx4 v[128:131], v2, s[8:11], s96 offen offset:0 sc1
  s_mov_b32 s16, s42
  s_mov_b32 s17, s43
  s_mov_b32 s18, 3584
  s_mov_b32 s19, 0x20000
  s_mul_i32 s56, s5, 448
  s_lshl_b32 s57, s6, 6
  s_add_u32 s56, s56, s57
  v_lshlrev_b32 v12, 1, v1
  buffer_load_ushort v124, v12, s[16:19], s56 offen
  v_exp_f32 v64, v64
  v_exp_f32 v65, v65
  v_exp_f32 v66, v66
  v_exp_f32 v67, v67
  s_waitcnt lgkmcnt(2)
  v_smfmac_f32_32x32x32_bf16 v[80:95], v[28:31], v[56:63], v8
  ds_read_b128 v[28:31], v10 offset:7680
  v_add_u32 v10, v10, v11
  v_exp_f32 v68, v68
  v_exp_f32 v69, v69
  v_exp_f32 v70, v70
  v_exp_f32 v71, v71
  v_mfma_f32_32x32x16_bf16 v[48:63], v[16:19], v[4:7], v[32:47]
  ds_read_b128 v[16:19], v9 offset:18432
  v_exp_f32 v72, v72
  v_exp_f32 v73, v73
  v_exp_f32 v74, v74
  v_exp_f32 v75, v75
  s_waitcnt lgkmcnt(2)
  v_smfmac_f32_32x32x32_bf16 v[80:95], v[24:27], v[64:71], v8
  ds_read_b128 v[24:27], v10 offset:0
  v_exp_f32 v76, v76
  v_exp_f32 v77, v77
  v_exp_f32 v78, v78
  v_exp_f32 v79, v79
  buffer_load_dwordx4 v[132:135], v2, s[8:11], s96 offen offset:1024 sc1
  v_exp_f32 v48, v48
  v_exp_f32 v49, v49
  v_exp_f32 v50, v50
  v_exp_f32 v51, v51
  s_waitcnt lgkmcnt(2)
  v_smfmac_f32_32x32x32_bf16 v[80:95], v[28:31], v[72:79], v8
  ds_read_b128 v[28:31], v10 offset:512
  v_exp_f32 v52, v52
  v_exp_f32 v53, v53
  v_exp_f32 v54, v54
  v_exp_f32 v55, v55
  v_mfma_f32_32x32x16_bf16 v[64:79], v[20:23], v[4:7], v[32:47]
  ds_read_b128 v[20:23], v9 offset:19456
  v_exp_f32 v56, v56
  v_exp_f32 v57, v57
  v_exp_f32 v58, v58
  v_exp_f32 v59, v59
  s_waitcnt lgkmcnt(2)
  v_smfmac_f32_32x32x32_bf16 v[80:95], v[24:27], v[48:55], v8
  ds_read_b128 v[24:27], v10 offset:1024
  v_exp_f32 v60, v60
  v_exp_f32 v61, v61
  v_exp_f32 v62, v62
  v_exp_f32 v63, v63
  buffer_load_dwordx4 v[136:139], v2, s[8:11], s96 offen offset:2048 sc1
  s_waitcnt vmcnt(2)
  v_lshlrev_b32 v124, 16, v124
  s_lshl_b32 s56, s6, 8
  s_add_u32 s56, s56, 162176
  v_lshlrev_b32 v12, 2, v1
  v_add_u32 v12, s56, v12
  s_mov_b32 exec_lo, 0xffffffff
  s_mov_b32 exec_hi, 0x0
  ds_write_b32 v12, v124
  s_mov_b64 exec, -1
  v_exp_f32 v64, v64
  v_exp_f32 v65, v65
  v_exp_f32 v66, v66
  v_exp_f32 v67, v67
  s_waitcnt lgkmcnt(2)
  v_smfmac_f32_32x32x32_bf16 v[80:95], v[28:31], v[56:63], v8
  ds_read_b128 v[28:31], v10 offset:1536
  v_exp_f32 v68, v68
  v_exp_f32 v69, v69
  v_exp_f32 v70, v70
  v_exp_f32 v71, v71
  v_mfma_f32_32x32x16_bf16 v[48:63], v[16:19], v[4:7], v[32:47]
  ds_read_b128 v[16:19], v9 offset:20480
  v_exp_f32 v72, v72
  v_exp_f32 v73, v73
  v_exp_f32 v74, v74
  v_exp_f32 v75, v75
  s_waitcnt lgkmcnt(2)
  v_smfmac_f32_32x32x32_bf16 v[80:95], v[24:27], v[64:71], v8
  ds_read_b128 v[24:27], v10 offset:2048
  v_exp_f32 v76, v76
  v_exp_f32 v77, v77
  v_exp_f32 v78, v78
  v_exp_f32 v79, v79
  v_mov_b32 v116, -1
  v_mov_b32 v117, -1
  v_mov_b32 v118, -1
  v_mov_b32 v119, -1
  s_lshl_b32 s58, s25, 10
  s_sub_u32 s58, s99, s58
  s_add_u32 s56, s58, 6291456
  s_cmp_eq_u32 s90, 1
  s_cbranch_scc0 L_hs_33
  buffer_store_dwordx4 v[116:119], v2, s[8:11], s56 offen offset:0
  buffer_store_dwordx4 v[116:119], v2, s[8:11], s56 offen offset:1024
L_hd_34:
  buffer_load_dwordx4 v[140:143], v2, s[8:11], s96 offen offset:3072 sc1
  s_add_u32 s96, s96, 4096
  v_exp_f32 v48, v48
  v_exp_f32 v49, v49
  v_exp_f32 v50, v50
  v_exp_f32 v51, v51
  s_waitcnt lgkmcnt(2)
  v_smfmac_f32_32x32x32_bf16 v[80:95], v[28:31], v[72:79], v8
  ds_read_b128 v[28:31], v10 offset:2560
  v_exp_f32 v52, v52
  v_exp_f32 v53, v53
  v_exp_f32 v54, v54
  v_exp_f32 v55, v55
  v_mfma_f32_32x32x16_bf16 v[64:79], v[20:23], v[4:7], v[32:47]
  ds_read_b128 v[20:23], v9 offset:21504
  v_exp_f32 v56, v56
  v_exp_f32 v57, v57
  v_exp_f32 v58, v58
  v_exp_f32 v59, v59
  s_waitcnt lgkmcnt(2)
  v_smfmac_f32_32x32x32_bf16 v[80:95], v[24:27], v[48:55], v8
  ds_read_b128 v[24:27], v10 offset:3072
  v_exp_f32 v60, v60
  v_exp_f32 v61, v61
  v_exp_f32 v62, v62
  v_exp_f32 v63, v63
  s_lshl_b32 s58, s25, 10
  s_sub_u32 s58, s99, s58
  s_add_u32 s56, s58, 8388608
  s_cmp_eq_u32 s90, 1
  s_cbranch_scc0 L_hs_35
  buffer_store_dwordx4 v[116:119], v2, s[8:11], s56 offen offset:0
  buffer_store_dwordx4 v[116:119], v2, s[8:11], s56 offen offset:1024
L_hd_36:
  buffer_load_dwordx4 v[144:147], v2, s[8:11], s96 offen offset:0 sc1
  v_exp_f32 v64, v64
  v_exp_f32 v65, v65
  v_exp_f32 v66, v66
  v_exp_f32 v67, v67
  s_waitcnt lgkmcnt(2)
  v_smfmac_f32_32x32x32_bf16 v[80:95], v[28:31], v[56:63], v8
  ds_read_b128 v[28:31], v10 offset:3584
  v_exp_f32 v68, v68
  v_exp_f32 v69, v69
  v_exp_f32 v70, v70
  v_exp_f32 v71, v71
  v_mfma_f32_32x32x16_bf16 v[48:63], v[16:19], v[4:7], v[32:47]
  ds_read_b128 v[16:19], v9 offset:22528
  v_exp_f32 v72, v72
  v_exp_f32 v73, v73
  v_exp_f32 v74, v74
  v_exp_f32 v75, v75
  s_waitcnt lgkmcnt(2)
  v_smfmac_f32_32x32x32_bf16 v[80:95], v[24:27], v[64:71], v8
  ds_read_b128 v[24:27], v10 offset:4096
  v_exp_f32 v76, v76
  v_exp_f32 v77, v77
  v_exp_f32 v78, v78
  v_exp_f32 v79, v79
  s_lshl_b32 s56, s4, 1
  s_add_u32 s56, s56, s26
  s_lshl_b32 s56, s56, 3
  s_add_u32 s56, s56, s5
  s_lshl_b32 s56, s56, 10
  s_add_u32 s56, s56, 17825792
  s_cmp_eq_u32 s90, 1
  s_cbranch_scc0 L_hs_37
  buffer_store_dwordx4 v[116:119], v2, s[8:11], s56 offen
L_hd_38:
  s_lshl_b32 s56, s4, 1
  s_add_u32 s56, s56, s26
  s_mul_i32 s56, s56, 112
  s_mul_i32 s3, s5, 14
  s_add_u32 s56, s56, s3
  s_mul_i32 s3, s24, 7
  s_add_u32 s56, s56, s3
  s_add_u32 s56, s56, 0
  s_lshl_b32 s56, s56, 10
  s_add_u32 s56, s56, 10485760
  s_cmp_eq_u32 s90, 1
  s_cbranch_scc0 L_hs_39
  buffer_store_dwordx4 v[116:119], v2, s[8:11], s56 offen offset:0
L_hd_40:
  buffer_load_dwordx4 v[148:151], v2, s[8:11], s96 offen offset:1024 sc1
  v_exp_f32 v48, v48
  v_exp_f32 v49, v49
  v_exp_f32 v50, v50
  v_exp_f32 v51, v51
  s_waitcnt lgkmcnt(2)
  v_smfmac_f32_32x32x32_bf16 v[80:95], v[28:31], v[72:79], v8
  ds_read_b128 v[28:31], v10 offset:4608
  v_exp_f32 v52, v52
  v_exp_f32 v53, v53
  v_exp_f32 v54, v54
  v_exp_f32 v55, v55
  v_mfma_f32_32x32x16_bf16 v[64:79], v[20:23], v[4:7], v[32:47]
  ds_read_b128 v[20:23], v9 offset:23552
  v_exp_f32 v56, v56
  v_exp_f32 v57, v57
  v_exp_f32 v58, v58
  v_exp_f32 v59, v59
  s_waitcnt lgkmcnt(2)
  v_smfmac_f32_32x32x32_bf16 v[80:95], v[24:27], v[48:55], v8
  ds_read_b128 v[24:27], v10 offset:5120
  v_exp_f32 v60, v60
  v_exp_f32 v61, v61
  v_exp_f32 v62, v62
  v_exp_f32 v63, v63
  s_lshl_b32 s56, s4, 1
  s_add_u32 s56, s56, s26
  s_mul_i32 s56, s56, 112
  s_mul_i32 s3, s5, 14
  s_add_u32 s56, s56, s3
  s_mul_i32 s3, s24, 7
  s_add_u32 s56, s56, s3
  s_add_u32 s56, s56, 1
  s_lshl_b32 s56, s56, 10
  s_add_u32 s56, s56, 10485760
  s_cmp_eq_u32 s90, 1
  s_cbranch_scc0 L_hs_41
  buffer_store_dwordx4 v[116:119], v2, s[8:11], s56 offen offset:0
  buffer_store_dwordx4 v[116:119], v2, s[8:11], s56 offen offset:1024
L_hd_42:
  buffer_load_dwordx4 v[152:155], v2, s[8:11], s96 offen offset:2048 sc1
  v_exp_f32 v64, v64
  v_exp_f32 v65, v65
  v_exp_f32 v66, v66
  v_exp_f32 v67, v67
  s_waitcnt lgkmcnt(2)
  v_smfmac_f32_32x32x32_bf16 v[80:95], v[28:31], v[56:63], v8
  ds_read_b128 v[28:31], v10 offset:5632
  v_exp_f32 v68, v68
  v_exp_f32 v69, v69
  v_exp_f32 v70, v70
  v_exp_f32 v71, v71
  v_mfma_f32_32x32x16_bf16 v[48:63], v[16:19], v[4:7], v[32:47]
  ds_read_b128 v[16:19], v9 offset:24576
  v_exp_f32 v72, v72
  v_exp_f32 v73, v73
  v_exp_f32 v74, v74
  v_exp_f32 v75, v75
  s_waitcnt lgkmcnt(2)
  v_smfmac_f32_32x32x32_bf16 v[80:95], v[24:27], v[64:71], v8
  ds_read_b128 v[24:27], v10 offset:6144
  v_exp_f32 v76, v76
  v_exp_f32 v77, v77
  v_exp_f32 v78, v78
  v_exp_f32 v79, v79
  s_lshl_b32 s56, s4, 1
  s_add_u32 s56, s56, s26
  s_mul_i32 s56, s56, 112
  s_mul_i32 s3, s5, 14
  s_add_u32 s56, s56, s3
  s_mul_i32 s3, s24, 7
  s_add_u32 s56, s56, s3
  s_add_u32 s56, s56, 3
  s_lshl_b32 s56, s56, 10
  s_add_u32 s56, s56, 10485760
  s_cmp_eq_u32 s90, 1
  s_cbranch_scc0 L_hs_43
  buffer_store_dwordx4 v[116:119], v2, s[8:11], s56 offen offset:0
  buffer_store_dwordx4 v[116:119], v2, s[8:11], s56 offen offset:1024
L_hd_44:
  buffer_load_dwordx4 v[156:159], v2, s[8:11], s96 offen offset:3072 sc1
  s_add_u32 s96, s96, 4096
  v_exp_f32 v48, v48
  v_exp_f32 v49, v49
  v_exp_f32 v50, v50
  v_exp_f32 v51, v51
  s_waitcnt lgkmcnt(2)
  v_smfmac_f32_32x32x32_bf16 v[80:95], v[28:31], v[72:79], v8
  ds_read_b128 v[28:31], v10 offset:6656
  v_exp_f32 v52, v52
  v_exp_f32 v53, v53
  v_exp_f32 v54, v54
  v_exp_f32 v55, v55
  v_mfma_f32_32x32x16_bf16 v[64:79], v[20:23], v[4:7], v[32:47]
  ds_read_b128 v[20:23], v9 offset:25600
  v_exp_f32 v56, v56
  v_exp_f32 v57, v57
  v_exp_f32 v58, v58
  v_exp_f32 v59, v59
  s_waitcnt lgkmcnt(2)
  v_smfmac_f32_32x32x32_bf16 v[80:95], v[24:27], v[48:55], v8
  ds_read_b128 v[24:27], v10 offset:7168
  v_exp_f32 v60, v60
  v_exp_f32 v61, v61
  v_exp_f32 v62, v62
  v_exp_f32 v63, v63
  s_lshl_b32 s56, s4, 1
  s_add_u32 s56, s56, s26
  s_mul_i32 s56, s56, 112
  s_mul_i32 s3, s5, 14
  s_add_u32 s56, s56, s3
  s_mul_i32 s3, s24, 7
  s_add_u32 s56, s56, s3
  s_add_u32 s56, s56, 5
  s_lshl_b32 s56, s56, 10
  s_add_u32 s56, s56, 10485760
  s_cmp_eq_u32 s90, 1
  s_cbranch_scc0 L_hs_45
  buffer_store_dwordx4 v[116:119], v2, s[8:11], s56 offen offset:0
  buffer_store_dwordx4 v[116:119], v2, s[8:11], s56 offen offset:1024
L_hd_46:
  buffer_load_dwordx4 v[160:163], v2, s[8:11], s96 offen offset:0 sc1
  v_exp_f32 v64, v64
  v_exp_f32 v65, v65
  v_exp_f32 v66, v66
  v_exp_f32 v67, v67
  s_waitcnt lgkmcnt(2)
  v_smfmac_f32_32x32x32_bf16 v[80:95], v[28:31], v[56:63], v8
  ds_read_b128 v[28:31], v10 offset:7680
  v_add_u32 v10, v10, v11
  v_exp_f32 v68, v68
  v_exp_f32 v69, v69
  v_exp_f32 v70, v70
  v_exp_f32 v71, v71
  v_mfma_f32_32x32x16_bf16 v[48:63], v[16:19], v[4:7], v[32:47]
  ds_read_b128 v[16:19], v9 offset:26624
  v_exp_f32 v72, v72
  v_exp_f32 v73, v73
  v_exp_f32 v74, v74
  v_exp_f32 v75, v75
  s_waitcnt lgkmcnt(2)
  v_smfmac_f32_32x32x32_bf16 v[80:95], v[24:27], v[64:71], v8
  ds_read_b128 v[24:27], v10 offset:0
  v_exp_f32 v76, v76
  v_exp_f32 v77, v77
  v_exp_f32 v78, v78
  v_exp_f32 v79, v79
  buffer_load_dwordx4 v[164:167], v2, s[8:11], s96 offen offset:1024 sc1
  v_exp_f32 v48, v48
  v_exp_f32 v49, v49
  v_exp_f32 v50, v50
  v_exp_f32 v51, v51
  s_waitcnt lgkmcnt(2)
  v_smfmac_f32_32x32x32_bf16 v[80:95], v[28:31], v[72:79], v8
  ds_read_b128 v[28:31], v10 offset:512
  v_exp_f32 v52, v52
  v_exp_f32 v53, v53
  v_exp_f32 v54, v54
  v_exp_f32 v55, v55
  v_mfma_f32_32x32x16_bf16 v[64:79], v[20:23], v[4:7], v[32:47]
  ds_read_b128 v[20:23], v9 offset:27648
  v_exp_f32 v56, v56
  v_exp_f32 v57, v57
  v_exp_f32 v58, v58
  v_exp_f32 v59, v59
  s_waitcnt lgkmcnt(2)
  v_smfmac_f32_32x32x32_bf16 v[80:95], v[24:27], v[48:55], v8
  ds_read_b128 v[24:27], v10 offset:1024
  v_exp_f32 v60, v60
  v_exp_f32 v61, v61
  v_exp_f32 v62, v62
  v_exp_f32 v63, v63
  buffer_load_dwordx4 v[168:171], v2, s[8:11], s96 offen offset:2048 sc1
  v_exp_f32 v64, v64
  v_exp_f32 v65, v65
  v_exp_f32 v66, v66
  v_exp_f32 v67, v67
  s_waitcnt lgkmcnt(2)
  v_smfmac_f32_32x32x32_bf16 v[80:95], v[28:31], v[56:63], v8
  ds_read_b128 v[28:31], v10 offset:1536
  v_exp_f32 v68, v68
  v_exp_f32 v69, v69
  v_exp_f32 v70, v70
  v_exp_f32 v71, v71
  v_mfma_f32_32x32x16_bf16 v[48:63], v[16:19], v[4:7], v[32:47]
  ds_read_b128 v[16:19], v9 offset:28672
  v_exp_f32 v72, v72
  v_exp_f32 v73, v73
  v_exp_f32 v74, v74
  v_exp_f32 v75, v75
  s_waitcnt lgkmcnt(2)
  v_smfmac_f32_32x32x32_bf16 v[80:95], v[24:27], v[64:71], v8
  ds_read_b128 v[24:27], v10 offset:2048
  v_exp_f32 v76, v76
  v_exp_f32 v77, v77
  v_exp_f32 v78, v78
  v_exp_f32 v79, v79
  buffer_load_dwordx4 v[172:175], v2, s[8:11], s96 offen offset:3072 sc1
  s_add_u32 s96, s96, 4096
  s_waitcnt vmcnt(3)
  v_mov_b32 v12, 161512
  v_mov_b32 v13, 1
  s_mov_b64 exec, 1
  ds_add_rtn_u32 v13, v12, v13
  s_waitcnt lgkmcnt(0)
  v_readfirstlane_b32 s56, v13
  s_mov_b64 exec, -1
  s_cmp_eq_u32 s56, 3
  s_cbranch_scc0 L_pub_47
  s_lshl_b32 s56, s5, 5
  s_add_u32 s56, s56, s4
  s_lshl_b32 s56, s56, 7
  s_add_u32 s56, s56, 22085632
  v_mov_b32 v14, s7
  v_mov_b32 v12, 0
  s_mov_b64 exec, 1
  buffer_store_dword v14, v12, s[8:11], s56 offen sc1
  s_mov_b64 exec, -1
L_pub_47:
  v_exp_f32 v48, v48
  v_exp_f32 v49, v49
  v_exp_f32 v50, v50
  v_exp_f32 v51, v51
  s_waitcnt lgkmcnt(2)
  v_smfmac_f32_32x32x32_bf16 v[80:95], v[28:31], v[72:79], v8
  ds_read_b128 v[28:31], v10 offset:2560
  v_exp_f32 v52, v52
  v_exp_f32 v53, v53
  v_exp_f32 v54, v54
  v_exp_f32 v55, v55
  v_mfma_f32_32x32x16_bf16 v[64:79], v[20:23], v[4:7], v[32:47]
  ds_read_b128 v[20:23], v9 offset:29696
  v_exp_f32 v56, v56
  v_exp_f32 v57, v57
  v_exp_f32 v58, v58
  v_exp_f32 v59, v59
  s_waitcnt lgkmcnt(2)
  v_smfmac_f32_32x32x32_bf16 v[80:95], v[24:27], v[48:55], v8
  ds_read_b128 v[24:27], v10 offset:3072
  v_exp_f32 v60, v60
  v_exp_f32 v61, v61
  v_exp_f32 v62, v62
  v_exp_f32 v63, v63
  buffer_load_dwordx4 v[176:179], v2, s[8:11], s96 offen offset:0 sc1
  v_exp_f32 v64, v64
  v_exp_f32 v65, v65
  v_exp_f32 v66, v66
  v_exp_f32 v67, v67
  s_waitcnt lgkmcnt(2)
  v_smfmac_f32_32x32x32_bf16 v[80:95], v[28:31], v[56:63], v8
  ds_read_b128 v[28:31], v10 offset:3584
  v_exp_f32 v68, v68
  v_exp_f32 v69, v69
  v_exp_f32 v70, v70
  v_exp_f32 v71, v71
  v_mfma_f32_32x32x16_bf16 v[48:63], v[16:19], v[4:7], v[32:47]
  ds_read_b128 v[16:19], v9 offset:30720
  v_exp_f32 v72, v72
  v_exp_f32 v73, v73
  v_exp_f32 v74, v74
  v_exp_f32 v75, v75
  s_waitcnt lgkmcnt(2)
  v_smfmac_f32_32x32x32_bf16 v[80:95], v[24:27], v[64:71], v8
  ds_read_b128 v[24:27], v10 offset:4096
  v_exp_f32 v76, v76
  v_exp_f32 v77, v77
  v_exp_f32 v78, v78
  v_exp_f32 v79, v79
  buffer_load_dwordx4 v[180:183], v2, s[8:11], s96 offen offset:1024 sc1
  v_exp_f32 v48, v48
  v_exp_f32 v49, v49
  v_exp_f32 v50, v50
  v_exp_f32 v51, v51
  s_waitcnt lgkmcnt(2)
  v_smfmac_f32_32x32x32_bf16 v[80:95], v[28:31], v[72:79], v8
  ds_read_b128 v[28:31], v10 offset:4608
  v_exp_f32 v52, v52
  v_exp_f32 v53, v53
  v_exp_f32 v54, v54
  v_exp_f32 v55, v55
  v_mfma_f32_32x32x16_bf16 v[64:79], v[20:23], v[4:7], v[32:47]
  ds_read_b128 v[20:23], v9 offset:31744
  v_exp_f32 v56, v56
  v_exp_f32 v57, v57
  v_exp_f32 v58, v58
  v_exp_f32 v59, v59
  s_waitcnt lgkmcnt(2)
  v_smfmac_f32_32x32x32_bf16 v[80:95], v[24:27], v[48:55], v8
  ds_read_b128 v[24:27], v10 offset:5120
  v_exp_f32 v60, v60
  v_exp_f32 v61, v61
  v_exp_f32 v62, v62
  v_exp_f32 v63, v63
  buffer_load_dwordx4 v[184:187], v2, s[8:11], s96 offen offset:2048 sc1
  s_mov_b32 s59, 16384
L_lw_48:
  v_mov_b32 v0, 161484
  ds_read_b32 v0, v0
  s_waitcnt lgkmcnt(0)
  v_readfirstlane_b32 s61, v0
  s_nop 0
  s_cmp_ge_u32 s61, 4
  s_cbranch_scc0 L_lw_48_r
L_lw_48_ok:
  v_exp_f32 v64, v64
  v_exp_f32 v65, v65
  v_exp_f32 v66, v66
  v_exp_f32 v67, v67
  s_waitcnt lgkmcnt(2)
  v_smfmac_f32_32x32x32_bf16 v[80:95], v[28:31], v[56:63], v8
  ds_read_b128 v[28:31], v10 offset:5632
  v_exp_f32 v68, v68
  v_exp_f32 v69, v69
  v_exp_f32 v70, v70
  v_exp_f32 v71, v71
  v_mfma_f32_32x32x16_bf16 v[48:63], v[16:19], v[4:7], v[32:47]
  v_add_u32 v9, 65536, v9
  ds_read_b128 v[16:19], v9 offset:0
  v_exp_f32 v72, v72
  v_exp_f32 v73, v73
  v_exp_f32 v74, v74
  v_exp_f32 v75, v75
  s_waitcnt lgkmcnt(2)
  v_smfmac_f32_32x32x32_bf16 v[80:95], v[24:27], v[64:71], v8
  ds_read_b128 v[24:27], v10 offset:6144
  v_exp_f32 v76, v76
  v_exp_f32 v77, v77
  v_exp_f32 v78, v78
  v_exp_f32 v79, v79
  buffer_load_dwordx4 v[188:191], v2, s[8:11], s96 offen offset:3072 sc1
  s_add_u32 s96, s96, 4096
  v_exp_f32 v48, v48
  v_exp_f32 v49, v49
  v_exp_f32 v50, v50
  v_exp_f32 v51, v51
  s_waitcnt lgkmcnt(2)
  v_smfmac_f32_32x32x32_bf16 v[80:95], v[28:31], v[72:79], v8
  ds_read_b128 v[28:31], v10 offset:6656
  v_exp_f32 v52, v52
  v_exp_f32 v53, v53
  v_exp_f32 v54, v54
  v_exp_f32 v55, v55
  v_mfma_f32_32x32x16_bf16 v[64:79], v[20:23], v[4:7], v[32:47]
  ds_read_b128 v[20:23], v9 offset:1024
  v_exp_f32 v56, v56
  v_exp_f32 v57, v57
  v_exp_f32 v58, v58
  v_exp_f32 v59, v59
  s_waitcnt lgkmcnt(2)
  v_smfmac_f32_32x32x32_bf16 v[80:95], v[24:27], v[48:55], v8
  ds_read_b128 v[24:27], v10 offset:7168
  v_exp_f32 v60, v60
  v_exp_f32 v61, v61
  v_exp_f32 v62, v62
  v_exp_f32 v63, v63
  buffer_load_dwordx4 v[192:195], v2, s[8:11], s96 offen offset:0 sc1
  v_exp_f32 v64, v64
  v_exp_f32 v65, v65
  v_exp_f32 v66, v66
  v_exp_f32 v67, v67
  s_waitcnt lgkmcnt(2)
  v_smfmac_f32_32x32x32_bf16 v[80:95], v[28:31], v[56:63], v8
  ds_read_b128 v[28:31], v10 offset:7680
  v_mad_u32_u24 v10, v11, 5, v10
  v_exp_f32 v68, v68
  v_exp_f32 v69, v69
  v_exp_f32 v70, v70
  v_exp_f32 v71, v71
  v_mfma_f32_32x32x16_bf16 v[48:63], v[16:19], v[4:7], v[32:47]
  ds_read_b128 v[16:19], v9 offset:2048
  v_exp_f32 v72, v72
  v_exp_f32 v73, v73
  v_exp_f32 v74, v74
  v_exp_f32 v75, v75
  s_waitcnt lgkmcnt(2)
  v_smfmac_f32_32x32x32_bf16 v[80:95], v[24:27], v[64:71], v8
  ds_read_b128 v[24:27], v10 offset:0
  v_exp_f32 v76, v76
  v_exp_f32 v77, v77
  v_exp_f32 v78, v78
  v_exp_f32 v79, v79
  buffer_load_dwordx4 v[196:199], v2, s[8:11], s96 offen offset:1024 sc1
  v_exp_f32 v48, v48
  v_exp_f32 v49, v49
  v_exp_f32 v50, v50
  v_exp_f32 v51, v51
  s_waitcnt lgkmcnt(2)
  v_smfmac_f32_32x32x32_bf16 v[80:95], v[28:31], v[72:79], v8
  ds_read_b128 v[28:31], v10 offset:512
  v_exp_f32 v52, v52
  v_exp_f32 v53, v53
  v_exp_f32 v54, v54
  v_exp_f32 v55, v55
  v_mfma_f32_32x32x16_bf16 v[64:79], v[20:23], v[4:7], v[32:47]
  ds_read_b128 v[20:23], v9 offset:3072
  v_exp_f32 v56, v56
  v_exp_f32 v57, v57
  v_exp_f32 v58, v58
  v_exp_f32 v59, v59
  s_waitcnt lgkmcnt(2)
  v_smfmac_f32_32x32x32_bf16 v[80:95], v[24:27], v[48:55], v8
  ds_read_b128 v[24:27], v10 offset:1024
  v_exp_f32 v60, v60
  v_exp_f32 v61, v61
  v_exp_f32 v62, v62
  v_exp_f32 v63, v63
  buffer_load_dwordx4 v[200:203], v2, s[8:11], s96 offen offset:2048 sc1
  v_exp_f32 v64, v64
  v_exp_f32 v65, v65
  v_exp_f32 v66, v66
  v_exp_f32 v67, v67
  s_waitcnt lgkmcnt(2)
  v_smfmac_f32_32x32x32_bf16 v[80:95], v[28:31], v[56:63], v8
  ds_read_b128 v[28:31], v10 offset:1536
  v_exp_f32 v68, v68
  v_exp_f32 v69, v69
  v_exp_f32 v70, v70
  v_exp_f32 v71, v71
  v_mfma_f32_32x32x16_bf16 v[48:63], v[16:19], v[4:7], v[32:47]
  ds_read_b128 v[16:19], v9 offset:4096
  v_exp_f32 v72, v72
  v_exp_f32 v73, v73
  v_exp_f32 v74, v74
  v_exp_f32 v75, v75
  s_waitcnt lgkmcnt(2)
  v_smfmac_f32_32x32x32_bf16 v[80:95], v[24:27], v[64:71], v8
  ds_read_b128 v[24:27], v10 offset:2048
  v_exp_f32 v76, v76
  v_exp_f32 v77, v77
  v_exp_f32 v78, v78
  v_exp_f32 v79, v79
  buffer_load_dwordx4 v[204:207], v2, s[8:11], s96 offen offset:3072 sc1
  s_add_u32 s96, s96, 4096
  v_mov_b32 v0, 161488
  s_mov_b64 exec, 2
  ds_add_u32 v0, v1
  s_mov_b64 exec, -1
  v_exp_f32 v48, v48
  v_exp_f32 v49, v49
  v_exp_f32 v50, v50
  v_exp_f32 v51, v51
  s_waitcnt lgkmcnt(2)
  v_smfmac_f32_32x32x32_bf16 v[80:95], v[28:31], v[72:79], v8
  ds_read_b128 v[28:31], v10 offset:2560
  v_exp_f32 v52, v52
  v_exp_f32 v53, v53
  v_exp_f32 v54, v54
  v_exp_f32 v55, v55
  v_mfma_f32_32x32x16_bf16 v[64:79], v[20:23], v[4:7], v[32:47]
  ds_read_b128 v[20:23], v9 offset:5120
  v_exp_f32 v56, v56
  v_exp_f32 v57, v57
  v_exp_f32 v58, v58
  v_exp_f32 v59, v59
  s_waitcnt lgkmcnt(2)
  v_smfmac_f32_32x32x32_bf16 v[80:95], v[24:27], v[48:55], v8
  ds_read_b128 v[24:27], v10 offset:3072
  v_exp_f32 v60, v60
  v_exp_f32 v61, v61
  v_exp_f32 v62, v62
  v_exp_f32 v63, v63
  buffer_load_dwordx4 v[208:211], v2, s[8:11], s96 offen offset:0 sc1
  v_exp_f32 v64, v64
  v_exp_f32 v65, v65
  v_exp_f32 v66, v66
  v_exp_f32 v67, v67
  s_waitcnt lgkmcnt(2)
  v_smfmac_f32_32x32x32_bf16 v[80:95], v[28:31], v[56:63], v8
  ds_read_b128 v[28:31], v10 offset:3584
  v_exp_f32 v68, v68
  v_exp_f32 v69, v69
  v_exp_f32 v70, v70
  v_exp_f32 v71, v71
  v_mfma_f32_32x32x16_bf16 v[48:63], v[16:19], v[4:7], v[32:47]
  ds_read_b128 v[16:19], v9 offset:6144
  v_exp_f32 v72, v72
  v_exp_f32 v73, v73
  v_exp_f32 v74, v74
  v_exp_f32 v75, v75
  s_waitcnt lgkmcnt(2)
  v_smfmac_f32_32x32x32_bf16 v[80:95], v[24:27], v[64:71], v8
  ds_read_b128 v[24:27], v10 offset:4096
  v_exp_f32 v76, v76
  v_exp_f32 v77, v77
  v_exp_f32 v78, v78
  v_exp_f32 v79, v79
  buffer_load_dwordx4 v[212:215], v2, s[8:11], s96 offen offset:1024 sc1
  s_cmp_eq_u32 s6, 3
  s_cbranch_scc0 L_p3_49
  s_setprio 0
L_p3_49:
  v_exp_f32 v48, v48
  v_exp_f32 v49, v49
  v_exp_f32 v50, v50
  v_exp_f32 v51, v51
  s_waitcnt lgkmcnt(2)
  v_smfmac_f32_32x32x32_bf16 v[80:95], v[28:31], v[72:79], v8
  ds_read_b128 v[28:31], v10 offset:4608
  v_exp_f32 v52, v52
  v_exp_f32 v53, v53
  v_exp_f32 v54, v54
  v_exp_f32 v55, v55
  v_mfma_f32_32x32x16_bf16 v[64:79], v[20:23], v[4:7], v[32:47]
  ds_read_b128 v[20:23], v9 offset:7168
  v_exp_f32 v56, v56
  v_exp_f32 v57, v57
  v_exp_f32 v58, v58
  v_exp_f32 v59, v59
  s_waitcnt lgkmcnt(2)
  v_smfmac_f32_32x32x32_bf16 v[80:95], v[24:27], v[48:55], v8
  ds_read_b128 v[24:27], v10 offset:5120
  v_exp_f32 v60, v60
  v_exp_f32 v61, v61
  v_exp_f32 v62, v62
  v_exp_f32 v63, v63
  buffer_load_dwordx4 v[216:219], v2, s[8:11], s96 offen offset:2048 sc1
  v_exp_f32 v64, v64
  v_exp_f32 v65, v65
  v_exp_f32 v66, v66
  v_exp_f32 v67, v67
  s_waitcnt lgkmcnt(2)
  v_smfmac_f32_32x32x32_bf16 v[80:95], v[28:31], v[56:63], v8
  ds_read_b128 v[28:31], v10 offset:5632
  v_exp_f32 v68, v68
  v_exp_f32 v69, v69
  v_exp_f32 v70, v70
  v_exp_f32 v71, v71
  v_mfma_f32_32x32x16_bf16 v[48:63], v[16:19], v[4:7], v[32:47]
  ds_read_b128 v[16:19], v9 offset:8192
  v_exp_f32 v72, v72
  v_exp_f32 v73, v73
  v_exp_f32 v74, v74
  v_exp_f32 v75, v75
  s_waitcnt lgkmcnt(2)
  v_smfmac_f32_32x32x32_bf16 v[80:95], v[24:27], v[64:71], v8
  ds_read_b128 v[24:27], v10 offset:6144
  v_exp_f32 v76, v76
  v_exp_f32 v77, v77
  v_exp_f32 v78, v78
  v_exp_f32 v79, v79
  buffer_load_dwordx4 v[220:223], v2, s[8:11], s96 offen offset:3072 sc1
  s_add_u32 s96, s96, 4096
  v_exp_f32 v48, v48
  v_exp_f32 v49, v49
  v_exp_f32 v50, v50
  v_exp_f32 v51, v51
  s_waitcnt lgkmcnt(2)
  v_smfmac_f32_32x32x32_bf16 v[80:95], v[28:31], v[72:79], v8
  ds_read_b128 v[28:31], v10 offset:6656
  v_exp_f32 v52, v52
  v_exp_f32 v53, v53
  v_exp_f32 v54, v54
  v_exp_f32 v55, v55
  v_mfma_f32_32x32x16_bf16 v[64:79], v[20:23], v[4:7], v[32:47]
  ds_read_b128 v[20:23], v9 offset:9216
  v_exp_f32 v56, v56
  v_exp_f32 v57, v57
  v_exp_f32 v58, v58
  v_exp_f32 v59, v59
  s_waitcnt lgkmcnt(2)
  v_smfmac_f32_32x32x32_bf16 v[80:95], v[24:27], v[48:55], v8
  ds_read_b128 v[24:27], v10 offset:7168
  v_exp_f32 v60, v60
  v_exp_f32 v61, v61
  v_exp_f32 v62, v62
  v_exp_f32 v63, v63
  buffer_load_dwordx4 v[224:227], v2, s[8:11], s96 offen offset:0 sc1
  v_exp_f32 v64, v64
  v_exp_f32 v65, v65
  v_exp_f32 v66, v66
  v_exp_f32 v67, v67
  s_waitcnt lgkmcnt(2)
  v_smfmac_f32_32x32x32_bf16 v[80:95], v[28:31], v[56:63], v8
  ds_read_b128 v[28:31], v10 offset:7680
  v_add_u32 v10, v10, v11
  v_exp_f32 v68, v68
  v_exp_f32 v69, v69
  v_exp_f32 v70, v70
  v_exp_f32 v71, v71
  v_mfma_f32_32x32x16_bf16 v[48:63], v[16:19], v[4:7], v[32:47]
  ds_read_b128 v[16:19], v9 offset:10240
  v_exp_f32 v72, v72
  v_exp_f32 v73, v73
  v_exp_f32 v74, v74
  v_exp_f32 v75, v75
  s_waitcnt lgkmcnt(2)
  v_smfmac_f32_32x32x32_bf16 v[80:95], v[24:27], v[64:71], v8
  ds_read_b128 v[24:27], v10 offset:0
  v_exp_f32 v76, v76
  v_exp_f32 v77, v77
  v_exp_f32 v78, v78
  v_exp_f32 v79, v79
  buffer_load_dwordx4 v[228:231], v2, s[8:11], s96 offen offset:1024 sc1
  v_exp_f32 v48, v48
  v_exp_f32 v49, v49
  v_exp_f32 v50, v50
  v_exp_f32 v51, v51
  s_waitcnt lgkmcnt(2)
  v_smfmac_f32_32x32x32_bf16 v[80:95], v[28:31], v[72:79], v8
  ds_read_b128 v[28:31], v10 offset:512
  v_exp_f32 v52, v52
  v_exp_f32 v53, v53
  v_exp_f32 v54, v54
  v_exp_f32 v55, v55
  v_mfma_f32_32x32x16_bf16 v[64:79], v[20:23], v[4:7], v[32:47]
  ds_read_b128 v[20:23], v9 offset:11264
  v_exp_f32 v56, v56
  v_exp_f32 v57, v57
  v_exp_f32 v58, v58
  v_exp_f32 v59, v59
  s_waitcnt lgkmcnt(2)
  v_smfmac_f32_32x32x32_bf16 v[80:95], v[24:27], v[48:55], v8
  ds_read_b128 v[24:27], v10 offset:1024
  v_exp_f32 v60, v60
  v_exp_f32 v61, v61
  v_exp_f32 v62, v62
  v_exp_f32 v63, v63
  buffer_load_dwordx4 v[232:235], v2, s[8:11], s96 offen offset:2048 sc1
  v_exp_f32 v64, v64
  v_exp_f32 v65, v65
  v_exp_f32 v66, v66
  v_exp_f32 v67, v67
  s_waitcnt lgkmcnt(2)
  v_smfmac_f32_32x32x32_bf16 v[80:95], v[28:31], v[56:63], v8
  ds_read_b128 v[28:31], v10 offset:1536
  v_exp_f32 v68, v68
  v_exp_f32 v69, v69
  v_exp_f32 v70, v70
  v_exp_f32 v71, v71
  v_mfma_f32_32x32x16_bf16 v[48:63], v[16:19], v[4:7], v[32:47]
  ds_read_b128 v[16:19], v9 offset:12288
  v_exp_f32 v72, v72
  v_exp_f32 v73, v73
  v_exp_f32 v74, v74
  v_exp_f32 v75, v75
  s_waitcnt lgkmcnt(2)
  v_smfmac_f32_32x32x32_bf16 v[80:95], v[24:27], v[64:71], v8
  ds_read_b128 v[24:27], v10 offset:2048
  v_exp_f32 v76, v76
  v_exp_f32 v77, v77
  v_exp_f32 v78, v78
  v_exp_f32 v79, v79
  buffer_load_dwordx4 v[236:239], v2, s[8:11], s96 offen offset:3072 sc1
  s_add_u32 s96, s96, 4096
  v_exp_f32 v48, v48
  v_exp_f32 v49, v49
  v_exp_f32 v50, v50
  v_exp_f32 v51, v51
  s_waitcnt lgkmcnt(2)
  v_smfmac_f32_32x32x32_bf16 v[80:95], v[28:31], v[72:79], v8
  ds_read_b128 v[28:31], v10 offset:2560
  v_exp_f32 v52, v52
  v_exp_f32 v53, v53
  v_exp_f32 v54, v54
  v_exp_f32 v55, v55
  v_mfma_f32_32x32x16_bf16 v[64:79], v[20:23], v[4:7], v[32:47]
  ds_read_b128 v[20:23], v9 offset:13312
  v_exp_f32 v56, v56
  v_exp_f32 v57, v57
  v_exp_f32 v58, v58
  v_exp_f32 v59, v59
  s_waitcnt lgkmcnt(2)
  v_smfmac_f32_32x32x32_bf16 v[80:95], v[24:27], v[48:55], v8
  ds_read_b128 v[24:27], v10 offset:3072
  v_exp_f32 v60, v60
  v_exp_f32 v61, v61
  v_exp_f32 v62, v62
  v_exp_f32 v63, v63
  buffer_load_dwordx4 v[240:243], v2, s[8:11], s96 offen offset:0 sc1
  s_setprio 0
  v_exp_f32 v64, v64
  v_exp_f32 v65, v65
  v_exp_f32 v66, v66
  v_exp_f32 v67, v67
  s_waitcnt lgkmcnt(2)
  v_smfmac_f32_32x32x32_bf16 v[80:95], v[28:31], v[56:63], v8
  ds_read_b128 v[28:31], v10 offset:3584
  v_exp_f32 v68, v68
  v_exp_f32 v69, v69
  v_exp_f32 v70, v70
  v_exp_f32 v71, v71
  v_mfma_f32_32x32x16_bf16 v[48:63], v[16:19], v[4:7], v[32:47]
  ds_read_b128 v[16:19], v9 offset:14336
  v_exp_f32 v72, v72
  v_exp_f32 v73, v73
  v_exp_f32 v74, v74
  v_exp_f32 v75, v75
  s_waitcnt lgkmcnt(2)
  v_smfmac_f32_32x32x32_bf16 v[80:95], v[24:27], v[64:71], v8
  ds_read_b128 v[24:27], v10 offset:4096
  v_exp_f32 v76, v76
  v_exp_f32 v77, v77
  v_exp_f32 v78, v78
  v_exp_f32 v79, v79
  buffer_load_dwordx4 v[244:247], v2, s[8:11], s96 offen offset:1024 sc1
  buffer_load_dwordx4 v[248:251], v2, s[8:11], s96 offen offset:2048 sc1
  v_exp_f32 v48, v48
  v_exp_f32 v49, v49
  v_exp_f32 v50, v50
  v_exp_f32 v51, v51
  s_waitcnt lgkmcnt(2)
  v_smfmac_f32_32x32x32_bf16 v[80:95], v[28:31], v[72:79], v8
  ds_read_b128 v[28:31], v10 offset:4608
  v_exp_f32 v52, v52
  v_exp_f32 v53, v53
  v_exp_f32 v54, v54
  v_exp_f32 v55, v55
  v_mfma_f32_32x32x16_bf16 v[64:79], v[20:23], v[4:7], v[32:47]
  ds_read_b128 v[20:23], v9 offset:15360
  v_exp_f32 v56, v56
  v_exp_f32 v57, v57
  v_exp_f32 v58, v58
  v_exp_f32 v59, v59
  s_waitcnt lgkmcnt(2)
  v_smfmac_f32_32x32x32_bf16 v[80:95], v[24:27], v[48:55], v8
  ds_read_b128 v[24:27], v10 offset:5120
  v_exp_f32 v60, v60
  v_exp_f32 v61, v61
  v_exp_f32 v62, v62
  v_exp_f32 v63, v63
  buffer_load_dwordx4 v[252:255], v2, s[8:11], s96 offen offset:3072 sc1
  s_add_u32 s96, s96, 4096
  v_exp_f32 v64, v64
  v_exp_f32 v65, v65
  v_exp_f32 v66, v66
  v_exp_f32 v67, v67
  s_waitcnt lgkmcnt(2)
  v_smfmac_f32_32x32x32_bf16 v[80:95], v[28:31], v[56:63], v8
  ds_read_b128 v[28:31], v10 offset:5632
  v_exp_f32 v68, v68
  v_exp_f32 v69, v69
  v_exp_f32 v70, v70
  v_exp_f32 v71, v71
  v_mfma_f32_32x32x16_bf16 v[48:63], v[16:19], v[4:7], v[32:47]
  ds_read_b128 v[16:19], v9 offset:16384
  v_exp_f32 v72, v72
  v_exp_f32 v73, v73
  v_exp_f32 v74, v74
  v_exp_f32 v75, v75
  s_waitcnt lgkmcnt(2)
  v_smfmac_f32_32x32x32_bf16 v[80:95], v[24:27], v[64:71], v8
  ds_read_b128 v[24:27], v10 offset:6144
  v_exp_f32 v76, v76
  v_exp_f32 v77, v77
  v_exp_f32 v78, v78
  v_exp_f32 v79, v79
  s_add_u32 s56, s97, 0
  buffer_load_dwordx4 v[96:99], v2, s[8:11], s56 offen offset:0 sc1
  s_add_u32 s56, s97, 0
  buffer_load_dwordx4 v[100:103], v2, s[8:11], s56 offen offset:1024 sc1
  v_exp_f32 v48, v48
  v_exp_f32 v49, v49
  v_exp_f32 v50, v50
  v_exp_f32 v51, v51
  s_waitcnt lgkmcnt(2)
  v_smfmac_f32_32x32x32_bf16 v[80:95], v[28:31], v[72:79], v8
  ds_read_b128 v[28:31], v10 offset:6656
  v_exp_f32 v52, v52
  v_exp_f32 v53, v53
  v_exp_f32 v54, v54
  v_exp_f32 v55, v55
  v_mfma_f32_32x32x16_bf16 v[64:79], v[20:23], v[4:7], v[32:47]
  ds_read_b128 v[20:23], v9 offset:17408
  v_exp_f32 v56, v56
  v_exp_f32 v57, v57
  v_exp_f32 v58, v58
  v_exp_f32 v59, v59
  s_waitcnt lgkmcnt(2)
  v_smfmac_f32_32x32x32_bf16 v[80:95], v[24:27], v[48:55], v8
  ds_read_b128 v[24:27], v10 offset:7168
  v_exp_f32 v60, v60
  v_exp_f32 v61, v61
  v_exp_f32 v62, v62
  v_exp_f32 v63, v63
  s_add_u32 s56, s97, 0
  buffer_load_dwordx4 v[104:107], v2, s[8:11], s56 offen offset:2048 sc1
  s_add_u32 s56, s97, 0
  buffer_load_dwordx4 v[108:111], v2, s[8:11], s56 offen offset:3072 sc1
  v_exp_f32 v64, v64
  v_exp_f32 v65, v65
  v_exp_f32 v66, v66
  v_exp_f32 v67, v67
  s_waitcnt lgkmcnt(2)
  v_smfmac_f32_32x32x32_bf16 v[80:95], v[28:31], v[56:63], v8
  ds_read_b128 v[28:31], v10 offset:7680
  v_add_u32 v10, v10, v11
  v_exp_f32 v68, v68
  v_exp_f32 v69, v69
  v_exp_f32 v70, v70
  v_exp_f32 v71, v71
  v_mfma_f32_32x32x16_bf16 v[48:63], v[16:19], v[4:7], v[32:47]
  ds_read_b128 v[16:19], v9 offset:18432
  v_exp_f32 v72, v72
  v_exp_f32 v73, v73
  v_exp_f32 v74, v74
  v_exp_f32 v75, v75
  s_waitcnt lgkmcnt(2)
  v_smfmac_f32_32x32x32_bf16 v[80:95], v[24:27], v[64:71], v8
  ds_read_b128 v[24:27], v10 offset:0
  v_exp_f32 v76, v76
  v_exp_f32 v77, v77
  v_exp_f32 v78, v78
  v_exp_f32 v79, v79
  s_add_u32 s56, s97, 4096
  buffer_load_dwordx4 v[112:115], v2, s[8:11], s56 offen offset:0 sc1
  s_add_u32 s56, s97, 4096
  buffer_load_dwordx4 v[116:119], v2, s[8:11], s56 offen offset:1024 sc1
  v_exp_f32 v48, v48
  v_exp_f32 v49, v49
  v_exp_f32 v50, v50
  v_exp_f32 v51, v51
  s_waitcnt lgkmcnt(2)
  v_smfmac_f32_32x32x32_bf16 v[80:95], v[28:31], v[72:79], v8
  ds_read_b128 v[28:31], v10 offset:512
  v_exp_f32 v52, v52
  v_exp_f32 v53, v53
  v_exp_f32 v54, v54
  v_exp_f32 v55, v55
  v_mfma_f32_32x32x16_bf16 v[64:79], v[20:23], v[4:7], v[32:47]
  ds_read_b128 v[20:23], v9 offset:19456
  v_exp_f32 v56, v56
  v_exp_f32 v57, v57
  v_exp_f32 v58, v58
  v_exp_f32 v59, v59
  s_waitcnt lgkmcnt(2)
  v_smfmac_f32_32x32x32_bf16 v[80:95], v[24:27], v[48:55], v8
  ds_read_b128 v[24:27], v10 offset:1024
  v_exp_f32 v60, v60
  v_exp_f32 v61, v61
  v_exp_f32 v62, v62
  v_exp_f32 v63, v63
  s_add_u32 s56, s97, 4096
  buffer_load_dwordx4 v[120:123], v2, s[8:11], s56 offen offset:2048 sc1
  s_add_u32 s56, s97, 4096
  buffer_load_dwordx4 v[124:127], v2, s[8:11], s56 offen offset:3072 sc1
  v_exp_f32 v64, v64
  v_exp_f32 v65, v65
  v_exp_f32 v66, v66
  v_exp_f32 v67, v67
  s_waitcnt lgkmcnt(2)
  v_smfmac_f32_32x32x32_bf16 v[80:95], v[28:31], v[56:63], v8
  ds_read_b128 v[28:31], v10 offset:1536
  v_exp_f32 v68, v68
  v_exp_f32 v69, v69
  v_exp_f32 v70, v70
  v_exp_f32 v71, v71
  v_mfma_f32_32x32x16_bf16 v[48:63], v[16:19], v[4:7], v[32:47]
  ds_read_b128 v[16:19], v9 offset:20480
  v_exp_f32 v72, v72
  v_exp_f32 v73, v73
  v_exp_f32 v74, v74
  v_exp_f32 v75, v75
  s_waitcnt lgkmcnt(2)
  v_smfmac_f32_32x32x32_bf16 v[80:95], v[24:27], v[64:71], v8
  ds_read_b128 v[24:27], v10 offset:2048
  v_exp_f32 v76, v76
  v_exp_f32 v77, v77
  v_exp_f32 v78, v78
  v_exp_f32 v79, v79
  s_add_u32 s56, s97, 125952
  s_lshl_b32 s57, s6, 10
  s_add_u32 m0, s57, 139264
  s_nop 0
  buffer_load_dwordx4 v2, s[8:11], s56 offen sc1 lds
  s_add_u32 s56, s97, 126976
  s_lshl_b32 s57, s6, 10
  s_add_u32 m0, s57, 147456
  s_nop 0
  buffer_load_dwordx4 v2, s[8:11], s56 offen sc1 lds
  v_exp_f32 v48, v48
  v_exp_f32 v49, v49
  v_exp_f32 v50, v50
  v_exp_f32 v51, v51
  s_waitcnt lgkmcnt(2)
  v_smfmac_f32_32x32x32_bf16 v[80:95], v[28:31], v[72:79], v8
  ds_read_b128 v[28:31], v10 offset:2560
  v_exp_f32 v52, v52
  v_exp_f32 v53, v53
  v_exp_f32 v54, v54
  v_exp_f32 v55, v55
  v_mfma_f32_32x32x16_bf16 v[64:79], v[20:23], v[4:7], v[32:47]
  ds_read_b128 v[20:23], v9 offset:21504
  v_exp_f32 v56, v56
  v_exp_f32 v57, v57
  v_exp_f32 v58, v58
  v_exp_f32 v59, v59
  s_waitcnt lgkmcnt(2)
  v_smfmac_f32_32x32x32_bf16 v[80:95], v[24:27], v[48:55], v8
  ds_read_b128 v[24:27], v10 offset:3072
  v_exp_f32 v60, v60
  v_exp_f32 v61, v61
  v_exp_f32 v62, v62
  v_exp_f32 v63, v63
  v_and_b32 v12, 31, v1
  v_lshrrev_b32 v13, 5, v1
  s_lshl_b32 s56, s4, 6
  s_lshl_b32 s57, s26, 5
  s_add_u32 s56, s56, s57
  v_add_u32 v3, s56, v12
  v_lshlrev_b32 v3, 10, v3
  v_lshl_add_u32 v3, v13, 3, v3
  s_lshl_b32 s56, s5, 7
  s_lshl_b32 s57, s24, 6
  s_add_u32 s56, s56, s57
  s_lshl_b32 s57, s25, 5
  s_add_u32 s92, s56, s57
  buffer_load_dwordx2 v[12:13], v3, s[12:15], s92 offen
  buffer_load_dwordx2 v[14:15], v3, s[12:15], s92 offen offset:16
  v_exp_f32 v64, v64
  v_exp_f32 v65, v65
  v_exp_f32 v66, v66
  v_exp_f32 v67, v67
  s_waitcnt lgkmcnt(2)
  v_smfmac_f32_32x32x32_bf16 v[80:95], v[28:31], v[56:63], v8
  ds_read_b128 v[28:31], v10 offset:3584
  v_exp_f32 v68, v68
  v_exp_f32 v69, v69
  v_exp_f32 v70, v70
  v_exp_f32 v71, v71
  v_mfma_f32_32x32x16_bf16 v[48:63], v[16:19], v[4:7], v[32:47]
  ds_read_b128 v[16:19], v9 offset:22528
  v_exp_f32 v72, v72
  v_exp_f32 v73, v73
  v_exp_f32 v74, v74
  v_exp_f32 v75, v75
  s_waitcnt lgkmcnt(2)
  v_smfmac_f32_32x32x32_bf16 v[80:95], v[24:27], v[64:71], v8
  ds_read_b128 v[24:27], v10 offset:4096
  v_exp_f32 v76, v76
  v_exp_f32 v77, v77
  v_exp_f32 v78, v78
  v_exp_f32 v79, v79
  v_exp_f32 v48, v48
  v_exp_f32 v49, v49
  v_exp_f32 v50, v50
  v_exp_f32 v51, v51
  s_waitcnt lgkmcnt(2)
  v_smfmac_f32_32x32x32_bf16 v[80:95], v[28:31], v[72:79], v8
  ds_read_b128 v[28:31], v10 offset:4608
  v_exp_f32 v52, v52
  v_exp_f32 v53, v53
  v_exp_f32 v54, v54
  v_exp_f32 v55, v55
  v_mfma_f32_32x32x16_bf16 v[64:79], v[20:23], v[4:7], v[32:47]
  ds_read_b128 v[20:23], v9 offset:23552
  v_exp_f32 v56, v56
  v_exp_f32 v57, v57
  v_exp_f32 v58, v58
  v_exp_f32 v59, v59
  s_waitcnt lgkmcnt(2)
  v_smfmac_f32_32x32x32_bf16 v[80:95], v[24:27], v[48:55], v8
  ds_read_b128 v[24:27], v10 offset:5120
  v_exp_f32 v60, v60
  v_exp_f32 v61, v61
  v_exp_f32 v62, v62
  v_exp_f32 v63, v63
  v_exp_f32 v64, v64
  v_exp_f32 v65, v65
  v_exp_f32 v66, v66
  v_exp_f32 v67, v67
  s_waitcnt lgkmcnt(2)
  v_smfmac_f32_32x32x32_bf16 v[80:95], v[28:31], v[56:63], v8
  ds_read_b128 v[28:31], v10 offset:5632
  v_exp_f32 v68, v68
  v_exp_f32 v69, v69
  v_exp_f32 v70, v70
  v_exp_f32 v71, v71
  v_mfma_f32_32x32x16_bf16 v[48:63], v[16:19], v[4:7], v[32:47]
  ds_read_b128 v[16:19], v9 offset:24576
  v_exp_f32 v72, v72
  v_exp_f32 v73, v73
  v_exp_f32 v74, v74
  v_exp_f32 v75, v75
  s_waitcnt lgkmcnt(2)
  v_smfmac_f32_32x32x32_bf16 v[80:95], v[24:27], v[64:71], v8
  ds_read_b128 v[24:27], v10 offset:6144
  v_exp_f32 v76, v76
  v_exp_f32 v77, v77
  v_exp_f32 v78, v78
  v_exp_f32 v79, v79
  v_exp_f32 v48, v48
  v_exp_f32 v49, v49
  v_exp_f32 v50, v50
  v_exp_f32 v51, v51
  s_waitcnt lgkmcnt(2)
  v_smfmac_f32_32x32x32_bf16 v[80:95], v[28:31], v[72:79], v8
  ds_read_b128 v[28:31], v10 offset:6656
  v_exp_f32 v52, v52
  v_exp_f32 v53, v53
  v_exp_f32 v54, v54
  v_exp_f32 v55, v55
  v_mfma_f32_32x32x16_bf16 v[64:79], v[20:23], v[4:7], v[32:47]
  ds_read_b128 v[20:23], v9 offset:25600
  v_exp_f32 v56, v56
  v_exp_f32 v57, v57
  v_exp_f32 v58, v58
  v_exp_f32 v59, v59
  s_waitcnt lgkmcnt(2)
  v_smfmac_f32_32x32x32_bf16 v[80:95], v[24:27], v[48:55], v8
  ds_read_b128 v[24:27], v10 offset:7168
  v_exp_f32 v60, v60
  v_exp_f32 v61, v61
  v_exp_f32 v62, v62
  v_exp_f32 v63, v63
  v_exp_f32 v64, v64
  v_exp_f32 v65, v65
  v_exp_f32 v66, v66
  v_exp_f32 v67, v67
  s_waitcnt lgkmcnt(2)
  v_smfmac_f32_32x32x32_bf16 v[80:95], v[28:31], v[56:63], v8
  ds_read_b128 v[28:31], v10 offset:7680
  v_add_u32 v10, v10, v11
  v_exp_f32 v68, v68
  v_exp_f32 v69, v69
  v_exp_f32 v70, v70
  v_exp_f32 v71, v71
  v_mfma_f32_32x32x16_bf16 v[48:63], v[16:19], v[4:7], v[32:47]
  ds_read_b128 v[16:19], v9 offset:26624
  v_exp_f32 v72, v72
  v_exp_f32 v73, v73
  v_exp_f32 v74, v74
  v_exp_f32 v75, v75
  s_waitcnt lgkmcnt(2)
  v_smfmac_f32_32x32x32_bf16 v[80:95], v[24:27], v[64:71], v8
  ds_read_b128 v[24:27], v10 offset:0
  v_exp_f32 v76, v76
  v_exp_f32 v77, v77
  v_exp_f32 v78, v78
  v_exp_f32 v79, v79
  v_exp_f32 v48, v48
  v_exp_f32 v49, v49
  v_exp_f32 v50, v50
  v_exp_f32 v51, v51
  s_waitcnt lgkmcnt(2)
  v_smfmac_f32_32x32x32_bf16 v[80:95], v[28:31], v[72:79], v8
  ds_read_b128 v[28:31], v10 offset:512
  v_exp_f32 v52, v52
  v_exp_f32 v53, v53
  v_exp_f32 v54, v54
  v_exp_f32 v55, v55
  v_mfma_f32_32x32x16_bf16 v[64:79], v[20:23], v[4:7], v[32:47]
  ds_read_b128 v[20:23], v9 offset:27648
  v_exp_f32 v56, v56
  v_exp_f32 v57, v57
  v_exp_f32 v58, v58
  v_exp_f32 v59, v59
  s_waitcnt lgkmcnt(2)
  v_smfmac_f32_32x32x32_bf16 v[80:95], v[24:27], v[48:55], v8
  ds_read_b128 v[24:27], v10 offset:1024
  v_exp_f32 v60, v60
  v_exp_f32 v61, v61
  v_exp_f32 v62, v62
  v_exp_f32 v63, v63
  v_exp_f32 v64, v64
  v_exp_f32 v65, v65
  v_exp_f32 v66, v66
  v_exp_f32 v67, v67
  s_waitcnt lgkmcnt(2)
  v_smfmac_f32_32x32x32_bf16 v[80:95], v[28:31], v[56:63], v8
  ds_read_b128 v[28:31], v10 offset:1536
  v_exp_f32 v68, v68
  v_exp_f32 v69, v69
  v_exp_f32 v70, v70
  v_exp_f32 v71, v71
  v_mfma_f32_32x32x16_bf16 v[48:63], v[16:19], v[4:7], v[32:47]
  ds_read_b128 v[16:19], v9 offset:28672
  v_exp_f32 v72, v72
  v_exp_f32 v73, v73
  v_exp_f32 v74, v74
  v_exp_f32 v75, v75
  s_waitcnt lgkmcnt(2)
  v_smfmac_f32_32x32x32_bf16 v[80:95], v[24:27], v[64:71], v8
  ds_read_b128 v[24:27], v10 offset:2048
  v_exp_f32 v76, v76
  v_exp_f32 v77, v77
  v_exp_f32 v78, v78
  v_exp_f32 v79, v79
  v_exp_f32 v48, v48
  v_exp_f32 v49, v49
  v_exp_f32 v50, v50
  v_exp_f32 v51, v51
  s_waitcnt lgkmcnt(2)
  v_smfmac_f32_32x32x32_bf16 v[80:95], v[28:31], v[72:79], v8
  ds_read_b128 v[28:31], v10 offset:2560
  v_exp_f32 v52, v52
  v_exp_f32 v53, v53
  v_exp_f32 v54, v54
  v_exp_f32 v55, v55
  v_mfma_f32_32x32x16_bf16 v[64:79], v[20:23], v[4:7], v[32:47]
  ds_read_b128 v[20:23], v9 offset:29696
  v_exp_f32 v56, v56
  v_exp_f32 v57, v57
  v_exp_f32 v58, v58
  v_exp_f32 v59, v59
  s_waitcnt lgkmcnt(2)
  v_smfmac_f32_32x32x32_bf16 v[80:95], v[24:27], v[48:55], v8
  ds_read_b128 v[24:27], v10 offset:3072
  v_exp_f32 v60, v60
  v_exp_f32 v61, v61
  v_exp_f32 v62, v62
  v_exp_f32 v63, v63
  v_exp_f32 v64, v64
  v_exp_f32 v65, v65
  v_exp_f32 v66, v66
  v_exp_f32 v67, v67
  s_waitcnt lgkmcnt(2)
  v_smfmac_f32_32x32x32_bf16 v[80:95], v[28:31], v[56:63], v8
  ds_read_b128 v[28:31], v10 offset:3584
  v_exp_f32 v68, v68
  v_exp_f32 v69, v69
  v_exp_f32 v70, v70
  v_exp_f32 v71, v71
  v_mfma_f32_32x32x16_bf16 v[48:63], v[16:19], v[4:7], v[32:47]
  ds_read_b128 v[16:19], v9 offset:30720
  v_exp_f32 v72, v72
  v_exp_f32 v73, v73
  v_exp_f32 v74, v74
  v_exp_f32 v75, v75
  s_waitcnt lgkmcnt(2)
  v_smfmac_f32_32x32x32_bf16 v[80:95], v[24:27], v[64:71], v8
  ds_read_b128 v[24:27], v10 offset:4096
  v_exp_f32 v76, v76
  v_exp_f32 v77, v77
  v_exp_f32 v78, v78
  v_exp_f32 v79, v79
  v_exp_f32 v48, v48
  v_exp_f32 v49, v49
  v_exp_f32 v50, v50
  v_exp_f32 v51, v51
  s_waitcnt lgkmcnt(2)
  v_smfmac_f32_32x32x32_bf16 v[80:95], v[28:31], v[72:79], v8
  ds_read_b128 v[28:31], v10 offset:4608
  v_exp_f32 v52, v52
  v_exp_f32 v53, v53
  v_exp_f32 v54, v54
  v_exp_f32 v55, v55
  v_mfma_f32_32x32x16_bf16 v[64:79], v[20:23], v[4:7], v[32:47]
  ds_read_b128 v[20:23], v9 offset:31744
  v_exp_f32 v56, v56
  v_exp_f32 v57, v57
  v_exp_f32 v58, v58
  v_exp_f32 v59, v59
  s_waitcnt lgkmcnt(2)
  v_smfmac_f32_32x32x32_bf16 v[80:95], v[24:27], v[48:55], v8
  ds_read_b128 v[24:27], v10 offset:5120
  v_exp_f32 v60, v60
  v_exp_f32 v61, v61
  v_exp_f32 v62, v62
  v_exp_f32 v63, v63
  v_exp_f32 v64, v64
  v_exp_f32 v65, v65
  v_exp_f32 v66, v66
  v_exp_f32 v67, v67
  s_waitcnt lgkmcnt(2)
  v_smfmac_f32_32x32x32_bf16 v[80:95], v[28:31], v[56:63], v8
  ds_read_b128 v[28:31], v10 offset:5632
  v_exp_f32 v68, v68
  v_exp_f32 v69, v69
  v_exp_f32 v70, v70
  v_exp_f32 v71, v71
  v_mfma_f32_32x32x16_bf16 v[48:63], v[16:19], v[4:7], v[32:47]
  v_exp_f32 v72, v72
  v_exp_f32 v73, v73
  v_exp_f32 v74, v74
  v_exp_f32 v75, v75
  s_waitcnt lgkmcnt(1)
  v_smfmac_f32_32x32x32_bf16 v[80:95], v[24:27], v[64:71], v8
  ds_read_b128 v[24:27], v10 offset:6144
  v_exp_f32 v76, v76
  v_exp_f32 v77, v77
  v_exp_f32 v78, v78
  v_exp_f32 v79, v79
  s_mov_b32 s59, 16384
L_lw_50:
  v_mov_b32 v0, 161508
  ds_read_b32 v0, v0
  s_waitcnt lgkmcnt(0)
  v_readfirstlane_b32 s61, v0
  s_nop 0
  s_cmp_ge_u32 s61, 1
  s_cbranch_scc0 L_lw_50_r
L_lw_50_ok:
  v_exp_f32 v48, v48
  v_exp_f32 v49, v49
  v_exp_f32 v50, v50
  v_exp_f32 v51, v51
  s_waitcnt lgkmcnt(1)
  v_smfmac_f32_32x32x32_bf16 v[80:95], v[28:31], v[72:79], v8
  ds_read_b128 v[28:31], v10 offset:6656
  v_exp_f32 v52, v52
  v_exp_f32 v53, v53
  v_exp_f32 v54, v54
  v_exp_f32 v55, v55
  v_mfma_f32_32x32x16_bf16 v[64:79], v[20:23], v[4:7], v[32:47]
  v_exp_f32 v56, v56
  v_exp_f32 v57, v57
  v_exp_f32 v58, v58
  v_exp_f32 v59, v59
  s_waitcnt lgkmcnt(1)
  v_smfmac_f32_32x32x32_bf16 v[80:95], v[24:27], v[48:55], v8
  ds_read_b128 v[24:27], v10 offset:7168
  v_exp_f32 v60, v60
  v_exp_f32 v61, v61
  v_exp_f32 v62, v62
  v_exp_f32 v63, v63
  s_waitcnt vmcnt(0)
  v_exp_f32 v64, v64
  v_exp_f32 v65, v65
  v_exp_f32 v66, v66
  v_exp_f32 v67, v67
  s_waitcnt lgkmcnt(1)
  v_smfmac_f32_32x32x32_bf16 v[80:95], v[28:31], v[56:63], v8
  ds_read_b128 v[28:31], v10 offset:7680
  v_exp_f32 v68, v68
  v_exp_f32 v69, v69
  v_exp_f32 v70, v70
  v_exp_f32 v71, v71
  v_exp_f32 v72, v72
  v_exp_f32 v73, v73
  v_exp_f32 v74, v74
  v_exp_f32 v75, v75
  s_waitcnt lgkmcnt(1)
  v_smfmac_f32_32x32x32_bf16 v[80:95], v[24:27], v[64:71], v8
  v_exp_f32 v76, v76
  v_exp_f32 v77, v77
  v_exp_f32 v78, v78
  v_exp_f32 v79, v79
  s_setprio 0
  s_waitcnt lgkmcnt(0)
  v_smfmac_f32_32x32x32_bf16 v[80:95], v[28:31], v[72:79], v8
  s_branch L_loop_done
L_loop_B:
  s_setprio 1
  s_waitcnt vmcnt(0)
  v_mov_b32 v12, 161476
  v_mov_b32 v13, 1
  s_mov_b64 exec, 1
  ds_add_rtn_u32 v13, v12, v13
  s_waitcnt lgkmcnt(0)
  v_readfirstlane_b32 s56, v13
  s_mov_b64 exec, -1
  s_cmp_eq_u32 s56, 3
  s_cbranch_scc0 L_pub_51
  s_lshl_b32 s56, s5, 5
  s_add_u32 s56, s56, s4
  s_lshl_b32 s56, s56, 7
  s_add_u32 s56, s56, 22020096
  v_mov_b32 v14, s7
  v_mov_b32 v12, 0
  s_mov_b64 exec, 1
  buffer_store_dword v14, v12, s[8:11], s56 offen sc1
  s_mov_b64 exec, -1
L_pub_51:
  s_waitcnt lgkmcnt(2)
  v_mfma_f32_32x32x16_bf16 v[48:63], v[16:19], v[4:7], v[32:47]
  ds_read_b128 v[16:19], v9 offset:2048
  s_nop 10
  v_exp_f32 v48, v48
  v_exp_f32 v49, v49
  v_exp_f32 v50, v50
  v_exp_f32 v51, v51
  ds_read_b128 v[28:31], v10 offset:512
  v_exp_f32 v52, v52
  v_exp_f32 v53, v53
  v_exp_f32 v54, v54
  v_exp_f32 v55, v55
  s_waitcnt lgkmcnt(3)
  v_mfma_f32_32x32x16_bf16 v[64:79], v[20:23], v[4:7], v[32:47]
  ds_read_b128 v[20:23], v9 offset:3072
  v_exp_f32 v56, v56
  v_exp_f32 v57, v57
  v_exp_f32 v58, v58
  v_exp_f32 v59, v59
  s_waitcnt lgkmcnt(3)
  v_smfmac_f32_32x32x32_bf16 v[80:95], v[24:27], v[48:55], v8
  ds_read_b128 v[24:27], v10 offset:1024
  v_exp_f32 v60, v60
  v_exp_f32 v61, v61
  v_exp_f32 v62, v62
  v_exp_f32 v63, v63
  s_and_b32 s56, s6, 3
  s_add_u32 s57, s56, 12
  s_add_u32 s57, s57, s93
  s_and_b32 s57, s57, 15
  s_lshl_b32 s57, s57, 12
  s_add_u32 s94, s57, 65536
  s_lshl_b32 s56, s56, 12
  s_add_u32 s95, s56, 81920
  s_mov_b32 m0, s95
  s_nop 0
  buffer_load_dwordx4 v2, s[8:11], s94 offen offset:0 sc1 lds
  buffer_load_dwordx4 v2, s[8:11], s94 offen offset:1024 sc1 lds
  s_mov_b32 m0, s95
  s_nop 0
  buffer_load_dwordx4 v2, s[8:11], s94 offen offset:2048 sc1 lds
  buffer_load_dwordx4 v2, s[8:11], s94 offen offset:3072 sc1 lds
  v_exp_f32 v64, v64
  v_exp_f32 v65, v65
  v_exp_f32 v66, v66
  v_exp_f32 v67, v67
  s_waitcnt lgkmcnt(2)
  v_smfmac_f32_32x32x32_bf16 v[80:95], v[28:31], v[56:63], v8
  ds_read_b128 v[28:31], v10 offset:1536
  v_exp_f32 v68, v68
  v_exp_f32 v69, v69
  v_exp_f32 v70, v70
  v_exp_f32 v71, v71
  v_mfma_f32_32x32x16_bf16 v[48:63], v[16:19], v[4:7], v[32:47]
  ds_read_b128 v[16:19], v9 offset:4096
  v_exp_f32 v72, v72
  v_exp_f32 v73, v73
  v_exp_f32 v74, v74
  v_exp_f32 v75, v75
  s_waitcnt lgkmcnt(2)
  v_smfmac_f32_32x32x32_bf16 v[80:95], v[24:27], v[64:71], v8
  ds_read_b128 v[24:27], v10 offset:2048
  v_exp_f32 v76, v76
  v_exp_f32 v77, v77
  v_exp_f32 v78, v78
  v_exp_f32 v79, v79
  s_add_u32 m0, s95, 32768
  s_add_u32 s56, s94, 65536
  buffer_load_dwordx4 v2, s[8:11], s56 offen offset:0 sc1 lds
  buffer_load_dwordx4 v2, s[8:11], s56 offen offset:1024 sc1 lds
  s_add_u32 m0, s95, 32768
  s_add_u32 s56, s94, 65536
  buffer_load_dwordx4 v2, s[8:11], s56 offen offset:2048 sc1 lds
  buffer_load_dwordx4 v2, s[8:11], s56 offen offset:3072 sc1 lds
  v_exp_f32 v48, v48
  v_exp_f32 v49, v49
  v_exp_f32 v50, v50
  v_exp_f32 v51, v51
  s_waitcnt lgkmcnt(2)
  v_smfmac_f32_32x32x32_bf16 v[80:95], v[28:31], v[72:79], v8
  ds_read_b128 v[28:31], v10 offset:2560
  v_exp_f32 v52, v52
  v_exp_f32 v53, v53
  v_exp_f32 v54, v54
  v_exp_f32 v55, v55
  v_mfma_f32_32x32x16_bf16 v[64:79], v[20:23], v[4:7], v[32:47]
  ds_read_b128 v[20:23], v9 offset:5120
  v_exp_f32 v56, v56
  v_exp_f32 v57, v57
  v_exp_f32 v58, v58
  v_exp_f32 v59, v59
  s_waitcnt lgkmcnt(2)
  v_smfmac_f32_32x32x32_bf16 v[80:95], v[24:27], v[48:55], v8
  ds_read_b128 v[24:27], v10 offset:3072
  v_exp_f32 v60, v60
  v_exp_f32 v61, v61
  v_exp_f32 v62, v62
  v_exp_f32 v63, v63
  s_cmp_eq_u32 s6, 7
  s_cbranch_scc1 L_w7_52
L_w7b_53:
  v_exp_f32 v64, v64
  v_exp_f32 v65, v65
  v_exp_f32 v66, v66
  v_exp_f32 v67, v67
  s_waitcnt lgkmcnt(2)
  v_smfmac_f32_32x32x32_bf16 v[80:95], v[28:31], v[56:63], v8
  ds_read_b128 v[28:31], v10 offset:3584
  v_exp_f32 v68, v68
  v_exp_f32 v69, v69
  v_exp_f32 v70, v70
  v_exp_f32 v71, v71
  v_mfma_f32_32x32x16_bf16 v[48:63], v[16:19], v[4:7], v[32:47]
  ds_read_b128 v[16:19], v9 offset:6144
  v_exp_f32 v72, v72
  v_exp_f32 v73, v73
  v_exp_f32 v74, v74
  v_exp_f32 v75, v75
  s_waitcnt lgkmcnt(2)
  v_smfmac_f32_32x32x32_bf16 v[80:95], v[24:27], v[64:71], v8
  ds_read_b128 v[24:27], v10 offset:4096
  v_exp_f32 v76, v76
  v_exp_f32 v77, v77
  v_exp_f32 v78, v78
  v_exp_f32 v79, v79
  s_cmp_eq_u32 s6, 7
  s_cbranch_scc1 L_w7_54
L_w7b_55:
  v_exp_f32 v48, v48
  v_exp_f32 v49, v49
  v_exp_f32 v50, v50
  v_exp_f32 v51, v51
  s_waitcnt lgkmcnt(2)
  v_smfmac_f32_32x32x32_bf16 v[80:95], v[28:31], v[72:79], v8
  ds_read_b128 v[28:31], v10 offset:4608
  v_exp_f32 v52, v52
  v_exp_f32 v53, v53
  v_exp_f32 v54, v54
  v_exp_f32 v55, v55
  v_mfma_f32_32x32x16_bf16 v[64:79], v[20:23], v[4:7], v[32:47]
  ds_read_b128 v[20:23], v9 offset:7168
  v_exp_f32 v56, v56
  v_exp_f32 v57, v57
  v_exp_f32 v58, v58
  v_exp_f32 v59, v59
  s_waitcnt lgkmcnt(2)
  v_smfmac_f32_32x32x32_bf16 v[80:95], v[24:27], v[48:55], v8
  ds_read_b128 v[24:27], v10 offset:5120
  v_exp_f32 v60, v60
  v_exp_f32 v61, v61
  v_exp_f32 v62, v62
  v_exp_f32 v63, v63
  s_waitcnt vmcnt(0)
  v_mov_b32 v0, 161484
  s_mov_b64 exec, 2
  ds_add_u32 v0, v1
  s_mov_b64 exec, -1
  v_exp_f32 v64, v64
  v_exp_f32 v65, v65
  v_exp_f32 v66, v66
  v_exp_f32 v67, v67
  s_waitcnt lgkmcnt(2)
  v_smfmac_f32_32x32x32_bf16 v[80:95], v[28:31], v[56:63], v8
  ds_read_b128 v[28:31], v10 offset:5632
  v_exp_f32 v68, v68
  v_exp_f32 v69, v69
  v_exp_f32 v70, v70
  v_exp_f32 v71, v71
  v_mfma_f32_32x32x16_bf16 v[48:63], v[16:19], v[4:7], v[32:47]
  ds_read_b128 v[16:19], v9 offset:8192
  v_exp_f32 v72, v72
  v_exp_f32 v73, v73
  v_exp_f32 v74, v74
  v_exp_f32 v75, v75
  s_waitcnt lgkmcnt(2)
  v_smfmac_f32_32x32x32_bf16 v[80:95], v[24:27], v[64:71], v8
  ds_read_b128 v[24:27], v10 offset:6144
  v_exp_f32 v76, v76
  v_exp_f32 v77, v77
  v_exp_f32 v78, v78
  v_exp_f32 v79, v79
  s_cmp_eq_u32 s6, 7
  s_cbranch_scc1 L_w7_56
L_w7b_57:
  v_exp_f32 v48, v48
  v_exp_f32 v49, v49
  v_exp_f32 v50, v50
  v_exp_f32 v51, v51
  s_waitcnt lgkmcnt(2)
  v_smfmac_f32_32x32x32_bf16 v[80:95], v[28:31], v[72:79], v8
  ds_read_b128 v[28:31], v10 offset:6656
  v_exp_f32 v52, v52
  v_exp_f32 v53, v53
  v_exp_f32 v54, v54
  v_exp_f32 v55, v55
  v_mfma_f32_32x32x16_bf16 v[64:79], v[20:23], v[4:7], v[32:47]
  ds_read_b128 v[20:23], v9 offset:9216
  v_exp_f32 v56, v56
  v_exp_f32 v57, v57
  v_exp_f32 v58, v58
  v_exp_f32 v59, v59
  s_waitcnt lgkmcnt(2)
  v_smfmac_f32_32x32x32_bf16 v[80:95], v[24:27], v[48:55], v8
  ds_read_b128 v[24:27], v10 offset:7168
  v_exp_f32 v60, v60
  v_exp_f32 v61, v61
  v_exp_f32 v62, v62
  v_exp_f32 v63, v63
  s_cmp_eq_u32 s6, 7
  s_cbranch_scc1 L_w7_58
L_w7b_59:
  v_exp_f32 v64, v64
  v_exp_f32 v65, v65
  v_exp_f32 v66, v66
  v_exp_f32 v67, v67
  s_waitcnt lgkmcnt(2)
  v_smfmac_f32_32x32x32_bf16 v[80:95], v[28:31], v[56:63], v8
  ds_read_b128 v[28:31], v10 offset:7680
  v_add_u32 v10, v10, v11
  v_exp_f32 v68, v68
  v_exp_f32 v69, v69
  v_exp_f32 v70, v70
  v_exp_f32 v71, v71
  v_mfma_f32_32x32x16_bf16 v[48:63], v[16:19], v[4:7], v[32:47]
  ds_read_b128 v[16:19], v9 offset:10240
  v_exp_f32 v72, v72
  v_exp_f32 v73, v73
  v_exp_f32 v74, v74
  v_exp_f32 v75, v75
  s_waitcnt lgkmcnt(2)
  v_smfmac_f32_32x32x32_bf16 v[80:95], v[24:27], v[64:71], v8
  ds_read_b128 v[24:27], v10 offset:0
  v_exp_f32 v76, v76
  v_exp_f32 v77, v77
  v_exp_f32 v78, v78
  v_exp_f32 v79, v79
  s_cmp_eq_u32 s6, 7
  s_cbranch_scc1 L_w7_60
  s_mov_b32 s59, 16384
L_lw_62:
  v_mov_b32 v0, 161504
  ds_read_b32 v0, v0
  s_waitcnt lgkmcnt(0)
  v_readfirstlane_b32 s61, v0
  s_nop 0
  s_cmp_ge_u32 s61, 1
  s_cbranch_scc0 L_lw_62_r
L_lw_62_ok:
L_w7b_61:
  v_exp_f32 v48, v48
  v_exp_f32 v49, v49
  v_exp_f32 v50, v50
  v_exp_f32 v51, v51
  s_waitcnt lgkmcnt(2)
  v_smfmac_f32_32x32x32_bf16 v[80:95], v[28:31], v[72:79], v8
  ds_read_b128 v[28:31], v10 offset:512
  v_exp_f32 v52, v52
  v_exp_f32 v53, v53
  v_exp_f32 v54, v54
  v_exp_f32 v55, v55
  v_mfma_f32_32x32x16_bf16 v[64:79], v[20:23], v[4:7], v[32:47]
  ds_read_b128 v[20:23], v9 offset:11264
  v_exp_f32 v56, v56
  v_exp_f32 v57, v57
  v_exp_f32 v58, v58
  v_exp_f32 v59, v59
  s_waitcnt lgkmcnt(2)
  v_smfmac_f32_32x32x32_bf16 v[80:95], v[24:27], v[48:55], v8
  ds_read_b128 v[24:27], v10 offset:1024
  v_exp_f32 v60, v60
  v_exp_f32 v61, v61
  v_exp_f32 v62, v62
  v_exp_f32 v63, v63
  s_cmp_eq_u32 s6, 7
  s_cbranch_scc1 L_w7_63
  buffer_load_dwordx4 v[128:131], v2, s[8:11], s96 offen offset:0 sc1
  buffer_load_dwordx4 v[132:135], v2, s[8:11], s96 offen offset:1024 sc1
  s_mov_b32 s16, s42
  s_mov_b32 s17, s43
  s_mov_b32 s18, 3584
  s_mov_b32 s19, 0x20000
  s_mul_i32 s56, s5, 448
  s_lshl_b32 s57, s6, 6
  s_add_u32 s56, s56, s57
  v_lshlrev_b32 v12, 1, v1
  buffer_load_ushort v124, v12, s[16:19], s56 offen
L_w7b_64:
  v_exp_f32 v64, v64
  v_exp_f32 v65, v65
  v_exp_f32 v66, v66
  v_exp_f32 v67, v67
  s_waitcnt lgkmcnt(2)
  v_smfmac_f32_32x32x32_bf16 v[80:95], v[28:31], v[56:63], v8
  ds_read_b128 v[28:31], v10 offset:1536
  v_exp_f32 v68, v68
  v_exp_f32 v69, v69
  v_exp_f32 v70, v70
  v_exp_f32 v71, v71
  v_mfma_f32_32x32x16_bf16 v[48:63], v[16:19], v[4:7], v[32:47]
  ds_read_b128 v[16:19], v9 offset:12288
  v_exp_f32 v72, v72
  v_exp_f32 v73, v73
  v_exp_f32 v74, v74
  v_exp_f32 v75, v75
  s_waitcnt lgkmcnt(2)
  v_smfmac_f32_32x32x32_bf16 v[80:95], v[24:27], v[64:71], v8
  ds_read_b128 v[24:27], v10 offset:2048
  v_exp_f32 v76, v76
  v_exp_f32 v77, v77
  v_exp_f32 v78, v78
  v_exp_f32 v79, v79
  s_cmp_eq_u32 s6, 7
  s_cbranch_scc1 L_w7_65
  buffer_load_dwordx4 v[136:139], v2, s[8:11], s96 offen offset:2048 sc1
  buffer_load_dwordx4 v[140:143], v2, s[8:11], s96 offen offset:3072 sc1
  s_add_u32 s96, s96, 4096
L_w7b_66:
  v_exp_f32 v48, v48
  v_exp_f32 v49, v49
  v_exp_f32 v50, v50
  v_exp_f32 v51, v51
  s_waitcnt lgkmcnt(2)
  v_smfmac_f32_32x32x32_bf16 v[80:95], v[28:31], v[72:79], v8
  ds_read_b128 v[28:31], v10 offset:2560
  v_exp_f32 v52, v52
  v_exp_f32 v53, v53
  v_exp_f32 v54, v54
  v_exp_f32 v55, v55
  v_mfma_f32_32x32x16_bf16 v[64:79], v[20:23], v[4:7], v[32:47]
  ds_read_b128 v[20:23], v9 offset:13312
  v_exp_f32 v56, v56
  v_exp_f32 v57, v57
  v_exp_f32 v58, v58
  v_exp_f32 v59, v59
  s_waitcnt lgkmcnt(2)
  v_smfmac_f32_32x32x32_bf16 v[80:95], v[24:27], v[48:55], v8
  ds_read_b128 v[24:27], v10 offset:3072
  v_exp_f32 v60, v60
  v_exp_f32 v61, v61
  v_exp_f32 v62, v62
  v_exp_f32 v63, v63
  s_cmp_eq_u32 s6, 7
  s_cbranch_scc1 L_w7_67
  buffer_load_dwordx4 v[144:147], v2, s[8:11], s96 offen offset:0 sc1
  buffer_load_dwordx4 v[148:151], v2, s[8:11], s96 offen offset:1024 sc1
  s_waitcnt vmcnt(4)
  v_lshlrev_b32 v124, 16, v124
  s_lshl_b32 s56, s6, 8
  s_add_u32 s56, s56, 162176
  v_lshlrev_b32 v12, 2, v1
  v_add_u32 v12, s56, v12
  s_mov_b32 exec_lo, 0xffffffff
  s_mov_b32 exec_hi, 0x0
  ds_write_b32 v12, v124
  s_mov_b64 exec, -1
L_w7b_68:
  v_exp_f32 v64, v64
  v_exp_f32 v65, v65
  v_exp_f32 v66, v66
  v_exp_f32 v67, v67
  s_waitcnt lgkmcnt(2)
  v_smfmac_f32_32x32x32_bf16 v[80:95], v[28:31], v[56:63], v8
  ds_read_b128 v[28:31], v10 offset:3584
  v_exp_f32 v68, v68
  v_exp_f32 v69, v69
  v_exp_f32 v70, v70
  v_exp_f32 v71, v71
  v_mfma_f32_32x32x16_bf16 v[48:63], v[16:19], v[4:7], v[32:47]
  ds_read_b128 v[16:19], v9 offset:14336
  v_exp_f32 v72, v72
  v_exp_f32 v73, v73
  v_exp_f32 v74, v74
  v_exp_f32 v75, v75
  s_waitcnt lgkmcnt(2)
  v_smfmac_f32_32x32x32_bf16 v[80:95], v[24:27], v[64:71], v8
  ds_read_b128 v[24:27], v10 offset:4096
  v_exp_f32 v76, v76
  v_exp_f32 v77, v77
  v_exp_f32 v78, v78
  v_exp_f32 v79, v79
  s_cmp_eq_u32 s6, 7
  s_cbranch_scc1 L_w7_69
  buffer_load_dwordx4 v[152:155], v2, s[8:11], s96 offen offset:2048 sc1
  buffer_load_dwordx4 v[156:159], v2, s[8:11], s96 offen offset:3072 sc1
  s_add_u32 s96, s96, 4096
L_w7b_70:
  v_exp_f32 v48, v48
  v_exp_f32 v49, v49
  v_exp_f32 v50, v50
  v_exp_f32 v51, v51
  s_waitcnt lgkmcnt(2)
  v_smfmac_f32_32x32x32_bf16 v[80:95], v[28:31], v[72:79], v8
  ds_read_b128 v[28:31], v10 offset:4608
  v_exp_f32 v52, v52
  v_exp_f32 v53, v53
  v_exp_f32 v54, v54
  v_exp_f32 v55, v55
  v_mfma_f32_32x32x16_bf16 v[64:79], v[20:23], v[4:7], v[32:47]
  ds_read_b128 v[20:23], v9 offset:15360
  v_exp_f32 v56, v56
  v_exp_f32 v57, v57
  v_exp_f32 v58, v58
  v_exp_f32 v59, v59
  s_waitcnt lgkmcnt(2)
  v_smfmac_f32_32x32x32_bf16 v[80:95], v[24:27], v[48:55], v8
  ds_read_b128 v[24:27], v10 offset:5120
  v_exp_f32 v60, v60
  v_exp_f32 v61, v61
  v_exp_f32 v62, v62
  v_exp_f32 v63, v63
  s_cmp_eq_u32 s6, 7
  s_cbranch_scc1 L_w7_71
L_w7b_72:
  s_mov_b32 s59, 16384
L_lw_73:
  v_mov_b32 v0, 161472
  ds_read_b32 v0, v0
  s_waitcnt lgkmcnt(0)
  v_readfirstlane_b32 s61, v0
  s_nop 0
  s_cmp_ge_u32 s61, 4
  s_cbranch_scc0 L_lw_73_r
L_lw_73_ok:
  s_cmp_eq_u32 s6, 7
  s_cbranch_scc1 L_w7b_75
  buffer_load_dwordx4 v[160:163], v2, s[8:11], s96 offen offset:0 sc1
  buffer_load_dwordx4 v[164:167], v2, s[8:11], s96 offen offset:1024 sc1
L_w7b_75:
  v_exp_f32 v64, v64
  v_exp_f32 v65, v65
  v_exp_f32 v66, v66
  v_exp_f32 v67, v67
  s_waitcnt lgkmcnt(2)
  v_smfmac_f32_32x32x32_bf16 v[80:95], v[28:31], v[56:63], v8
  ds_read_b128 v[28:31], v10 offset:5632
  v_exp_f32 v68, v68
  v_exp_f32 v69, v69
  v_exp_f32 v70, v70
  v_exp_f32 v71, v71
  v_mfma_f32_32x32x16_bf16 v[48:63], v[16:19], v[4:7], v[32:47]
  ds_read_b128 v[16:19], v9 offset:16384
  v_exp_f32 v72, v72
  v_exp_f32 v73, v73
  v_exp_f32 v74, v74
  v_exp_f32 v75, v75
  s_waitcnt lgkmcnt(2)
  v_smfmac_f32_32x32x32_bf16 v[80:95], v[24:27], v[64:71], v8
  ds_read_b128 v[24:27], v10 offset:6144
  v_exp_f32 v76, v76
  v_exp_f32 v77, v77
  v_exp_f32 v78, v78
  v_exp_f32 v79, v79
  s_cmp_eq_u32 s6, 7
  s_cbranch_scc1 L_w7_76
  buffer_load_dwordx4 v[168:171], v2, s[8:11], s96 offen offset:2048 sc1
  buffer_load_dwordx4 v[172:175], v2, s[8:11], s96 offen offset:3072 sc1
  s_add_u32 s96, s96, 4096
L_w7b_77:
  v_exp_f32 v48, v48
  v_exp_f32 v49, v49
  v_exp_f32 v50, v50
  v_exp_f32 v51, v51
  s_waitcnt lgkmcnt(2)
  v_smfmac_f32_32x32x32_bf16 v[80:95], v[28:31], v[72:79], v8
  ds_read_b128 v[28:31], v10 offset:6656
  v_exp_f32 v52, v52
  v_exp_f32 v53, v53
  v_exp_f32 v54, v54
  v_exp_f32 v55, v55
  v_mfma_f32_32x32x16_bf16 v[64:79], v[20:23], v[4:7], v[32:47]
  ds_read_b128 v[20:23], v9 offset:17408
  v_exp_f32 v56, v56
  v_exp_f32 v57, v57
  v_exp_f32 v58, v58
  v_exp_f32 v59, v59
  s_waitcnt lgkmcnt(2)
  v_smfmac_f32_32x32x32_bf16 v[80:95], v[24:27], v[48:55], v8
  ds_read_b128 v[24:27], v10 offset:7168
  v_exp_f32 v60, v60
  v_exp_f32 v61, v61
  v_exp_f32 v62, v62
  v_exp_f32 v63, v63
  s_cmp_eq_u32 s6, 7
  s_cbranch_scc1 L_w7_78
  buffer_load_dwordx4 v[176:179], v2, s[8:11], s96 offen offset:0 sc1
  buffer_load_dwordx4 v[180:183], v2, s[8:11], s96 offen offset:1024 sc1
L_w7b_79:
  v_exp_f32 v64, v64
  v_exp_f32 v65, v65
  v_exp_f32 v66, v66
  v_exp_f32 v67, v67
  s_waitcnt lgkmcnt(2)
  v_smfmac_f32_32x32x32_bf16 v[80:95], v[28:31], v[56:63], v8
  ds_read_b128 v[28:31], v10 offset:7680
  v_add_u32 v10, v10, v11
  v_exp_f32 v68, v68
  v_exp_f32 v69, v69
  v_exp_f32 v70, v70
  v_exp_f32 v71, v71
  v_mfma_f32_32x32x16_bf16 v[48:63], v[16:19], v[4:7], v[32:47]
  ds_read_b128 v[16:19], v9 offset:18432
  v_exp_f32 v72, v72
  v_exp_f32 v73, v73
  v_exp_f32 v74, v74
  v_exp_f32 v75, v75
  s_waitcnt lgkmcnt(2)
  v_smfmac_f32_32x32x32_bf16 v[80:95], v[24:27], v[64:71], v8
  ds_read_b128 v[24:27], v10 offset:0
  v_exp_f32 v76, v76
  v_exp_f32 v77, v77
  v_exp_f32 v78, v78
  v_exp_f32 v79, v79
  s_cmp_eq_u32 s6, 7
  s_cbranch_scc1 L_w7_80
  buffer_load_dwordx4 v[184:187], v2, s[8:11], s96 offen offset:2048 sc1
  buffer_load_dwordx4 v[188:191], v2, s[8:11], s96 offen offset:3072 sc1
  s_add_u32 s96, s96, 4096
L_w7b_81:
  v_exp_f32 v48, v48
  v_exp_f32 v49, v49
  v_exp_f32 v50, v50
  v_exp_f32 v51, v51
  s_waitcnt lgkmcnt(2)
  v_smfmac_f32_32x32x32_bf16 v[80:95], v[28:31], v[72:79], v8
  ds_read_b128 v[28:31], v10 offset:512
  v_exp_f32 v52, v52
  v_exp_f32 v53, v53
  v_exp_f32 v54, v54
  v_exp_f32 v55, v55
  v_mfma_f32_32x32x16_bf16 v[64:79], v[20:23], v[4:7], v[32:47]
  ds_read_b128 v[20:23], v9 offset:19456
  v_exp_f32 v56, v56
  v_exp_f32 v57, v57
  v_exp_f32 v58, v58
  v_exp_f32 v59, v59
  s_waitcnt lgkmcnt(2)
  v_smfmac_f32_32x32x32_bf16 v[80:95], v[24:27], v[48:55], v8
  ds_read_b128 v[24:27], v10 offset:1024
  v_exp_f32 v60, v60
  v_exp_f32 v61, v61
  v_exp_f32 v62, v62
  v_exp_f32 v63, v63
  s_cmp_eq_u32 s6, 7
  s_cbranch_scc1 L_w7_82
  buffer_load_dwordx4 v[192:195], v2, s[8:11], s96 offen offset:0 sc1
  buffer_load_dwordx4 v[196:199], v2, s[8:11], s96 offen offset:1024 sc1
L_w7b_83:
  v_exp_f32 v64, v64
  v_exp_f32 v65, v65
  v_exp_f32 v66, v66
  v_exp_f32 v67, v67
  s_waitcnt lgkmcnt(2)
  v_smfmac_f32_32x32x32_bf16 v[80:95], v[28:31], v[56:63], v8
  ds_read_b128 v[28:31], v10 offset:1536
  v_exp_f32 v68, v68
  v_exp_f32 v69, v69
  v_exp_f32 v70, v70
  v_exp_f32 v71, v71
  v_mfma_f32_32x32x16_bf16 v[48:63], v[16:19], v[4:7], v[32:47]
  ds_read_b128 v[16:19], v9 offset:20480
  v_exp_f32 v72, v72
  v_exp_f32 v73, v73
  v_exp_f32 v74, v74
  v_exp_f32 v75, v75
  s_waitcnt lgkmcnt(2)
  v_smfmac_f32_32x32x32_bf16 v[80:95], v[24:27], v[64:71], v8
  ds_read_b128 v[24:27], v10 offset:2048
  v_exp_f32 v76, v76
  v_exp_f32 v77, v77
  v_exp_f32 v78, v78
  v_exp_f32 v79, v79
  s_cmp_eq_u32 s6, 7
  s_cbranch_scc1 L_w7_84
  buffer_load_dwordx4 v[200:203], v2, s[8:11], s96 offen offset:2048 sc1
  buffer_load_dwordx4 v[204:207], v2, s[8:11], s96 offen offset:3072 sc1
  s_add_u32 s96, s96, 4096
L_w7b_85:
  v_exp_f32 v48, v48
  v_exp_f32 v49, v49
  v_exp_f32 v50, v50
  v_exp_f32 v51, v51
  s_waitcnt lgkmcnt(2)
  v_smfmac_f32_32x32x32_bf16 v[80:95], v[28:31], v[72:79], v8
  ds_read_b128 v[28:31], v10 offset:2560
  v_exp_f32 v52, v52
  v_exp_f32 v53, v53
  v_exp_f32 v54, v54
  v_exp_f32 v55, v55
  v_mfma_f32_32x32x16_bf16 v[64:79], v[20:23], v[4:7], v[32:47]
  ds_read_b128 v[20:23], v9 offset:21504
  v_exp_f32 v56, v56
  v_exp_f32 v57, v57
  v_exp_f32 v58, v58
  v_exp_f32 v59, v59
  s_waitcnt lgkmcnt(2)
  v_smfmac_f32_32x32x32_bf16 v[80:95], v[24:27], v[48:55], v8
  ds_read_b128 v[24:27], v10 offset:3072
  v_exp_f32 v60, v60
  v_exp_f32 v61, v61
  v_exp_f32 v62, v62
  v_exp_f32 v63, v63
  s_cmp_eq_u32 s6, 7
  s_cbranch_scc1 L_w7_86
  buffer_load_dwordx4 v[208:211], v2, s[8:11], s96 offen offset:0 sc1
  buffer_load_dwordx4 v[212:215], v2, s[8:11], s96 offen offset:1024 sc1
L_w7b_87:
  v_exp_f32 v64, v64
  v_exp_f32 v65, v65
  v_exp_f32 v66, v66
  v_exp_f32 v67, v67
  s_waitcnt lgkmcnt(2)
  v_smfmac_f32_32x32x32_bf16 v[80:95], v[28:31], v[56:63], v8
  ds_read_b128 v[28:31], v10 offset:3584
  v_exp_f32 v68, v68
  v_exp_f32 v69, v69
  v_exp_f32 v70, v70
  v_exp_f32 v71, v71
  v_mfma_f32_32x32x16_bf16 v[48:63], v[16:19], v[4:7], v[32:47]
  ds_read_b128 v[16:19], v9 offset:22528
  v_exp_f32 v72, v72
  v_exp_f32 v73, v73
  v_exp_f32 v74, v74
  v_exp_f32 v75, v75
  s_waitcnt lgkmcnt(2)
  v_smfmac_f32_32x32x32_bf16 v[80:95], v[24:27], v[64:71], v8
  ds_read_b128 v[24:27], v10 offset:4096
  v_exp_f32 v76, v76
  v_exp_f32 v77, v77
  v_exp_f32 v78, v78
  v_exp_f32 v79, v79
  s_cmp_eq_u32 s6, 7
  s_cbranch_scc1 L_w7_88
  buffer_load_dwordx4 v[216:219], v2, s[8:11], s96 offen offset:2048 sc1
  buffer_load_dwordx4 v[220:223], v2, s[8:11], s96 offen offset:3072 sc1
  s_add_u32 s96, s96, 4096
L_w7b_89:
  v_exp_f32 v48, v48
  v_exp_f32 v49, v49
  v_exp_f32 v50, v50
  v_exp_f32 v51, v51
  s_waitcnt lgkmcnt(2)
  v_smfmac_f32_32x32x32_bf16 v[80:95], v[28:31], v[72:79], v8
  ds_read_b128 v[28:31], v10 offset:4608
  v_exp_f32 v52, v52
  v_exp_f32 v53, v53
  v_exp_f32 v54, v54
  v_exp_f32 v55, v55
  v_mfma_f32_32x32x16_bf16 v[64:79], v[20:23], v[4:7], v[32:47]
  ds_read_b128 v[20:23], v9 offset:23552
  v_exp_f32 v56, v56
  v_exp_f32 v57, v57
  v_exp_f32 v58, v58
  v_exp_f32 v59, v59
  s_waitcnt lgkmcnt(2)
  v_smfmac_f32_32x32x32_bf16 v[80:95], v[24:27], v[48:55], v8
  ds_read_b128 v[24:27], v10 offset:5120
  v_exp_f32 v60, v60
  v_exp_f32 v61, v61
  v_exp_f32 v62, v62
  v_exp_f32 v63, v63
  s_cmp_eq_u32 s6, 7
  s_cbranch_scc1 L_w7_90
  buffer_load_dwordx4 v[224:227], v2, s[8:11], s96 offen offset:0 sc1
  buffer_load_dwordx4 v[228:231], v2, s[8:11], s96 offen offset:1024 sc1
L_w7b_91:
  v_exp_f32 v64, v64
  v_exp_f32 v65, v65
  v_exp_f32 v66, v66
  v_exp_f32 v67, v67
  s_waitcnt lgkmcnt(2)
  v_smfmac_f32_32x32x32_bf16 v[80:95], v[28:31], v[56:63], v8
  ds_read_b128 v[28:31], v10 offset:5632
  v_exp_f32 v68, v68
  v_exp_f32 v69, v69
  v_exp_f32 v70, v70
  v_exp_f32 v71, v71
  v_mfma_f32_32x32x16_bf16 v[48:63], v[16:19], v[4:7], v[32:47]
  ds_read_b128 v[16:19], v9 offset:24576
  v_exp_f32 v72, v72
  v_exp_f32 v73, v73
  v_exp_f32 v74, v74
  v_exp_f32 v75, v75
  s_waitcnt lgkmcnt(2)
  v_smfmac_f32_32x32x32_bf16 v[80:95], v[24:27], v[64:71], v8
  ds_read_b128 v[24:27], v10 offset:6144
  v_exp_f32 v76, v76
  v_exp_f32 v77, v77
  v_exp_f32 v78, v78
  v_exp_f32 v79, v79
  s_cmp_eq_u32 s6, 7
  s_cbranch_scc1 L_w7_92
  buffer_load_dwordx4 v[232:235], v2, s[8:11], s96 offen offset:2048 sc1
L_w7b_93:
  v_exp_f32 v48, v48
  v_exp_f32 v49, v49
  v_exp_f32 v50, v50
  v_exp_f32 v51, v51
  s_waitcnt lgkmcnt(2)
  v_smfmac_f32_32x32x32_bf16 v[80:95], v[28:31], v[72:79], v8
  ds_read_b128 v[28:31], v10 offset:6656
  v_exp_f32 v52, v52
  v_exp_f32 v53, v53
  v_exp_f32 v54, v54
  v_exp_f32 v55, v55
  v_mfma_f32_32x32x16_bf16 v[64:79], v[20:23], v[4:7], v[32:47]
  ds_read_b128 v[20:23], v9 offset:25600
  v_exp_f32 v56, v56
  v_exp_f32 v57, v57
  v_exp_f32 v58, v58
  v_exp_f32 v59, v59
  s_waitcnt lgkmcnt(2)
  v_smfmac_f32_32x32x32_bf16 v[80:95], v[24:27], v[48:55], v8
  ds_read_b128 v[24:27], v10 offset:7168
  v_exp_f32 v60, v60
  v_exp_f32 v61, v61
  v_exp_f32 v62, v62
  v_exp_f32 v63, v63
  s_cmp_eq_u32 s6, 7
  s_cbranch_scc1 L_w7_94
  buffer_load_dwordx4 v[236:239], v2, s[8:11], s96 offen offset:3072 sc1
  s_add_u32 s96, s96, 4096
L_w7b_95:
  v_exp_f32 v64, v64
  v_exp_f32 v65, v65
  v_exp_f32 v66, v66
  v_exp_f32 v67, v67
  s_waitcnt lgkmcnt(2)
  v_smfmac_f32_32x32x32_bf16 v[80:95], v[28:31], v[56:63], v8
  ds_read_b128 v[28:31], v10 offset:7680
  v_add_u32 v10, v10, v11
  v_exp_f32 v68, v68
  v_exp_f32 v69, v69
  v_exp_f32 v70, v70
  v_exp_f32 v71, v71
  v_mfma_f32_32x32x16_bf16 v[48:63], v[16:19], v[4:7], v[32:47]
  ds_read_b128 v[16:19], v9 offset:26624
  v_exp_f32 v72, v72
  v_exp_f32 v73, v73
  v_exp_f32 v74, v74
  v_exp_f32 v75, v75
  s_waitcnt lgkmcnt(2)
  v_smfmac_f32_32x32x32_bf16 v[80:95], v[24:27], v[64:71], v8
  ds_read_b128 v[24:27], v10 offset:0
  v_exp_f32 v76, v76
  v_exp_f32 v77, v77
  v_exp_f32 v78, v78
  v_exp_f32 v79, v79
  s_cmp_eq_u32 s6, 7
  s_cbranch_scc1 L_w7_96
  buffer_load_dwordx4 v[240:243], v2, s[8:11], s96 offen offset:0 sc1
L_w7b_97:
  v_exp_f32 v48, v48
  v_exp_f32 v49, v49
  v_exp_f32 v50, v50
  v_exp_f32 v51, v51
  s_waitcnt lgkmcnt(2)
  v_smfmac_f32_32x32x32_bf16 v[80:95], v[28:31], v[72:79], v8
  ds_read_b128 v[28:31], v10 offset:512
  v_exp_f32 v52, v52
  v_exp_f32 v53, v53
  v_exp_f32 v54, v54
  v_exp_f32 v55, v55
  v_mfma_f32_32x32x16_bf16 v[64:79], v[20:23], v[4:7], v[32:47]
  ds_read_b128 v[20:23], v9 offset:27648
  v_exp_f32 v56, v56
  v_exp_f32 v57, v57
  v_exp_f32 v58, v58
  v_exp_f32 v59, v59
  s_waitcnt lgkmcnt(2)
  v_smfmac_f32_32x32x32_bf16 v[80:95], v[24:27], v[48:55], v8
  ds_read_b128 v[24:27], v10 offset:1024
  v_exp_f32 v60, v60
  v_exp_f32 v61, v61
  v_exp_f32 v62, v62
  v_exp_f32 v63, v63
  s_cmp_eq_u32 s6, 7
  s_cbranch_scc1 L_w7_98
  buffer_load_dwordx4 v[244:247], v2, s[8:11], s96 offen offset:1024 sc1
L_w7b_99:
  v_exp_f32 v64, v64
  v_exp_f32 v65, v65
  v_exp_f32 v66, v66
  v_exp_f32 v67, v67
  s_waitcnt lgkmcnt(2)
  v_smfmac_f32_32x32x32_bf16 v[80:95], v[28:31], v[56:63], v8
  ds_read_b128 v[28:31], v10 offset:1536
  v_exp_f32 v68, v68
  v_exp_f32 v69, v69
  v_exp_f32 v70, v70
  v_exp_f32 v71, v71
  v_mfma_f32_32x32x16_bf16 v[48:63], v[16:19], v[4:7], v[32:47]
  ds_read_b128 v[16:19], v9 offset:28672
  v_exp_f32 v72, v72
  v_exp_f32 v73, v73
  v_exp_f32 v74, v74
  v_exp_f32 v75, v75
  s_waitcnt lgkmcnt(2)
  v_smfmac_f32_32x32x32_bf16 v[80:95], v[24:27], v[64:71], v8
  ds_read_b128 v[24:27], v10 offset:2048
  v_exp_f32 v76, v76
  v_exp_f32 v77, v77
  v_exp_f32 v78, v78
  v_exp_f32 v79, v79
  s_cmp_eq_u32 s6, 7
  s_cbranch_scc1 L_w7_100
  buffer_load_dwordx4 v[248:251], v2, s[8:11], s96 offen offset:2048 sc1
L_w7b_101:
  v_exp_f32 v48, v48
  v_exp_f32 v49, v49
  v_exp_f32 v50, v50
  v_exp_f32 v51, v51
  s_waitcnt lgkmcnt(2)
  v_smfmac_f32_32x32x32_bf16 v[80:95], v[28:31], v[72:79], v8
  ds_read_b128 v[28:31], v10 offset:2560
  v_exp_f32 v52, v52
  v_exp_f32 v53, v53
  v_exp_f32 v54, v54
  v_exp_f32 v55, v55
  v_mfma_f32_32x32x16_bf16 v[64:79], v[20:23], v[4:7], v[32:47]
  ds_read_b128 v[20:23], v9 offset:29696
  v_exp_f32 v56, v56
  v_exp_f32 v57, v57
  v_exp_f32 v58, v58
  v_exp_f32 v59, v59
  s_waitcnt lgkmcnt(2)
  v_smfmac_f32_32x32x32_bf16 v[80:95], v[24:27], v[48:55], v8
  ds_read_b128 v[24:27], v10 offset:3072
  v_exp_f32 v60, v60
  v_exp_f32 v61, v61
  v_exp_f32 v62, v62
  v_exp_f32 v63, v63
  s_cmp_eq_u32 s6, 7
  s_cbranch_scc1 L_w7b_103
  buffer_load_dwordx4 v[252:255], v2, s[8:11], s96 offen offset:3072 sc1
  s_add_u32 s96, s96, 4096
L_w7b_103:
  v_exp_f32 v64, v64
  v_exp_f32 v65, v65
  v_exp_f32 v66, v66
  v_exp_f32 v67, v67
  s_waitcnt lgkmcnt(2)
  v_smfmac_f32_32x32x32_bf16 v[80:95], v[28:31], v[56:63], v8
  ds_read_b128 v[28:31], v10 offset:3584
  v_exp_f32 v68, v68
  v_exp_f32 v69, v69
  v_exp_f32 v70, v70
  v_exp_f32 v71, v71
  v_mfma_f32_32x32x16_bf16 v[48:63], v[16:19], v[4:7], v[32:47]
  ds_read_b128 v[16:19], v9 offset:30720
  v_exp_f32 v72, v72
  v_exp_f32 v73, v73
  v_exp_f32 v74, v74
  v_exp_f32 v75, v75
  s_waitcnt lgkmcnt(2)
  v_smfmac_f32_32x32x32_bf16 v[80:95], v[24:27], v[64:71], v8
  ds_read_b128 v[24:27], v10 offset:4096
  v_exp_f32 v76, v76
  v_exp_f32 v77, v77
  v_exp_f32 v78, v78
  v_exp_f32 v79, v79
  s_cmp_eq_u32 s6, 7
  s_cbranch_scc1 L_w7b_105
  s_add_u32 s56, s97, 0
  buffer_load_dwordx4 v[96:99], v2, s[8:11], s56 offen offset:0 sc1
L_w7b_105:
  v_exp_f32 v48, v48
  v_exp_f32 v49, v49
  v_exp_f32 v50, v50
  v_exp_f32 v51, v51
  s_waitcnt lgkmcnt(2)
  v_smfmac_f32_32x32x32_bf16 v[80:95], v[28:31], v[72:79], v8
  ds_read_b128 v[28:31], v10 offset:4608
  v_exp_f32 v52, v52
  v_exp_f32 v53, v53
  v_exp_f32 v54, v54
  v_exp_f32 v55, v55
  v_mfma_f32_32x32x16_bf16 v[64:79], v[20:23], v[4:7], v[32:47]
  ds_read_b128 v[20:23], v9 offset:31744
  v_exp_f32 v56, v56
  v_exp_f32 v57, v57
  v_exp_f32 v58, v58
  v_exp_f32 v59, v59
  s_waitcnt lgkmcnt(2)
  v_smfmac_f32_32x32x32_bf16 v[80:95], v[24:27], v[48:55], v8
  ds_read_b128 v[24:27], v10 offset:5120
  v_exp_f32 v60, v60
  v_exp_f32 v61, v61
  v_exp_f32 v62, v62
  v_exp_f32 v63, v63
  s_mov_b32 s59, 16384
L_lw_106:
  v_mov_b32 v0, 161484
  ds_read_b32 v0, v0
  s_waitcnt lgkmcnt(0)
  v_readfirstlane_b32 s61, v0
  s_nop 0
  s_cmp_ge_u32 s61, 4
  s_cbranch_scc0 L_lw_106_r
L_lw_106_ok:
  s_cmp_eq_u32 s6, 7
  s_cbranch_scc1 L_w7b_108
  s_add_u32 s56, s97, 0
  buffer_load_dwordx4 v[100:103], v2, s[8:11], s56 offen offset:1024 sc1
L_w7b_108:
  v_exp_f32 v64, v64
  v_exp_f32 v65, v65
  v_exp_f32 v66, v66
  v_exp_f32 v67, v67
  s_waitcnt lgkmcnt(2)
  v_smfmac_f32_32x32x32_bf16 v[80:95], v[28:31], v[56:63], v8
  ds_read_b128 v[28:31], v10 offset:5632
  v_exp_f32 v68, v68
  v_exp_f32 v69, v69
  v_exp_f32 v70, v70
  v_exp_f32 v71, v71
  v_mfma_f32_32x32x16_bf16 v[48:63], v[16:19], v[4:7], v[32:47]
  v_add_u32 v9, 65536, v9
  ds_read_b128 v[16:19], v9 offset:0
  v_exp_f32 v72, v72
  v_exp_f32 v73, v73
  v_exp_f32 v74, v74
  v_exp_f32 v75, v75
  s_waitcnt lgkmcnt(2)
  v_smfmac_f32_32x32x32_bf16 v[80:95], v[24:27], v[64:71], v8
  ds_read_b128 v[24:27], v10 offset:6144
  v_exp_f32 v76, v76
  v_exp_f32 v77, v77
  v_exp_f32 v78, v78
  v_exp_f32 v79, v79
  s_cmp_eq_u32 s6, 7
  s_cbranch_scc1 L_w7b_110
  s_add_u32 s56, s97, 0
  buffer_load_dwordx4 v[104:107], v2, s[8:11], s56 offen offset:2048 sc1
L_w7b_110:
  v_exp_f32 v48, v48
  v_exp_f32 v49, v49
  v_exp_f32 v50, v50
  v_exp_f32 v51, v51
  s_waitcnt lgkmcnt(2)
  v_smfmac_f32_32x32x32_bf16 v[80:95], v[28:31], v[72:79], v8
  ds_read_b128 v[28:31], v10 offset:6656
  v_exp_f32 v52, v52
  v_exp_f32 v53, v53
  v_exp_f32 v54, v54
  v_exp_f32 v55, v55
  v_mfma_f32_32x32x16_bf16 v[64:79], v[20:23], v[4:7], v[32:47]
  ds_read_b128 v[20:23], v9 offset:1024
  v_exp_f32 v56, v56
  v_exp_f32 v57, v57
  v_exp_f32 v58, v58
  v_exp_f32 v59, v59
  s_waitcnt lgkmcnt(2)
  v_smfmac_f32_32x32x32_bf16 v[80:95], v[24:27], v[48:55], v8
  ds_read_b128 v[24:27], v10 offset:7168
  v_exp_f32 v60, v60
  v_exp_f32 v61, v61
  v_exp_f32 v62, v62
  v_exp_f32 v63, v63
  s_cmp_eq_u32 s6, 7
  s_cbranch_scc1 L_w7_111
  s_add_u32 s56, s97, 0
  buffer_load_dwordx4 v[108:111], v2, s[8:11], s56 offen offset:3072 sc1
L_w7b_112:
  v_exp_f32 v64, v64
  v_exp_f32 v65, v65
  v_exp_f32 v66, v66
  v_exp_f32 v67, v67
  s_waitcnt lgkmcnt(2)
  v_smfmac_f32_32x32x32_bf16 v[80:95], v[28:31], v[56:63], v8
  ds_read_b128 v[28:31], v10 offset:7680
  v_mad_u32_u24 v10, v11, 5, v10
  v_exp_f32 v68, v68
  v_exp_f32 v69, v69
  v_exp_f32 v70, v70
  v_exp_f32 v71, v71
  v_mfma_f32_32x32x16_bf16 v[48:63], v[16:19], v[4:7], v[32:47]
  ds_read_b128 v[16:19], v9 offset:2048
  v_exp_f32 v72, v72
  v_exp_f32 v73, v73
  v_exp_f32 v74, v74
  v_exp_f32 v75, v75
  s_waitcnt lgkmcnt(2)
  v_smfmac_f32_32x32x32_bf16 v[80:95], v[24:27], v[64:71], v8
  ds_read_b128 v[24:27], v10 offset:0
  v_exp_f32 v76, v76
  v_exp_f32 v77, v77
  v_exp_f32 v78, v78
  v_exp_f32 v79, v79
  s_cmp_eq_u32 s6, 7
  s_cbranch_scc1 L_w7_113
  s_add_u32 s56, s97, 4096
  buffer_load_dwordx4 v[112:115], v2, s[8:11], s56 offen offset:0 sc1
L_w7b_114:
  v_exp_f32 v48, v48
  v_exp_f32 v49, v49
  v_exp_f32 v50, v50
  v_exp_f32 v51, v51
  s_waitcnt lgkmcnt(2)
  v_smfmac_f32_32x32x32_bf16 v[80:95], v[28:31], v[72:79], v8
  ds_read_b128 v[28:31], v10 offset:512
  v_exp_f32 v52, v52
  v_exp_f32 v53, v53
  v_exp_f32 v54, v54
  v_exp_f32 v55, v55
  v_mfma_f32_32x32x16_bf16 v[64:79], v[20:23], v[4:7], v[32:47]
  ds_read_b128 v[20:23], v9 offset:3072
  v_exp_f32 v56, v56
  v_exp_f32 v57, v57
  v_exp_f32 v58, v58
  v_exp_f32 v59, v59
  s_waitcnt lgkmcnt(2)
  v_smfmac_f32_32x32x32_bf16 v[80:95], v[24:27], v[48:55], v8
  ds_read_b128 v[24:27], v10 offset:1024
  v_exp_f32 v60, v60
  v_exp_f32 v61, v61
  v_exp_f32 v62, v62
  v_exp_f32 v63, v63
  s_cmp_eq_u32 s6, 7
  s_cbranch_scc1 L_w7b_116
  s_add_u32 s56, s97, 4096
  buffer_load_dwordx4 v[116:119], v2, s[8:11], s56 offen offset:1024 sc1
L_w7b_116:
  v_exp_f32 v64, v64
  v_exp_f32 v65, v65
  v_exp_f32 v66, v66
  v_exp_f32 v67, v67
  s_waitcnt lgkmcnt(2)
  v_smfmac_f32_32x32x32_bf16 v[80:95], v[28:31], v[56:63], v8
  ds_read_b128 v[28:31], v10 offset:1536
  v_exp_f32 v68, v68
  v_exp_f32 v69, v69
  v_exp_f32 v70, v70
  v_exp_f32 v71, v71
  v_mfma_f32_32x32x16_bf16 v[48:63], v[16:19], v[4:7], v[32:47]
  ds_read_b128 v[16:19], v9 offset:4096
  v_exp_f32 v72, v72
  v_exp_f32 v73, v73
  v_exp_f32 v74, v74
  v_exp_f32 v75, v75
  s_waitcnt lgkmcnt(2)
  v_smfmac_f32_32x32x32_bf16 v[80:95], v[24:27], v[64:71], v8
  ds_read_b128 v[24:27], v10 offset:2048
  v_exp_f32 v76, v76
  v_exp_f32 v77, v77
  v_exp_f32 v78, v78
  v_exp_f32 v79, v79
  s_cmp_eq_u32 s6, 7
  s_cbranch_scc1 L_w7_117
L_w7b_118:
  v_mov_b32 v0, 161488
  s_mov_b64 exec, 2
  ds_add_u32 v0, v1
  s_mov_b64 exec, -1
  s_cmp_eq_u32 s6, 7
  s_cbranch_scc1 L_w7b_120
  s_add_u32 s56, s97, 4096
  buffer_load_dwordx4 v[120:123], v2, s[8:11], s56 offen offset:2048 sc1
L_w7b_120:
  v_exp_f32 v48, v48
  v_exp_f32 v49, v49
  v_exp_f32 v50, v50
  v_exp_f32 v51, v51
  s_waitcnt lgkmcnt(2)
  v_smfmac_f32_32x32x32_bf16 v[80:95], v[28:31], v[72:79], v8
  ds_read_b128 v[28:31], v10 offset:2560
  v_exp_f32 v52, v52
  v_exp_f32 v53, v53
  v_exp_f32 v54, v54
  v_exp_f32 v55, v55
  v_mfma_f32_32x32x16_bf16 v[64:79], v[20:23], v[4:7], v[32:47]
  ds_read_b128 v[20:23], v9 offset:5120
  v_exp_f32 v56, v56
  v_exp_f32 v57, v57
  v_exp_f32 v58, v58
  v_exp_f32 v59, v59
  s_waitcnt lgkmcnt(2)
  v_smfmac_f32_32x32x32_bf16 v[80:95], v[24:27], v[48:55], v8
  ds_read_b128 v[24:27], v10 offset:3072
  v_exp_f32 v60, v60
  v_exp_f32 v61, v61
  v_exp_f32 v62, v62
  v_exp_f32 v63, v63
  s_cmp_eq_u32 s6, 7
  s_cbranch_scc1 L_w7b_122
  s_add_u32 s56, s97, 4096
  buffer_load_dwordx4 v[124:127], v2, s[8:11], s56 offen offset:3072 sc1
L_w7b_122:
  v_exp_f32 v64, v64
  v_exp_f32 v65, v65
  v_exp_f32 v66, v66
  v_exp_f32 v67, v67
  s_waitcnt lgkmcnt(2)
  v_smfmac_f32_32x32x32_bf16 v[80:95], v[28:31], v[56:63], v8
  ds_read_b128 v[28:31], v10 offset:3584
  v_exp_f32 v68, v68
  v_exp_f32 v69, v69
  v_exp_f32 v70, v70
  v_exp_f32 v71, v71
  v_mfma_f32_32x32x16_bf16 v[48:63], v[16:19], v[4:7], v[32:47]
  ds_read_b128 v[16:19], v9 offset:6144
  v_exp_f32 v72, v72
  v_exp_f32 v73, v73
  v_exp_f32 v74, v74
  v_exp_f32 v75, v75
  s_waitcnt lgkmcnt(2)
  v_smfmac_f32_32x32x32_bf16 v[80:95], v[24:27], v[64:71], v8
  ds_read_b128 v[24:27], v10 offset:4096
  v_exp_f32 v76, v76
  v_exp_f32 v77, v77
  v_exp_f32 v78, v78
  v_exp_f32 v79, v79
  v_exp_f32 v48, v48
  v_exp_f32 v49, v49
  v_exp_f32 v50, v50
  v_exp_f32 v51, v51
  s_waitcnt lgkmcnt(2)
  v_smfmac_f32_32x32x32_bf16 v[80:95], v[28:31], v[72:79], v8
  ds_read_b128 v[28:31], v10 offset:4608
  v_exp_f32 v52, v52
  v_exp_f32 v53, v53
  v_exp_f32 v54, v54
  v_exp_f32 v55, v55
  v_mfma_f32_32x32x16_bf16 v[64:79], v[20:23], v[4:7], v[32:47]
  ds_read_b128 v[20:23], v9 offset:7168
  v_exp_f32 v56, v56
  v_exp_f32 v57, v57
  v_exp_f32 v58, v58
  v_exp_f32 v59, v59
  s_waitcnt lgkmcnt(2)
  v_smfmac_f32_32x32x32_bf16 v[80:95], v[24:27], v[48:55], v8
  ds_read_b128 v[24:27], v10 offset:5120
  v_exp_f32 v60, v60
  v_exp_f32 v61, v61
  v_exp_f32 v62, v62
  v_exp_f32 v63, v63
  s_mov_b32 s59, 16384
L_lw_123:
  v_mov_b32 v0, 161488
  ds_read_b32 v0, v0
  s_waitcnt lgkmcnt(0)
  v_readfirstlane_b32 s61, v0
  s_nop 0
  s_cmp_ge_u32 s61, 8
  s_cbranch_scc0 L_lw_123_r
L_lw_123_ok:
  v_exp_f32 v64, v64
  v_exp_f32 v65, v65
  v_exp_f32 v66, v66
  v_exp_f32 v67, v67
  s_waitcnt lgkmcnt(2)
  v_smfmac_f32_32x32x32_bf16 v[80:95], v[28:31], v[56:63], v8
  ds_read_b128 v[28:31], v10 offset:5632
  v_exp_f32 v68, v68
  v_exp_f32 v69, v69
  v_exp_f32 v70, v70
  v_exp_f32 v71, v71
  v_mfma_f32_32x32x16_bf16 v[48:63], v[16:19], v[4:7], v[32:47]
  ds_read_b128 v[16:19], v9 offset:8192
  v_exp_f32 v72, v72
  v_exp_f32 v73, v73
  v_exp_f32 v74, v74
  v_exp_f32 v75, v75
  s_waitcnt lgkmcnt(2)
  v_smfmac_f32_32x32x32_bf16 v[80:95], v[24:27], v[64:71], v8
  ds_read_b128 v[24:27], v10 offset:6144
  v_exp_f32 v76, v76
  v_exp_f32 v77, v77
  v_exp_f32 v78, v78
  v_exp_f32 v79, v79
  s_cmp_eq_u32 s6, 7
  s_cbranch_scc1 L_w7_124
L_w7b_125:
  s_add_u32 s94, s98, 0
  s_and_b32 s56, s6, 3
  s_lshl_b32 s56, s56, 14
  s_add_u32 s95, s56, 0
  s_mov_b32 m0, s95
  s_nop 0
  buffer_load_dwordx4 v2, s[8:11], s94 offen offset:0 sc1 lds
  v_exp_f32 v48, v48
  v_exp_f32 v49, v49
  v_exp_f32 v50, v50
  v_exp_f32 v51, v51
  s_waitcnt lgkmcnt(2)
  v_smfmac_f32_32x32x32_bf16 v[80:95], v[28:31], v[72:79], v8
  ds_read_b128 v[28:31], v10 offset:6656
  v_exp_f32 v52, v52
  v_exp_f32 v53, v53
  v_exp_f32 v54, v54
  v_exp_f32 v55, v55
  v_mfma_f32_32x32x16_bf16 v[64:79], v[20:23], v[4:7], v[32:47]
  ds_read_b128 v[20:23], v9 offset:9216
  v_exp_f32 v56, v56
  v_exp_f32 v57, v57
  v_exp_f32 v58, v58
  v_exp_f32 v59, v59
  s_waitcnt lgkmcnt(2)
  v_smfmac_f32_32x32x32_bf16 v[80:95], v[24:27], v[48:55], v8
  ds_read_b128 v[24:27], v10 offset:7168
  v_exp_f32 v60, v60
  v_exp_f32 v61, v61
  v_exp_f32 v62, v62
  v_exp_f32 v63, v63
  s_cmp_eq_u32 s6, 7
  s_cbranch_scc1 L_w7_126
L_w7b_127:
  s_mov_b32 m0, s95
  s_nop 0
  buffer_load_dwordx4 v2, s[8:11], s94 offen offset:1024 sc1 lds
  v_exp_f32 v64, v64
  v_exp_f32 v65, v65
  v_exp_f32 v66, v66
  v_exp_f32 v67, v67
  s_waitcnt lgkmcnt(2)
  v_smfmac_f32_32x32x32_bf16 v[80:95], v[28:31], v[56:63], v8
  ds_read_b128 v[28:31], v10 offset:7680
  v_add_u32 v10, v10, v11
  v_exp_f32 v68, v68
  v_exp_f32 v69, v69
  v_exp_f32 v70, v70
  v_exp_f32 v71, v71
  v_mfma_f32_32x32x16_bf16 v[48:63], v[16:19], v[4:7], v[32:47]
  ds_read_b128 v[16:19], v9 offset:10240
  v_exp_f32 v72, v72
  v_exp_f32 v73, v73
  v_exp_f32 v74, v74
  v_exp_f32 v75, v75
  s_waitcnt lgkmcnt(2)
  v_smfmac_f32_32x32x32_bf16 v[80:95], v[24:27], v[64:71], v8
  ds_read_b128 v[24:27], v10 offset:0
  v_exp_f32 v76, v76
  v_exp_f32 v77, v77
  v_exp_f32 v78, v78
  v_exp_f32 v79, v79
  s_cmp_eq_u32 s6, 7
  s_cbranch_scc1 L_w7_128
L_w7b_129:
  s_mov_b32 m0, s95
  s_nop 0
  buffer_load_dwordx4 v2, s[8:11], s94 offen offset:2048 sc1 lds
  v_exp_f32 v48, v48
  v_exp_f32 v49, v49
  v_exp_f32 v50, v50
  v_exp_f32 v51, v51
  s_waitcnt lgkmcnt(2)
  v_smfmac_f32_32x32x32_bf16 v[80:95], v[28:31], v[72:79], v8
  ds_read_b128 v[28:31], v10 offset:512
  v_exp_f32 v52, v52
  v_exp_f32 v53, v53
  v_exp_f32 v54, v54
  v_exp_f32 v55, v55
  v_mfma_f32_32x32x16_bf16 v[64:79], v[20:23], v[4:7], v[32:47]
  ds_read_b128 v[20:23], v9 offset:11264
  v_exp_f32 v56, v56
  v_exp_f32 v57, v57
  v_exp_f32 v58, v58
  v_exp_f32 v59, v59
  s_waitcnt lgkmcnt(2)
  v_smfmac_f32_32x32x32_bf16 v[80:95], v[24:27], v[48:55], v8
  ds_read_b128 v[24:27], v10 offset:1024
  v_exp_f32 v60, v60
  v_exp_f32 v61, v61
  v_exp_f32 v62, v62
  v_exp_f32 v63, v63
  s_cmp_eq_u32 s6, 7
  s_cbranch_scc1 L_w7_130
L_w7b_131:
  s_mov_b32 m0, s95
  s_nop 0
  buffer_load_dwordx4 v2, s[8:11], s94 offen offset:3072 sc1 lds
  v_exp_f32 v64, v64
  v_exp_f32 v65, v65
  v_exp_f32 v66, v66
  v_exp_f32 v67, v67
  s_waitcnt lgkmcnt(2)
  v_smfmac_f32_32x32x32_bf16 v[80:95], v[28:31], v[56:63], v8
  ds_read_b128 v[28:31], v10 offset:1536
  v_exp_f32 v68, v68
  v_exp_f32 v69, v69
  v_exp_f32 v70, v70
  v_exp_f32 v71, v71
  v_mfma_f32_32x32x16_bf16 v[48:63], v[16:19], v[4:7], v[32:47]
  ds_read_b128 v[16:19], v9 offset:12288
  v_exp_f32 v72, v72
  v_exp_f32 v73, v73
  v_exp_f32 v74, v74
  v_exp_f32 v75, v75
  s_waitcnt lgkmcnt(2)
  v_smfmac_f32_32x32x32_bf16 v[80:95], v[24:27], v[64:71], v8
  ds_read_b128 v[24:27], v10 offset:2048
  v_exp_f32 v76, v76
  v_exp_f32 v77, v77
  v_exp_f32 v78, v78
  v_exp_f32 v79, v79
  s_cmp_eq_u32 s6, 7
  s_cbranch_scc1 L_w7_132
L_w7b_133:
  s_add_u32 s94, s98, 4096
  s_and_b32 s56, s6, 3
  s_lshl_b32 s56, s56, 14
  s_add_u32 s95, s56, 4096
  s_mov_b32 m0, s95
  s_nop 0
  buffer_load_dwordx4 v2, s[8:11], s94 offen offset:0 sc1 lds
  v_exp_f32 v48, v48
  v_exp_f32 v49, v49
  v_exp_f32 v50, v50
  v_exp_f32 v51, v51
  s_waitcnt lgkmcnt(2)
  v_smfmac_f32_32x32x32_bf16 v[80:95], v[28:31], v[72:79], v8
  ds_read_b128 v[28:31], v10 offset:2560
  v_exp_f32 v52, v52
  v_exp_f32 v53, v53
  v_exp_f32 v54, v54
  v_exp_f32 v55, v55
  v_mfma_f32_32x32x16_bf16 v[64:79], v[20:23], v[4:7], v[32:47]
  ds_read_b128 v[20:23], v9 offset:13312
  v_exp_f32 v56, v56
  v_exp_f32 v57, v57
  v_exp_f32 v58, v58
  v_exp_f32 v59, v59
  s_waitcnt lgkmcnt(2)
  v_smfmac_f32_32x32x32_bf16 v[80:95], v[24:27], v[48:55], v8
  ds_read_b128 v[24:27], v10 offset:3072
  v_exp_f32 v60, v60
  v_exp_f32 v61, v61
  v_exp_f32 v62, v62
  v_exp_f32 v63, v63
  s_cmp_eq_u32 s6, 7
  s_cbranch_scc1 L_w7_134
L_w7b_135:
  s_mov_b32 m0, s95
  s_nop 0
  buffer_load_dwordx4 v2, s[8:11], s94 offen offset:1024 sc1 lds
  v_exp_f32 v64, v64
  v_exp_f32 v65, v65
  v_exp_f32 v66, v66
  v_exp_f32 v67, v67
  s_waitcnt lgkmcnt(2)
  v_smfmac_f32_32x32x32_bf16 v[80:95], v[28:31], v[56:63], v8
  ds_read_b128 v[28:31], v10 offset:3584
  v_exp_f32 v68, v68
  v_exp_f32 v69, v69
  v_exp_f32 v70, v70
  v_exp_f32 v71, v71
  v_mfma_f32_32x32x16_bf16 v[48:63], v[16:19], v[4:7], v[32:47]
  ds_read_b128 v[16:19], v9 offset:14336
  v_exp_f32 v72, v72
  v_exp_f32 v73, v73
  v_exp_f32 v74, v74
  v_exp_f32 v75, v75
  s_waitcnt lgkmcnt(2)
  v_smfmac_f32_32x32x32_bf16 v[80:95], v[24:27], v[64:71], v8
  ds_read_b128 v[24:27], v10 offset:4096
  v_exp_f32 v76, v76
  v_exp_f32 v77, v77
  v_exp_f32 v78, v78
  v_exp_f32 v79, v79
  s_cmp_eq_u32 s6, 7
  s_cbranch_scc1 L_w7_136
L_w7b_137:
  s_mov_b32 m0, s95
  s_nop 0
  buffer_load_dwordx4 v2, s[8:11], s94 offen offset:2048 sc1 lds
  v_exp_f32 v48, v48
  v_exp_f32 v49, v49
  v_exp_f32 v50, v50
  v_exp_f32 v51, v51
  s_waitcnt lgkmcnt(2)
  v_smfmac_f32_32x32x32_bf16 v[80:95], v[28:31], v[72:79], v8
  ds_read_b128 v[28:31], v10 offset:4608
  v_exp_f32 v52, v52
  v_exp_f32 v53, v53
  v_exp_f32 v54, v54
  v_exp_f32 v55, v55
  v_mfma_f32_32x32x16_bf16 v[64:79], v[20:23], v[4:7], v[32:47]
  ds_read_b128 v[20:23], v9 offset:15360
  v_exp_f32 v56, v56
  v_exp_f32 v57, v57
  v_exp_f32 v58, v58
  v_exp_f32 v59, v59
  s_waitcnt lgkmcnt(2)
  v_smfmac_f32_32x32x32_bf16 v[80:95], v[24:27], v[48:55], v8
  ds_read_b128 v[24:27], v10 offset:5120
  v_exp_f32 v60, v60
  v_exp_f32 v61, v61
  v_exp_f32 v62, v62
  v_exp_f32 v63, v63
  s_cmp_eq_u32 s6, 7
  s_cbranch_scc1 L_w7_138
L_w7b_139:
  s_mov_b32 m0, s95
  s_nop 0
  buffer_load_dwordx4 v2, s[8:11], s94 offen offset:3072 sc1 lds
  v_exp_f32 v64, v64
  v_exp_f32 v65, v65
  v_exp_f32 v66, v66
  v_exp_f32 v67, v67
  s_waitcnt lgkmcnt(2)
  v_smfmac_f32_32x32x32_bf16 v[80:95], v[28:31], v[56:63], v8
  ds_read_b128 v[28:31], v10 offset:5632
  v_exp_f32 v68, v68
  v_exp_f32 v69, v69
  v_exp_f32 v70, v70
  v_exp_f32 v71, v71
  v_mfma_f32_32x32x16_bf16 v[48:63], v[16:19], v[4:7], v[32:47]
  ds_read_b128 v[16:19], v9 offset:16384
  v_exp_f32 v72, v72
  v_exp_f32 v73, v73
  v_exp_f32 v74, v74
  v_exp_f32 v75, v75
  s_waitcnt lgkmcnt(2)
  v_smfmac_f32_32x32x32_bf16 v[80:95], v[24:27], v[64:71], v8
  ds_read_b128 v[24:27], v10 offset:6144
  v_exp_f32 v76, v76
  v_exp_f32 v77, v77
  v_exp_f32 v78, v78
  v_exp_f32 v79, v79
  s_add_u32 s94, s98, 8192
  s_and_b32 s56, s6, 3
  s_lshl_b32 s56, s56, 14
  s_add_u32 s95, s56, 8192
  s_mov_b32 m0, s95
  s_nop 0
  buffer_load_dwordx4 v2, s[8:11], s94 offen offset:0 sc1 lds
  v_exp_f32 v48, v48
  v_exp_f32 v49, v49
  v_exp_f32 v50, v50
  v_exp_f32 v51, v51
  s_waitcnt lgkmcnt(2)
  v_smfmac_f32_32x32x32_bf16 v[80:95], v[28:31], v[72:79], v8
  ds_read_b128 v[28:31], v10 offset:6656
  v_exp_f32 v52, v52
  v_exp_f32 v53, v53
  v_exp_f32 v54, v54
  v_exp_f32 v55, v55
  v_mfma_f32_32x32x16_bf16 v[64:79], v[20:23], v[4:7], v[32:47]
  ds_read_b128 v[20:23], v9 offset:17408
  v_exp_f32 v56, v56
  v_exp_f32 v57, v57
  v_exp_f32 v58, v58
  v_exp_f32 v59, v59
  s_waitcnt lgkmcnt(2)
  v_smfmac_f32_32x32x32_bf16 v[80:95], v[24:27], v[48:55], v8
  ds_read_b128 v[24:27], v10 offset:7168
  v_exp_f32 v60, v60
  v_exp_f32 v61, v61
  v_exp_f32 v62, v62
  v_exp_f32 v63, v63
  s_mov_b32 m0, s95
  s_nop 0
  buffer_load_dwordx4 v2, s[8:11], s94 offen offset:1024 sc1 lds
  v_exp_f32 v64, v64
  v_exp_f32 v65, v65
  v_exp_f32 v66, v66
  v_exp_f32 v67, v67
  s_waitcnt lgkmcnt(2)
  v_smfmac_f32_32x32x32_bf16 v[80:95], v[28:31], v[56:63], v8
  ds_read_b128 v[28:31], v10 offset:7680
  v_add_u32 v10, v10, v11
  v_exp_f32 v68, v68
  v_exp_f32 v69, v69
  v_exp_f32 v70, v70
  v_exp_f32 v71, v71
  v_mfma_f32_32x32x16_bf16 v[48:63], v[16:19], v[4:7], v[32:47]
  ds_read_b128 v[16:19], v9 offset:18432
  v_exp_f32 v72, v72
  v_exp_f32 v73, v73
  v_exp_f32 v74, v74
  v_exp_f32 v75, v75
  s_waitcnt lgkmcnt(2)
  v_smfmac_f32_32x32x32_bf16 v[80:95], v[24:27], v[64:71], v8
  ds_read_b128 v[24:27], v10 offset:0
  v_exp_f32 v76, v76
  v_exp_f32 v77, v77
  v_exp_f32 v78, v78
  v_exp_f32 v79, v79
  s_mov_b32 m0, s95
  s_nop 0
  buffer_load_dwordx4 v2, s[8:11], s94 offen offset:2048 sc1 lds
  v_exp_f32 v48, v48
  v_exp_f32 v49, v49
  v_exp_f32 v50, v50
  v_exp_f32 v51, v51
  s_waitcnt lgkmcnt(2)
  v_smfmac_f32_32x32x32_bf16 v[80:95], v[28:31], v[72:79], v8
  ds_read_b128 v[28:31], v10 offset:512
  v_exp_f32 v52, v52
  v_exp_f32 v53, v53
  v_exp_f32 v54, v54
  v_exp_f32 v55, v55
  v_mfma_f32_32x32x16_bf16 v[64:79], v[20:23], v[4:7], v[32:47]
  ds_read_b128 v[20:23], v9 offset:19456
  v_exp_f32 v56, v56
  v_exp_f32 v57, v57
  v_exp_f32 v58, v58
  v_exp_f32 v59, v59
  s_waitcnt lgkmcnt(2)
  v_smfmac_f32_32x32x32_bf16 v[80:95], v[24:27], v[48:55], v8
  ds_read_b128 v[24:27], v10 offset:1024
  v_exp_f32 v60, v60
  v_exp_f32 v61, v61
  v_exp_f32 v62, v62
  v_exp_f32 v63, v63
  s_mov_b32 m0, s95
  s_nop 0
  buffer_load_dwordx4 v2, s[8:11], s94 offen offset:3072 sc1 lds
  v_exp_f32 v64, v64
  v_exp_f32 v65, v65
  v_exp_f32 v66, v66
  v_exp_f32 v67, v67
  s_waitcnt lgkmcnt(2)
  v_smfmac_f32_32x32x32_bf16 v[80:95], v[28:31], v[56:63], v8
  ds_read_b128 v[28:31], v10 offset:1536
  v_exp_f32 v68, v68
  v_exp_f32 v69, v69
  v_exp_f32 v70, v70
  v_exp_f32 v71, v71
  v_mfma_f32_32x32x16_bf16 v[48:63], v[16:19], v[4:7], v[32:47]
  ds_read_b128 v[16:19], v9 offset:20480
  v_exp_f32 v72, v72
  v_exp_f32 v73, v73
  v_exp_f32 v74, v74
  v_exp_f32 v75, v75
  s_waitcnt lgkmcnt(2)
  v_smfmac_f32_32x32x32_bf16 v[80:95], v[24:27], v[64:71], v8
  ds_read_b128 v[24:27], v10 offset:2048
  v_exp_f32 v76, v76
  v_exp_f32 v77, v77
  v_exp_f32 v78, v78
  v_exp_f32 v79, v79
  s_add_u32 s94, s98, 12288
  s_and_b32 s56, s6, 3
  s_lshl_b32 s56, s56, 14
  s_add_u32 s95, s56, 12288
  s_mov_b32 m0, s95
  s_nop 0
  buffer_load_dwordx4 v2, s[8:11], s94 offen offset:0 sc1 lds
  v_exp_f32 v48, v48
  v_exp_f32 v49, v49
  v_exp_f32 v50, v50
  v_exp_f32 v51, v51
  s_waitcnt lgkmcnt(2)
  v_smfmac_f32_32x32x32_bf16 v[80:95], v[28:31], v[72:79], v8
  ds_read_b128 v[28:31], v10 offset:2560
  v_exp_f32 v52, v52
  v_exp_f32 v53, v53
  v_exp_f32 v54, v54
  v_exp_f32 v55, v55
  v_mfma_f32_32x32x16_bf16 v[64:79], v[20:23], v[4:7], v[32:47]
  ds_read_b128 v[20:23], v9 offset:21504
  v_exp_f32 v56, v56
  v_exp_f32 v57, v57
  v_exp_f32 v58, v58
  v_exp_f32 v59, v59
  s_waitcnt lgkmcnt(2)
  v_smfmac_f32_32x32x32_bf16 v[80:95], v[24:27], v[48:55], v8
  ds_read_b128 v[24:27], v10 offset:3072
  v_exp_f32 v60, v60
  v_exp_f32 v61, v61
  v_exp_f32 v62, v62
  v_exp_f32 v63, v63
  s_mov_b32 m0, s95
  s_nop 0
  buffer_load_dwordx4 v2, s[8:11], s94 offen offset:1024 sc1 lds
  v_exp_f32 v64, v64
  v_exp_f32 v65, v65
  v_exp_f32 v66, v66
  v_exp_f32 v67, v67
  s_waitcnt lgkmcnt(2)
  v_smfmac_f32_32x32x32_bf16 v[80:95], v[28:31], v[56:63], v8
  ds_read_b128 v[28:31], v10 offset:3584
  v_exp_f32 v68, v68
  v_exp_f32 v69, v69
  v_exp_f32 v70, v70
  v_exp_f32 v71, v71
  v_mfma_f32_32x32x16_bf16 v[48:63], v[16:19], v[4:7], v[32:47]
  ds_read_b128 v[16:19], v9 offset:22528
  v_exp_f32 v72, v72
  v_exp_f32 v73, v73
  v_exp_f32 v74, v74
  v_exp_f32 v75, v75
  s_waitcnt lgkmcnt(2)
  v_smfmac_f32_32x32x32_bf16 v[80:95], v[24:27], v[64:71], v8
  ds_read_b128 v[24:27], v10 offset:4096
  v_exp_f32 v76, v76
  v_exp_f32 v77, v77
  v_exp_f32 v78, v78
  v_exp_f32 v79, v79
  s_mov_b32 m0, s95
  s_nop 0
  buffer_load_dwordx4 v2, s[8:11], s94 offen offset:2048 sc1 lds
  v_exp_f32 v48, v48
  v_exp_f32 v49, v49
  v_exp_f32 v50, v50
  v_exp_f32 v51, v51
  s_waitcnt lgkmcnt(2)
  v_smfmac_f32_32x32x32_bf16 v[80:95], v[28:31], v[72:79], v8
  ds_read_b128 v[28:31], v10 offset:4608
  v_exp_f32 v52, v52
  v_exp_f32 v53, v53
  v_exp_f32 v54, v54
  v_exp_f32 v55, v55
  v_mfma_f32_32x32x16_bf16 v[64:79], v[20:23], v[4:7], v[32:47]
  ds_read_b128 v[20:23], v9 offset:23552
  v_exp_f32 v56, v56
  v_exp_f32 v57, v57
  v_exp_f32 v58, v58
  v_exp_f32 v59, v59
  s_waitcnt lgkmcnt(2)
  v_smfmac_f32_32x32x32_bf16 v[80:95], v[24:27], v[48:55], v8
  ds_read_b128 v[24:27], v10 offset:5120
  v_exp_f32 v60, v60
  v_exp_f32 v61, v61
  v_exp_f32 v62, v62
  v_exp_f32 v63, v63
  s_mov_b32 m0, s95
  s_nop 0
  buffer_load_dwordx4 v2, s[8:11], s94 offen offset:3072 sc1 lds
  v_exp_f32 v64, v64
  v_exp_f32 v65, v65
  v_exp_f32 v66, v66
  v_exp_f32 v67, v67
  s_waitcnt lgkmcnt(2)
  v_smfmac_f32_32x32x32_bf16 v[80:95], v[28:31], v[56:63], v8
  ds_read_b128 v[28:31], v10 offset:5632
  v_exp_f32 v68, v68
  v_exp_f32 v69, v69
  v_exp_f32 v70, v70
  v_exp_f32 v71, v71
  v_mfma_f32_32x32x16_bf16 v[48:63], v[16:19], v[4:7], v[32:47]
  ds_read_b128 v[16:19], v9 offset:24576
  v_exp_f32 v72, v72
  v_exp_f32 v73, v73
  v_exp_f32 v74, v74
  v_exp_f32 v75, v75
  s_waitcnt lgkmcnt(2)
  v_smfmac_f32_32x32x32_bf16 v[80:95], v[24:27], v[64:71], v8
  ds_read_b128 v[24:27], v10 offset:6144
  v_exp_f32 v76, v76
  v_exp_f32 v77, v77
  v_exp_f32 v78, v78
  v_exp_f32 v79, v79
  s_add_u32 s56, s97, 125952
  s_lshl_b32 s57, s6, 10
  s_add_u32 m0, s57, 139264
  s_nop 0
  buffer_load_dwordx4 v2, s[8:11], s56 offen sc1 lds
  v_exp_f32 v48, v48
  v_exp_f32 v49, v49
  v_exp_f32 v50, v50
  v_exp_f32 v51, v51
  s_waitcnt lgkmcnt(2)
  v_smfmac_f32_32x32x32_bf16 v[80:95], v[28:31], v[72:79], v8
  ds_read_b128 v[28:31], v10 offset:6656
  v_exp_f32 v52, v52
  v_exp_f32 v53, v53
  v_exp_f32 v54, v54
  v_exp_f32 v55, v55
  v_mfma_f32_32x32x16_bf16 v[64:79], v[20:23], v[4:7], v[32:47]
  ds_read_b128 v[20:23], v9 offset:25600
  v_exp_f32 v56, v56
  v_exp_f32 v57, v57
  v_exp_f32 v58, v58
  v_exp_f32 v59, v59
  s_waitcnt lgkmcnt(2)
  v_smfmac_f32_32x32x32_bf16 v[80:95], v[24:27], v[48:55], v8
  ds_read_b128 v[24:27], v10 offset:7168
  v_exp_f32 v60, v60
  v_exp_f32 v61, v61
  v_exp_f32 v62, v62
  v_exp_f32 v63, v63
  s_add_u32 s56, s97, 126976
  s_lshl_b32 s57, s6, 10
  s_add_u32 m0, s57, 147456
  s_nop 0
  buffer_load_dwordx4 v2, s[8:11], s56 offen sc1 lds
  v_exp_f32 v64, v64
  v_exp_f32 v65, v65
  v_exp_f32 v66, v66
  v_exp_f32 v67, v67
  s_waitcnt lgkmcnt(2)
  v_smfmac_f32_32x32x32_bf16 v[80:95], v[28:31], v[56:63], v8
  ds_read_b128 v[28:31], v10 offset:7680
  v_add_u32 v10, v10, v11
  v_exp_f32 v68, v68
  v_exp_f32 v69, v69
  v_exp_f32 v70, v70
  v_exp_f32 v71, v71
  v_mfma_f32_32x32x16_bf16 v[48:63], v[16:19], v[4:7], v[32:47]
  ds_read_b128 v[16:19], v9 offset:26624
  v_exp_f32 v72, v72
  v_exp_f32 v73, v73
  v_exp_f32 v74, v74
  v_exp_f32 v75, v75
  s_waitcnt lgkmcnt(2)
  v_smfmac_f32_32x32x32_bf16 v[80:95], v[24:27], v[64:71], v8
  ds_read_b128 v[24:27], v10 offset:0
  v_exp_f32 v76, v76
  v_exp_f32 v77, v77
  v_exp_f32 v78, v78
  v_exp_f32 v79, v79
  v_and_b32 v12, 31, v1
  v_lshrrev_b32 v13, 5, v1
  s_lshl_b32 s56, s4, 6
  s_lshl_b32 s57, s26, 5
  s_add_u32 s56, s56, s57
  v_add_u32 v3, s56, v12
  v_lshlrev_b32 v3, 10, v3
  v_lshl_add_u32 v3, v13, 3, v3
  s_lshl_b32 s56, s5, 7
  s_lshl_b32 s57, s24, 6
  s_add_u32 s56, s56, s57
  s_lshl_b32 s57, s25, 5
  s_add_u32 s92, s56, s57
  buffer_load_dwordx2 v[12:13], v3, s[12:15], s92 offen
  buffer_load_dwordx2 v[14:15], v3, s[12:15], s92 offen offset:16
  v_exp_f32 v48, v48
  v_exp_f32 v49, v49
  v_exp_f32 v50, v50
  v_exp_f32 v51, v51
  s_waitcnt lgkmcnt(2)
  v_smfmac_f32_32x32x32_bf16 v[80:95], v[28:31], v[72:79], v8
  ds_read_b128 v[28:31], v10 offset:512
  v_exp_f32 v52, v52
  v_exp_f32 v53, v53
  v_exp_f32 v54, v54
  v_exp_f32 v55, v55
  v_mfma_f32_32x32x16_bf16 v[64:79], v[20:23], v[4:7], v[32:47]
  ds_read_b128 v[20:23], v9 offset:27648
  v_exp_f32 v56, v56
  v_exp_f32 v57, v57
  v_exp_f32 v58, v58
  v_exp_f32 v59, v59
  s_waitcnt lgkmcnt(2)
  v_smfmac_f32_32x32x32_bf16 v[80:95], v[24:27], v[48:55], v8
  ds_read_b128 v[24:27], v10 offset:1024
  v_exp_f32 v60, v60
  v_exp_f32 v61, v61
  v_exp_f32 v62, v62
  v_exp_f32 v63, v63
  s_waitcnt vmcnt(4)
  v_mov_b32 v0, 161516
  s_mov_b64 exec, 2
  ds_add_u32 v0, v1
  s_mov_b64 exec, -1
  v_exp_f32 v64, v64
  v_exp_f32 v65, v65
  v_exp_f32 v66, v66
  v_exp_f32 v67, v67
  s_waitcnt lgkmcnt(2)
  v_smfmac_f32_32x32x32_bf16 v[80:95], v[28:31], v[56:63], v8
  ds_read_b128 v[28:31], v10 offset:1536
  v_exp_f32 v68, v68
  v_exp_f32 v69, v69
  v_exp_f32 v70, v70
  v_exp_f32 v71, v71
  v_mfma_f32_32x32x16_bf16 v[48:63], v[16:19], v[4:7], v[32:47]
  ds_read_b128 v[16:19], v9 offset:28672
  v_exp_f32 v72, v72
  v_exp_f32 v73, v73
  v_exp_f32 v74, v74
  v_exp_f32 v75, v75
  s_waitcnt lgkmcnt(2)
  v_smfmac_f32_32x32x32_bf16 v[80:95], v[24:27], v[64:71], v8
  ds_read_b128 v[24:27], v10 offset:2048
  v_exp_f32 v76, v76
  v_exp_f32 v77, v77
  v_exp_f32 v78, v78
  v_exp_f32 v79, v79
  v_exp_f32 v48, v48
  v_exp_f32 v49, v49
  v_exp_f32 v50, v50
  v_exp_f32 v51, v51
  s_waitcnt lgkmcnt(2)
  v_smfmac_f32_32x32x32_bf16 v[80:95], v[28:31], v[72:79], v8
  ds_read_b128 v[28:31], v10 offset:2560
  v_exp_f32 v52, v52
  v_exp_f32 v53, v53
  v_exp_f32 v54, v54
  v_exp_f32 v55, v55
  v_mfma_f32_32x32x16_bf16 v[64:79], v[20:23], v[4:7], v[32:47]
  ds_read_b128 v[20:23], v9 offset:29696
  v_exp_f32 v56, v56
  v_exp_f32 v57, v57
  v_exp_f32 v58, v58
  v_exp_f32 v59, v59
  s_waitcnt lgkmcnt(2)
  v_smfmac_f32_32x32x32_bf16 v[80:95], v[24:27], v[48:55], v8
  ds_read_b128 v[24:27], v10 offset:3072
  v_exp_f32 v60, v60
  v_exp_f32 v61, v61
  v_exp_f32 v62, v62
  v_exp_f32 v63, v63
  v_exp_f32 v64, v64
  v_exp_f32 v65, v65
  v_exp_f32 v66, v66
  v_exp_f32 v67, v67
  s_waitcnt lgkmcnt(2)
  v_smfmac_f32_32x32x32_bf16 v[80:95], v[28:31], v[56:63], v8
  ds_read_b128 v[28:31], v10 offset:3584
  v_exp_f32 v68, v68
  v_exp_f32 v69, v69
  v_exp_f32 v70, v70
  v_exp_f32 v71, v71
  v_mfma_f32_32x32x16_bf16 v[48:63], v[16:19], v[4:7], v[32:47]
  ds_read_b128 v[16:19], v9 offset:30720
  v_exp_f32 v72, v72
  v_exp_f32 v73, v73
  v_exp_f32 v74, v74
  v_exp_f32 v75, v75
  s_waitcnt lgkmcnt(2)
  v_smfmac_f32_32x32x32_bf16 v[80:95], v[24:27], v[64:71], v8
  ds_read_b128 v[24:27], v10 offset:4096
  v_exp_f32 v76, v76
  v_exp_f32 v77, v77
  v_exp_f32 v78, v78
  v_exp_f32 v79, v79
  v_exp_f32 v48, v48
  v_exp_f32 v49, v49
  v_exp_f32 v50, v50
  v_exp_f32 v51, v51
  s_waitcnt lgkmcnt(2)
  v_smfmac_f32_32x32x32_bf16 v[80:95], v[28:31], v[72:79], v8
  ds_read_b128 v[28:31], v10 offset:4608
  v_exp_f32 v52, v52
  v_exp_f32 v53, v53
  v_exp_f32 v54, v54
  v_exp_f32 v55, v55
  v_mfma_f32_32x32x16_bf16 v[64:79], v[20:23], v[4:7], v[32:47]
  ds_read_b128 v[20:23], v9 offset:31744
  v_exp_f32 v56, v56
  v_exp_f32 v57, v57
  v_exp_f32 v58, v58
  v_exp_f32 v59, v59
  s_waitcnt lgkmcnt(2)
  v_smfmac_f32_32x32x32_bf16 v[80:95], v[24:27], v[48:55], v8
  ds_read_b128 v[24:27], v10 offset:5120
  v_exp_f32 v60, v60
  v_exp_f32 v61, v61
  v_exp_f32 v62, v62
  v_exp_f32 v63, v63
  v_exp_f32 v64, v64
  v_exp_f32 v65, v65
  v_exp_f32 v66, v66
  v_exp_f32 v67, v67
  s_waitcnt lgkmcnt(2)
  v_smfmac_f32_32x32x32_bf16 v[80:95], v[28:31], v[56:63], v8
  ds_read_b128 v[28:31], v10 offset:5632
  v_exp_f32 v68, v68
  v_exp_f32 v69, v69
  v_exp_f32 v70, v70
  v_exp_f32 v71, v71
  v_mfma_f32_32x32x16_bf16 v[48:63], v[16:19], v[4:7], v[32:47]
  v_exp_f32 v72, v72
  v_exp_f32 v73, v73
  v_exp_f32 v74, v74
  v_exp_f32 v75, v75
  s_waitcnt lgkmcnt(1)
  v_smfmac_f32_32x32x32_bf16 v[80:95], v[24:27], v[64:71], v8
  ds_read_b128 v[24:27], v10 offset:6144
  v_exp_f32 v76, v76
  v_exp_f32 v77, v77
  v_exp_f32 v78, v78
  v_exp_f32 v79, v79
  s_mov_b32 s59, 16384
L_lw_140:
  v_mov_b32 v0, 161508
  ds_read_b32 v0, v0
  s_waitcnt lgkmcnt(0)
  v_readfirstlane_b32 s61, v0
  s_nop 0
  s_cmp_ge_u32 s61, 1
  s_cbranch_scc0 L_lw_140_r
L_lw_140_ok:
  v_exp_f32 v48, v48
  v_exp_f32 v49, v49
  v_exp_f32 v50, v50
  v_exp_f32 v51, v51
  s_waitcnt lgkmcnt(1)
  v_smfmac_f32_32x32x32_bf16 v[80:95], v[28:31], v[72:79], v8
  ds_read_b128 v[28:31], v10 offset:6656
  v_exp_f32 v52, v52
  v_exp_f32 v53, v53
  v_exp_f32 v54, v54
  v_exp_f32 v55, v55
  v_mfma_f32_32x32x16_bf16 v[64:79], v[20:23], v[4:7], v[32:47]
  v_exp_f32 v56, v56
  v_exp_f32 v57, v57
  v_exp_f32 v58, v58
  v_exp_f32 v59, v59
  s_waitcnt lgkmcnt(1)
  v_smfmac_f32_32x32x32_bf16 v[80:95], v[24:27], v[48:55], v8
  ds_read_b128 v[24:27], v10 offset:7168
  v_exp_f32 v60, v60
  v_exp_f32 v61, v61
  v_exp_f32 v62, v62
  v_exp_f32 v63, v63
  s_nop 0
  v_exp_f32 v64, v64
  v_exp_f32 v65, v65
  v_exp_f32 v66, v66
  v_exp_f32 v67, v67
  s_waitcnt lgkmcnt(1)
  v_smfmac_f32_32x32x32_bf16 v[80:95], v[28:31], v[56:63], v8
  ds_read_b128 v[28:31], v10 offset:7680
  v_exp_f32 v68, v68
  v_exp_f32 v69, v69
  v_exp_f32 v70, v70
  v_exp_f32 v71, v71
  v_exp_f32 v72, v72
  v_exp_f32 v73, v73
  v_exp_f32 v74, v74
  v_exp_f32 v75, v75
  s_waitcnt lgkmcnt(1)
  v_smfmac_f32_32x32x32_bf16 v[80:95], v[24:27], v[64:71], v8
  v_exp_f32 v76, v76
  v_exp_f32 v77, v77
  v_exp_f32 v78, v78
  v_exp_f32 v79, v79
  s_setprio 0
  s_waitcnt lgkmcnt(0)
  v_smfmac_f32_32x32x32_bf16 v[80:95], v[28:31], v[72:79], v8
L_loop_done:
  s_nop 7
  s_nop 7
  v_rcp_f32 v16, v88
  s_nop 0
  v_mul_f32 v80, v80, v16
  v_mul_f32 v81, v81, v16
  v_mul_f32 v82, v82, v16
  v_mul_f32 v83, v83, v16
  v_mul_f32 v84, v84, v16
  v_mul_f32 v85, v85, v16
  v_mul_f32 v86, v86, v16
  v_mul_f32 v87, v87, v16
  v_cvt_pk_bf16_f32 v20, v80, v81
  v_cvt_pk_bf16_f32 v21, v82, v83
  v_cvt_pk_bf16_f32 v22, v84, v85
  v_cvt_pk_bf16_f32 v23, v86, v87
  v_min_u32 v20, -2, v20
  v_min_u32 v21, -2, v21
  v_min_u32 v22, -2, v22
  v_min_u32 v23, -2, v23
  s_add_u32 s56, s99, 6291456
  s_cmp_eq_u32 s90, 1
  s_cbranch_scc0 L_hs_141
  buffer_store_dwordx4 v[20:23], v2, s[8:11], s56 offen
L_hd_142:
  v_mov_b32 v0, 161524
  s_mov_b64 exec, 2
  ds_add_u32 v0, v1
  s_mov_b64 exec, -1
  s_cmp_eq_u32 s6, 7
  s_cbranch_scc1 L_cs_143
  v_and_b32 v50, 15, v1
  v_bfe_u32 v51, v1, 4, 1
  v_cmp_eq_u32 vcc, v50, v51
  v_mov_b32 v51, 0x3f803f80
  s_nop 0
  v_cndmask_b32 v48, 0, v51, vcc
  v_cndmask_b32 v49, 0, v51, vcc
  v_cndmask_b32 v50, 0, v51, vcc
  v_cndmask_b32 v51, 0, v51, vcc
  s_nop 1
  v_mfma_f32_16x16x32_bf16 v[52:55], v[128:131], v[48:51], 0
  v_mfma_f32_16x16x32_bf16 v[56:59], v[132:135], v[48:51], 0
  v_mfma_f32_16x16x32_bf16 v[60:63], v[136:139], v[48:51], 0
  v_mfma_f32_16x16x32_bf16 v[44:47], v[140:143], v[48:51], 0
  v_mfma_f32_16x16x32_bf16 v[52:55], v[144:147], v[48:51], v[52:55]
  v_mfma_f32_16x16x32_bf16 v[56:59], v[148:151], v[48:51], v[56:59]
  v_mfma_f32_16x16x32_bf16 v[60:63], v[152:155], v[48:51], v[60:63]
  v_mfma_f32_16x16x32_bf16 v[44:47], v[156:159], v[48:51], v[44:47]
  v_mfma_f32_16x16x32_bf16 v[52:55], v[160:163], v[48:51], v[52:55]
  v_mfma_f32_16x16x32_bf16 v[56:59], v[164:167], v[48:51], v[56:59]
  v_mfma_f32_16x16x32_bf16 v[60:63], v[168:171], v[48:51], v[60:63]
  v_mfma_f32_16x16x32_bf16 v[44:47], v[172:175], v[48:51], v[44:47]
  v_mfma_f32_16x16x32_bf16 v[52:55], v[176:179], v[48:51], v[52:55]
  v_mfma_f32_16x16x32_bf16 v[56:59], v[180:183], v[48:51], v[56:59]
  v_mfma_f32_16x16x32_bf16 v[60:63], v[184:187], v[48:51], v[60:63]
  v_mfma_f32_16x16x32_bf16 v[44:47], v[188:191], v[48:51], v[44:47]
  v_mfma_f32_16x16x32_bf16 v[52:55], v[192:195], v[48:51], v[52:55]
  v_mfma_f32_16x16x32_bf16 v[56:59], v[196:199], v[48:51], v[56:59]
  v_mfma_f32_16x16x32_bf16 v[60:63], v[200:203], v[48:51], v[60:63]
  v_mfma_f32_16x16x32_bf16 v[44:47], v[204:207], v[48:51], v[44:47]
  v_mfma_f32_16x16x32_bf16 v[52:55], v[208:211], v[48:51], v[52:55]
  v_mfma_f32_16x16x32_bf16 v[56:59], v[212:215], v[48:51], v[56:59]
  v_mfma_f32_16x16x32_bf16 v[60:63], v[216:219], v[48:51], v[60:63]
  v_mfma_f32_16x16x32_bf16 v[44:47], v[220:223], v[48:51], v[44:47]
  v_mfma_f32_16x16x32_bf16 v[52:55], v[224:227], v[48:51], v[52:55]
  v_mfma_f32_16x16x32_bf16 v[56:59], v[228:231], v[48:51], v[56:59]
  v_mfma_f32_16x16x32_bf16 v[60:63], v[232:235], v[48:51], v[60:63]
  v_mfma_f32_16x16x32_bf16 v[44:47], v[236:239], v[48:51], v[44:47]
  v_mfma_f32_16x16x32_bf16 v[52:55], v[240:243], v[48:51], v[52:55]
  v_mfma_f32_16x16x32_bf16 v[56:59], v[244:247], v[48:51], v[56:59]
  v_mfma_f32_16x16x32_bf16 v[60:63], v[248:251], v[48:51], v[60:63]
  v_mfma_f32_16x16x32_bf16 v[44:47], v[252:255], v[48:51], v[44:47]
  v_lshrrev_b32 v40, 4, v1
  v_lshlrev_b32 v40, 4, v40
  v_and_b32 v41, 15, v1
  v_lshl_add_u32 v40, v41, 6, v40
  s_lshl_b32 s56, s6, 8
  s_add_u32 s56, s56, 162048
  v_add_u32 v40, s56, v40
  v_add_f32 v52, v52, v56
  v_add_f32 v53, v53, v57
  v_add_f32 v54, v54, v58
  v_add_f32 v55, v55, v59
  v_add_f32 v60, v60, v44
  v_add_f32 v61, v61, v45
  v_add_f32 v62, v62, v46
  v_add_f32 v63, v63, v47
  v_add_f32 v52, v52, v60
  v_add_f32 v53, v53, v61
  v_add_f32 v54, v54, v62
  v_add_f32 v55, v55, v63
  s_mov_b32 exec_lo, 0x30003
  s_mov_b32 exec_hi, 0x30003
  ds_write_b128 v40, v[52:55]
  s_mov_b64 exec, -1
L_cs_143:
  s_lshl_b32 s54, s4, 16
  s_lshl_b32 s55, s26, 15
  s_add_u32 s54, s54, s55
  s_lshl_b32 s55, s24, 4
  s_add_u32 s55, s55, s25
  s_lshl_b32 s55, s55, 10
  s_add_u32 s54, s54, s55
  s_add_u32 s54, s54, 6291456
  s_add_u32 s60, s54, 0
  buffer_load_dwordx4 v[64:67], v2, s[8:11], s60 offen offset:0 sc1
  buffer_load_dwordx4 v[68:71], v2, s[8:11], s60 offen offset:2048 sc1
  s_add_u32 s60, s54, 4096
  buffer_load_dwordx4 v[72:75], v2, s[8:11], s60 offen offset:0 sc1
  buffer_load_dwordx4 v[76:79], v2, s[8:11], s60 offen offset:2048 sc1
  s_add_u32 s60, s54, 8192
  buffer_load_dwordx4 v[80:83], v2, s[8:11], s60 offen offset:0 sc1
  buffer_load_dwordx4 v[84:87], v2, s[8:11], s60 offen offset:2048 sc1
  s_add_u32 s60, s54, 12288
  buffer_load_dwordx4 v[88:91], v2, s[8:11], s60 offen offset:0 sc1
  buffer_load_dwordx4 v[92:95], v2, s[8:11], s60 offen offset:2048 sc1
  s_lshl_b32 s3, s26, 2
  s_mul_i32 s3, s3, 3
  s_sub_u32 s56, s100, 1
  s_and_b32 s56, s56, 3
  s_add_u32 s56, s56, s3
  s_add_u32 s56, s56, 0
  s_lshl_b32 s56, s56, 11
  s_add_u32 s56, s56, 81920
  v_add_u32 v4, s56, v2
  s_sub_u32 s56, s100, 2
  s_and_b32 s56, s56, 3
  s_add_u32 s56, s56, s3
  s_add_u32 s56, s56, 3
  s_lshl_b32 s56, s56, 11
  s_add_u32 s56, s56, 81920
  v_add_u32 v5, s56, v2
  s_sub_u32 s56, s100, 3
  s_and_b32 s56, s56, 3
  s_add_u32 s56, s56, s3
  s_add_u32 s56, s56, 6
  s_lshl_b32 s56, s56, 11
  s_add_u32 s56, s56, 81920
  v_add_u32 v6, s56, v2
  s_sub_u32 s56, s100, 4
  s_and_b32 s56, s56, 3
  s_add_u32 s56, s56, s3
  s_add_u32 s56, s56, 9
  s_lshl_b32 s56, s56, 11
  s_add_u32 s56, s56, 81920
  v_add_u32 v7, s56, v2
  s_mov_b32 s59, 16384
L_lw_144:
  v_mov_b32 v0, 161524
  ds_read_b32 v0, v0
  s_waitcnt lgkmcnt(0)
  v_readfirstlane_b32 s61, v0
  s_nop 0
  s_cmp_ge_u32 s61, 8
  s_cbranch_scc0 L_lw_144_r
L_lw_144_ok:
  s_mul_i32 s57, s100, 3
  s_add_u32 s57, s57, s3
  s_lshl_b32 s57, s57, 11
  s_add_u32 s57, s57, 81920
  v_add_u32 v8, s57, v2
  s_mov_b32 s59, 16384
L_lw_145:
  v_mov_b32 v0, 161516
  ds_read_b32 v0, v0
  s_waitcnt lgkmcnt(0)
  v_readfirstlane_b32 s61, v0
  s_nop 0
  s_cmp_ge_u32 s61, 4
  s_cbranch_scc0 L_lw_145_r
L_lw_145_ok:
  s_mov_b32 s59, 16384
  v_add_u32 v10, s55, v2
  ds_read_b128 v[48:51], v10 offset:0
  ds_read_b128 v[52:55], v10 offset:32768
  ds_read_b128 v[56:59], v10 offset:2048
  ds_read_b128 v[60:63], v10 offset:34816
  s_setprio 1
  s_waitcnt vmcnt(7)
L_o_c0:
  v_max3_u32 v11, v64, v65, v66
  v_max_u32 v11, v11, v67
  v_cmp_eq_u32 vcc, -1, v11
  s_cbranch_vccnz L_o_r0
L_o_k0:
  s_waitcnt lgkmcnt(3)
  v_mfma_f32_32x32x16_bf16 v[16:31], v[48:51], v[64:67], 0
  ds_read_b128 v[48:51], v10 offset:4096
  s_waitcnt lgkmcnt(3)
  v_mfma_f32_32x32x16_bf16 v[32:47], v[52:55], v[64:67], 0
  ds_read_b128 v[52:55], v10 offset:36864
  s_waitcnt vmcnt(6)
L_o_c1:
  v_max3_u32 v11, v68, v69, v70
  v_max_u32 v11, v11, v71
  v_cmp_eq_u32 vcc, -1, v11
  s_cbranch_vccnz L_o_r1
L_o_k1:
  s_waitcnt lgkmcnt(3)
  v_mfma_f32_32x32x16_bf16 v[16:31], v[56:59], v[68:71], v[16:31]
  ds_read_b128 v[56:59], v10 offset:6144
  s_waitcnt lgkmcnt(3)
  v_mfma_f32_32x32x16_bf16 v[32:47], v[60:63], v[68:71], v[32:47]
  ds_read_b128 v[60:63], v10 offset:38912
  s_waitcnt vmcnt(5)
L_o_c2:
  v_max3_u32 v11, v72, v73, v74
  v_max_u32 v11, v11, v75
  v_cmp_eq_u32 vcc, -1, v11
  s_cbranch_vccnz L_o_r2
L_o_k2:
  s_waitcnt lgkmcnt(3)
  v_mfma_f32_32x32x16_bf16 v[16:31], v[48:51], v[72:75], v[16:31]
  ds_read_b128 v[48:51], v10 offset:8192
  s_waitcnt lgkmcnt(3)
  v_mfma_f32_32x32x16_bf16 v[32:47], v[52:55], v[72:75], v[32:47]
  ds_read_b128 v[52:55], v10 offset:40960
  s_waitcnt vmcnt(4)
L_o_c3:
  v_max3_u32 v11, v76, v77, v78
  v_max_u32 v11, v11, v79
  v_cmp_eq_u32 vcc, -1, v11
  s_cbranch_vccnz L_o_r3
L_o_k3:
  s_waitcnt lgkmcnt(3)
  v_mfma_f32_32x32x16_bf16 v[16:31], v[56:59], v[76:79], v[16:31]
  ds_read_b128 v[56:59], v10 offset:10240
  s_waitcnt lgkmcnt(3)
  v_mfma_f32_32x32x16_bf16 v[32:47], v[60:63], v[76:79], v[32:47]
  ds_read_b128 v[60:63], v10 offset:43008
  s_waitcnt vmcnt(3)
L_o_c4:
  v_max3_u32 v11, v80, v81, v82
  v_max_u32 v11, v11, v83
  v_cmp_eq_u32 vcc, -1, v11
  s_cbranch_vccnz L_o_r4
L_o_k4:
  s_waitcnt lgkmcnt(3)
  v_mfma_f32_32x32x16_bf16 v[16:31], v[48:51], v[80:83], v[16:31]
  ds_read_b128 v[48:51], v10 offset:12288
  s_waitcnt lgkmcnt(3)
  v_mfma_f32_32x32x16_bf16 v[32:47], v[52:55], v[80:83], v[32:47]
  ds_read_b128 v[52:55], v10 offset:45056
  s_waitcnt vmcnt(2)
L_o_c5:
  v_max3_u32 v11, v84, v85, v86
  v_max_u32 v11, v11, v87
  v_cmp_eq_u32 vcc, -1, v11
  s_cbranch_vccnz L_o_r5
L_o_k5:
  s_waitcnt lgkmcnt(3)
  v_mfma_f32_32x32x16_bf16 v[16:31], v[56:59], v[84:87], v[16:31]
  ds_read_b128 v[56:59], v10 offset:14336
  s_waitcnt lgkmcnt(3)
  v_mfma_f32_32x32x16_bf16 v[32:47], v[60:63], v[84:87], v[32:47]
  ds_read_b128 v[60:63], v10 offset:47104
  s_waitcnt vmcnt(1)
L_o_c6:
  v_max3_u32 v11, v88, v89, v90
  v_max_u32 v11, v11, v91
  v_cmp_eq_u32 vcc, -1, v11
  s_cbranch_vccnz L_o_r6
L_o_k6:
  s_waitcnt lgkmcnt(3)
  v_mfma_f32_32x32x16_bf16 v[16:31], v[48:51], v[88:91], v[16:31]
  s_waitcnt lgkmcnt(2)
  v_mfma_f32_32x32x16_bf16 v[32:47], v[52:55], v[88:91], v[32:47]
  s_waitcnt vmcnt(0)
L_o_c7:
  v_max3_u32 v11, v92, v93, v94
  v_max_u32 v11, v11, v95
  v_cmp_eq_u32 vcc, -1, v11
  s_cbranch_vccnz L_o_r7
L_o_k7:
  s_waitcnt lgkmcnt(1)
  v_mfma_f32_32x32x16_bf16 v[16:31], v[56:59], v[92:95], v[16:31]
  s_waitcnt lgkmcnt(0)
  v_mfma_f32_32x32x16_bf16 v[32:47], v[60:63], v[92:95], v[32:47]
  s_setprio 0
  s_nop 7
  s_nop 3
  s_cmp_eq_u32 s100, 0
  s_cbranch_scc1 L_own_146
  ds_write_b128 v4, v[16:19]
  ds_write_b128 v4, v[20:23] offset:1024
L_nxt_147:
  s_cmp_eq_u32 s100, 1
  s_cbranch_scc1 L_own_148
  ds_write_b128 v5, v[32:35]
  ds_write_b128 v5, v[36:39] offset:1024
L_nxt_149:
  s_cmp_eq_u32 s100, 2
  s_cbranch_scc1 L_own_150
  ds_write_b128 v6, v[24:27]
  ds_write_b128 v6, v[28:31] offset:1024
L_nxt_151:
  s_cmp_eq_u32 s100, 3
  s_cbranch_scc1 L_own_152
  ds_write_b128 v7, v[40:43]
  ds_write_b128 v7, v[44:47] offset:1024
L_nxt_153:
  s_cmp_lt_u32 s6, 4
  s_cbranch_scc0 L_w2b_skip
  s_add_u32 s56, s97, 8192
  buffer_load_dwordx4 v[64:67], v2, s[8:11], s56 offen offset:0 sc1
  s_add_u32 s56, s97, 8192
  buffer_load_dwordx4 v[68:71], v2, s[8:11], s56 offen offset:1024 sc1
  s_add_u32 s56, s97, 8192
  buffer_load_dwordx4 v[72:75], v2, s[8:11], s56 offen offset:2048 sc1
  s_add_u32 s56, s97, 8192
  buffer_load_dwordx4 v[76:79], v2, s[8:11], s56 offen offset:3072 sc1
  s_add_u32 s56, s97, 12288
  buffer_load_dwordx4 v[80:83], v2, s[8:11], s56 offen offset:0 sc1
  s_add_u32 s56, s97, 12288
  buffer_load_dwordx4 v[84:87], v2, s[8:11], s56 offen offset:1024 sc1
  s_add_u32 s56, s97, 114688
  buffer_load_dwordx4 v[88:91], v2, s[8:11], s56 offen offset:0 sc1
  s_add_u32 s56, s97, 114688
  buffer_load_dwordx4 v[92:95], v2, s[8:11], s56 offen offset:1024 sc1
L_w2b_skip:
  s_waitcnt lgkmcnt(0)
  s_barrier
  ds_read_b128 v[16:19], v8 offset:0
  ds_read_b128 v[20:23], v8 offset:1024
  ds_read_b128 v[24:27], v8 offset:2048
  ds_read_b128 v[28:31], v8 offset:3072
  ds_read_b128 v[32:35], v8 offset:4096
  ds_read_b128 v[36:39], v8 offset:5120
  s_add_u32 s56, s97, 116736
  s_lshl_b32 s57, s6, 10
  s_add_u32 m0, s57, 65536
  s_nop 0
  buffer_load_dwordx4 v2, s[8:11], s56 offen sc1 lds
  s_add_u32 s56, s97, 117760
  s_lshl_b32 s57, s6, 10
  s_add_u32 m0, s57, 73728
  s_nop 0
  buffer_load_dwordx4 v2, s[8:11], s56 offen sc1 lds
  v_lshlrev_b32 v56, 16, v12
  v_and_b32 v57, 0xffff0000, v12
  v_lshlrev_b32 v58, 16, v13
  v_and_b32 v59, 0xffff0000, v13
  v_lshlrev_b32 v60, 16, v14
  v_and_b32 v61, 0xffff0000, v14
  v_lshlrev_b32 v62, 16, v15
  v_and_b32 v63, 0xffff0000, v15
  v_add_f32 v48, v48, v56
  v_add_f32 v49, v49, v57
  v_add_f32 v50, v50, v58
  v_add_f32 v51, v51, v59
  v_add_f32 v52, v52, v60
  v_add_f32 v53, v53, v61
  v_add_f32 v54, v54, v62
  v_add_f32 v55, v55, v63
  s_waitcnt lgkmcnt(2)
  v_add_f32 v16, v16, v24
  v_add_f32 v17, v17, v25
  v_add_f32 v18, v18, v26
  v_add_f32 v19, v19, v27
  v_add_f32 v20, v20, v28
  v_add_f32 v21, v21, v29
  v_add_f32 v22, v22, v30
  v_add_f32 v23, v23, v31
  v_add_f32 v16, v16, v48
  v_add_f32 v17, v17, v49
  v_add_f32 v18, v18, v50
  v_add_f32 v19, v19, v51
  v_add_f32 v20, v20, v52
  v_add_f32 v21, v21, v53
  v_add_f32 v22, v22, v54
  v_add_f32 v23, v23, v55
  s_waitcnt lgkmcnt(0)
  v_add_f32 v16, v16, v32
  v_add_f32 v17, v17, v33
  v_add_f32 v18, v18, v34
  v_add_f32 v19, v19, v35
  v_add_f32 v20, v20, v36
  v_add_f32 v21, v21, v37
  v_add_f32 v22, v22, v38
  v_add_f32 v23, v23, v39
  v_cvt_pk_bf16_f32 v4, v16, v17
  v_cvt_pk_bf16_f32 v5, v18, v19
  v_cvt_pk_bf16_f32 v6, v20, v21
  v_cvt_pk_bf16_f32 v7, v22, v23
  v_min_u32 v4, -2, v4
  v_min_u32 v5, -2, v5
  v_min_u32 v6, -2, v6
  v_min_u32 v7, -2, v7
  s_add_u32 s56, s99, 8388608
  s_cmp_eq_u32 s90, 1
  s_cbranch_scc0 L_hs_154
  buffer_store_dwordx4 v[4:7], v2, s[8:11], s56 offen
L_hd_155:
  v_pk_mul_f32 v[24:25], v[16:17], v[16:17]
  v_pk_add_f32 v[26:27], v[16:17], v[18:19]
  v_pk_fma_f32 v[24:25], v[18:19], v[18:19], v[24:25]
  v_pk_add_f32 v[28:29], v[20:21], v[22:23]
  v_pk_fma_f32 v[24:25], v[20:21], v[20:21], v[24:25]
  v_pk_add_f32 v[26:27], v[26:27], v[28:29]
  v_pk_fma_f32 v[24:25], v[22:23], v[22:23], v[24:25]
  s_lshl_b32 s56, s4, 1
  s_add_u32 s56, s56, s26
  v_add_f32 v26, v26, v27
  s_lshl_b32 s56, s56, 3
  s_add_u32 s56, s56, s5
  v_add_f32 v24, v24, v25
  s_lshl_b32 s56, s56, 2
  v_lshrrev_b32 v25, 2, v2
  s_add_u32 s56, s56, s100
  s_lshl_b32 s56, s56, 8
  v_permlane32_swap_b32 v26, v24
  s_add_u32 s56, s56, 17825792
  v_add_f32 v26, v26, v24
  v_min_u32 v26, -2, v26
  s_cmp_eq_u32 s90, 1
  s_cbranch_scc0 L_hs_156
  buffer_store_dword v26, v25, s[8:11], s56 offen
L_hd_157:
  s_lshl_b32 s54, s4, 16
  s_lshl_b32 s55, s6, 12
  s_add_u32 s54, s54, s55
  s_add_u32 s54, s54, 8388608
  s_mov_b32 s93, s54
  v_and_b32 v12, 31, v1
  v_lshlrev_b32 v12, 3, v12
  s_lshl_b32 s3, s6, 12
  v_add_u32 v56, s3, v2
  s_barrier
  s_add_u32 s60, s93, 0
  s_lshl_b32 m0, s6, 12
  s_nop 0
  buffer_load_dwordx4 v2, s[8:11], s60 offen offset:0 sc1 lds
  buffer_load_dwordx4 v2, s[8:11], s60 offen offset:1024 sc1 lds
  buffer_load_dwordx4 v2, s[8:11], s60 offen offset:2048 sc1 lds
  buffer_load_dwordx4 v2, s[8:11], s60 offen offset:3072 sc1 lds
  s_cmp_eq_u32 s6, 7
  s_cbranch_scc1 L_h_w7a
  s_mul_i32 s54, s4, 224
  s_mul_i32 s55, s6, 14
  s_add_u32 s54, s54, s55
  s_lshl_b32 s54, s54, 10
  s_add_u32 s54, s54, 10485760
  s_add_u32 s55, s54, 114688
  s_mul_i32 s58, s4, 224
  s_mul_i32 s3, s5, 14
  s_add_u32 s58, s58, s3
  s_lshl_b32 s3, s6, 1
  s_add_u32 s58, s58, s3
  s_lshl_b32 s58, s58, 10
  s_add_u32 s58, s58, 10485760
  v_lshrrev_b32 v13, 5, v1
  v_lshlrev_b32 v13, 4, v13
  s_lshl_b32 s56, s6, 8
  s_add_u32 s56, s56, 162048
  v_add_u32 v13, s56, v13
  v_add_u32 v14, 156672, v12
  s_mov_b32 s59, 16384
  s_waitcnt vmcnt(0)
  ds_read_b128 v[16:19], v56 offset:0
  ds_read_b128 v[20:23], v56 offset:1024
  ds_read_b128 v[24:27], v56 offset:2048
  ds_read_b128 v[28:31], v56 offset:3072
L_ha_c:
  s_waitcnt lgkmcnt(2)
  v_max3_u32 v58, v16, v17, v18
  v_max_u32 v58, v58, v19
  v_max3_u32 v58, v58, v20, v21
  v_max3_u32 v58, v58, v22, v23
  s_waitcnt lgkmcnt(0)
  v_max3_u32 v58, v58, v24, v25
  v_max3_u32 v58, v58, v26, v27
  v_max3_u32 v58, v58, v28, v29
  v_max3_u32 v58, v58, v30, v31
  v_cmp_eq_u32 vcc, -1, v58
  s_cbranch_vccnz L_ha_r
L_ha_k:
  s_cmp_lt_u32 s6, 4
  s_cbranch_scc0 L_h_w7d
  s_add_u32 s60, s93, 32768
  s_lshl_b32 m0, s6, 12
  s_add_u32 m0, m0, 32768
  s_nop 0
  buffer_load_dwordx4 v2, s[8:11], s60 offen offset:0 sc1 lds
  buffer_load_dwordx4 v2, s[8:11], s60 offen offset:1024 sc1 lds
  buffer_load_dwordx4 v2, s[8:11], s60 offen offset:2048 sc1 lds
  buffer_load_dwordx4 v2, s[8:11], s60 offen offset:3072 sc1 lds
  s_branch L_h_w7d
L_h_w7a:
  s_lshl_b32 s58, s4, 14
  s_add_u32 s58, s58, 17825792
  s_add_u32 s60, s58, 0
  buffer_load_dwordx4 v[128:131], v2, s[8:11], s60 offen offset:0 sc1
  buffer_load_dwordx4 v[132:135], v2, s[8:11], s60 offen offset:1024 sc1
  buffer_load_dwordx4 v[136:139], v2, s[8:11], s60 offen offset:2048 sc1
  buffer_load_dwordx4 v[140:143], v2, s[8:11], s60 offen offset:3072 sc1
  s_add_u32 s60, s58, 4096
  buffer_load_dwordx4 v[144:147], v2, s[8:11], s60 offen offset:0 sc1
  buffer_load_dwordx4 v[148:151], v2, s[8:11], s60 offen offset:1024 sc1
  buffer_load_dwordx4 v[152:155], v2, s[8:11], s60 offen offset:2048 sc1
  buffer_load_dwordx4 v[156:159], v2, s[8:11], s60 offen offset:3072 sc1
  s_mov_b32 s59, 16384
  s_waitcnt vmcnt(8)
  ds_read_b128 v[16:19], v56 offset:0
  ds_read_b128 v[20:23], v56 offset:1024
  ds_read_b128 v[24:27], v56 offset:2048
  ds_read_b128 v[28:31], v56 offset:3072
L_ha7_c:
  s_waitcnt lgkmcnt(2)
  v_max3_u32 v58, v16, v17, v18
  v_max_u32 v58, v58, v19
  v_max3_u32 v58, v58, v20, v21
  v_max3_u32 v58, v58, v22, v23
  s_waitcnt lgkmcnt(0)
  v_max3_u32 v58, v58, v24, v25
  v_max3_u32 v58, v58, v26, v27
  v_max3_u32 v58, v58, v28, v29
  v_max3_u32 v58, v58, v30, v31
  v_cmp_eq_u32 vcc, -1, v58
  s_cbranch_vccnz L_ha7_r
L_ha7_k:
L_h_w7d:
  s_barrier
  s_cmp_lt_u32 s6, 4
  s_cbranch_scc0 L_h_preB
L_h_skipB:
  ds_read_b128 v[32:35], v2 offset:0
  ds_read_b128 v[36:39], v2 offset:1024
  ds_read_b128 v[40:43], v2 offset:2048
  ds_read_b128 v[44:47], v2 offset:3072
  ds_read_b128 v[48:51], v2 offset:4096
  ds_read_b128 v[52:55], v2 offset:5120
  ds_read_b128 v[56:59], v2 offset:6144
  ds_read_b128 v[60:63], v2 offset:7168
  s_setprio 2
  s_cmp_lt_u32 s6, 4
  s_cbranch_scc0 L_pr_158
  s_setprio 3
L_pr_158:
  s_waitcnt lgkmcnt(7)
  v_mfma_f32_32x32x16_bf16 v[16:31], v[128:131], v[32:35], 0
  ds_read_b128 v[32:35], v2 offset:8192
  s_waitcnt lgkmcnt(7)
  v_mfma_f32_32x32x16_bf16 v[16:31], v[132:135], v[36:39], v[16:31]
  ds_read_b128 v[36:39], v2 offset:9216
  s_waitcnt lgkmcnt(7)
  v_mfma_f32_32x32x16_bf16 v[16:31], v[136:139], v[40:43], v[16:31]
  ds_read_b128 v[40:43], v2 offset:10240
  s_waitcnt lgkmcnt(7)
  v_mfma_f32_32x32x16_bf16 v[16:31], v[140:143], v[44:47], v[16:31]
  ds_read_b128 v[44:47], v2 offset:11264
  s_waitcnt lgkmcnt(7)
  v_mfma_f32_32x32x16_bf16 v[16:31], v[144:147], v[48:51], v[16:31]
  ds_read_b128 v[48:51], v2 offset:12288
  s_waitcnt lgkmcnt(7)
  v_mfma_f32_32x32x16_bf16 v[16:31], v[148:151], v[52:55], v[16:31]
  ds_read_b128 v[52:55], v2 offset:13312
  s_waitcnt lgkmcnt(7)
  v_mfma_f32_32x32x16_bf16 v[16:31], v[152:155], v[56:59], v[16:31]
  ds_read_b128 v[56:59], v2 offset:14336
  s_waitcnt lgkmcnt(7)
  v_mfma_f32_32x32x16_bf16 v[16:31], v[156:159], v[60:63], v[16:31]
  ds_read_b128 v[60:63], v2 offset:15360
  s_waitcnt lgkmcnt(7)
  v_mfma_f32_32x32x16_bf16 v[16:31], v[160:163], v[32:35], v[16:31]
  ds_read_b128 v[32:35], v2 offset:16384
  s_waitcnt lgkmcnt(7)
  v_mfma_f32_32x32x16_bf16 v[16:31], v[164:167], v[36:39], v[16:31]
  ds_read_b128 v[36:39], v2 offset:17408
  s_waitcnt lgkmcnt(7)
  v_mfma_f32_32x32x16_bf16 v[16:31], v[168:171], v[40:43], v[16:31]
  ds_read_b128 v[40:43], v2 offset:18432
  s_waitcnt lgkmcnt(7)
  v_mfma_f32_32x32x16_bf16 v[16:31], v[172:175], v[44:47], v[16:31]
  ds_read_b128 v[44:47], v2 offset:19456
  s_waitcnt lgkmcnt(7)
  v_mfma_f32_32x32x16_bf16 v[16:31], v[176:179], v[48:51], v[16:31]
  ds_read_b128 v[48:51], v2 offset:20480
  s_waitcnt lgkmcnt(7)
  v_mfma_f32_32x32x16_bf16 v[16:31], v[180:183], v[52:55], v[16:31]
  ds_read_b128 v[52:55], v2 offset:21504
  s_waitcnt lgkmcnt(7)
  v_mfma_f32_32x32x16_bf16 v[16:31], v[184:187], v[56:59], v[16:31]
  ds_read_b128 v[56:59], v2 offset:22528
  s_waitcnt lgkmcnt(7)
  v_mfma_f32_32x32x16_bf16 v[16:31], v[188:191], v[60:63], v[16:31]
  ds_read_b128 v[60:63], v2 offset:23552
  s_waitcnt lgkmcnt(7)
  v_mfma_f32_32x32x16_bf16 v[16:31], v[192:195], v[32:35], v[16:31]
  ds_read_b128 v[32:35], v2 offset:24576
  s_waitcnt lgkmcnt(7)
  v_mfma_f32_32x32x16_bf16 v[16:31], v[196:199], v[36:39], v[16:31]
  ds_read_b128 v[36:39], v2 offset:25600
  s_waitcnt lgkmcnt(7)
  v_mfma_f32_32x32x16_bf16 v[16:31], v[200:203], v[40:43], v[16:31]
  ds_read_b128 v[40:43], v2 offset:26624
  s_waitcnt lgkmcnt(7)
  v_mfma_f32_32x32x16_bf16 v[16:31], v[204:207], v[44:47], v[16:31]
  ds_read_b128 v[44:47], v2 offset:27648
  v_mov_b32 v0, 161524
  ds_read_b32 v0, v0
  ds_read_b32 v12, v14 offset:0
  ds_read_b32 v15, v14 offset:4
  s_waitcnt lgkmcnt(10)
  v_mfma_f32_32x32x16_bf16 v[16:31], v[208:211], v[48:51], v[16:31]
  ds_read_b128 v[48:51], v2 offset:28672
  s_waitcnt lgkmcnt(10)
  v_mfma_f32_32x32x16_bf16 v[16:31], v[212:215], v[52:55], v[16:31]
  ds_read_b128 v[52:55], v2 offset:29696
  s_waitcnt lgkmcnt(10)
  v_mfma_f32_32x32x16_bf16 v[16:31], v[216:219], v[56:59], v[16:31]
  ds_read_b128 v[56:59], v2 offset:30720
  s_waitcnt lgkmcnt(3)
  v_readfirstlane_b32 s61, v0
  s_nop 0
  s_cmp_ge_u32 s61, 9
  s_cbranch_scc0 L_sc_159_r
L_sc_159_ok:
  v_mfma_f32_32x32x16_bf16 v[16:31], v[220:223], v[60:63], v[16:31]
  ds_read_b128 v[60:63], v2 offset:31744
  v_mul_f32 v8, 0x3b000000, v12
  v_mul_f32 v15, 0x3b000000, v15
  v_mfma_f32_32x32x16_bf16 v[16:31], v[224:227], v[32:35], v[16:31]
  ds_read_b128 v[32:35], v13 offset:0
  v_fma_f32 v15, -v8, v8, v15
  v_max_f32 v15, 0, v15
  v_mfma_f32_32x32x16_bf16 v[16:31], v[228:231], v[36:39], v[16:31]
  ds_read_b128 v[36:39], v13 offset:32
  v_cvt_pk_bf16_f32 v8, v8, v15
  v_and_b32 v15, 0xffff0000, v8
  v_mfma_f32_32x32x16_bf16 v[16:31], v[232:235], v[40:43], v[16:31]
  ds_read_b128 v[40:43], v13 offset:128
  v_lshlrev_b32 v8, 16, v8
  v_add_f32 v15, 0x3727c5ac, v15
  v_mfma_f32_32x32x16_bf16 v[16:31], v[236:239], v[44:47], v[16:31]
  ds_read_b128 v[44:47], v13 offset:160
  v_cvt_pk_bf16_f32 v15, v15, v15
  v_lshlrev_b32 v15, 16, v15
  s_waitcnt lgkmcnt(7)
  v_mfma_f32_32x32x16_bf16 v[16:31], v[240:243], v[48:51], v[16:31]
  ds_read_b128 v[48:51], v13 offset:64
  v_sqrt_f32 v15, v15
  s_nop 0
  v_cvt_pk_bf16_f32 v15, v15, v15
  s_waitcnt lgkmcnt(7)
  v_mfma_f32_32x32x16_bf16 v[16:31], v[244:247], v[52:55], v[16:31]
  ds_read_b128 v[52:55], v13 offset:96
  v_lshlrev_b32 v15, 16, v15
  v_rcp_f32 v9, v15
  s_waitcnt lgkmcnt(7)
  v_mfma_f32_32x32x16_bf16 v[16:31], v[248:251], v[56:59], v[16:31]
  ds_read_b128 v[56:59], v13 offset:192
  v_mul_f32 v8, v8, v9
  s_waitcnt lgkmcnt(7)
  v_mfma_f32_32x32x16_bf16 v[16:31], v[252:255], v[60:63], v[16:31]
  ds_read_b128 v[60:63], v13 offset:224
  s_setprio 0
  s_waitcnt lgkmcnt(0)
  v_fma_f32 v32, -v8, v32, v40
  v_fma_f32 v33, -v8, v33, v41
  v_fma_f32 v34, -v8, v34, v42
  v_fma_f32 v35, -v8, v35, v43
  v_fma_f32 v36, -v8, v36, v44
  v_fma_f32 v37, -v8, v37, v45
  v_fma_f32 v38, -v8, v38, v46
  v_fma_f32 v39, -v8, v39, v47
  v_fma_f32 v48, -v8, v48, v56
  v_fma_f32 v49, -v8, v49, v57
  v_fma_f32 v50, -v8, v50, v58
  v_fma_f32 v51, -v8, v51, v59
  v_fma_f32 v52, -v8, v52, v60
  v_fma_f32 v53, -v8, v53, v61
  v_fma_f32 v54, -v8, v54, v62
  v_fma_f32 v55, -v8, v55, v63
  v_fma_f32 v16, v16, v9, v32
  v_fma_f32 v17, v17, v9, v33
  v_fma_f32 v18, v18, v9, v34
  v_fma_f32 v19, v19, v9, v35
  v_fma_f32 v20, v20, v9, v36
  v_fma_f32 v21, v21, v9, v37
  v_fma_f32 v22, v22, v9, v38
  v_fma_f32 v23, v23, v9, v39
  v_fma_f32 v24, v24, v9, v48
  v_fma_f32 v25, v25, v9, v49
  v_fma_f32 v26, v26, v9, v50
  v_fma_f32 v27, v27, v9, v51
  v_fma_f32 v28, v28, v9, v52
  v_fma_f32 v29, v29, v9, v53
  v_fma_f32 v30, v30, v9, v54
  v_fma_f32 v31, v31, v9, v55
  v_max_f32 v32, 0, v16
  v_max_f32 v33, 0, v17
  v_max_f32 v34, 0, v18
  v_max_f32 v35, 0, v19
  v_max_f32 v36, 0, v20
  v_max_f32 v37, 0, v21
  v_max_f32 v38, 0, v22
  v_max_f32 v39, 0, v23
  v_max_f32 v48, 0, v24
  v_max_f32 v49, 0, v25
  v_max_f32 v50, 0, v26
  v_max_f32 v51, 0, v27
  v_max_f32 v52, 0, v28
  v_max_f32 v53, 0, v29
  v_max_f32 v54, 0, v30
  v_max_f32 v55, 0, v31
  v_mul_f32 v16, v16, v32
  v_mul_f32 v17, v17, v33
  v_mul_f32 v18, v18, v34
  v_mul_f32 v19, v19, v35
  v_mul_f32 v20, v20, v36
  v_mul_f32 v21, v21, v37
  v_mul_f32 v22, v22, v38
  v_mul_f32 v23, v23, v39
  v_mul_f32 v24, v24, v48
  v_mul_f32 v25, v25, v49
  v_mul_f32 v26, v26, v50
  v_mul_f32 v27, v27, v51
  v_mul_f32 v28, v28, v52
  v_mul_f32 v29, v29, v53
  v_mul_f32 v30, v30, v54
  v_mul_f32 v31, v31, v55
  v_cvt_pk_bf16_f32 v32, v16, v17
  v_cvt_pk_bf16_f32 v33, v18, v19
  v_cvt_pk_bf16_f32 v34, v20, v21
  v_cvt_pk_bf16_f32 v35, v22, v23
  v_cvt_pk_bf16_f32 v36, v24, v25
  v_cvt_pk_bf16_f32 v37, v26, v27
  v_cvt_pk_bf16_f32 v38, v28, v29
  v_cvt_pk_bf16_f32 v39, v30, v31
  v_min_u32 v32, -2, v32
  v_min_u32 v33, -2, v33
  v_min_u32 v34, -2, v34
  v_min_u32 v35, -2, v35
  v_min_u32 v36, -2, v36
  v_min_u32 v37, -2, v37
  v_min_u32 v38, -2, v38
  v_min_u32 v39, -2, v39
  s_cmp_eq_u32 s90, 1
  s_cbranch_scc0 L_hs_160
  buffer_store_dwordx4 v[32:35], v2, s[8:11], s58 offen
  buffer_store_dwordx4 v[36:39], v2, s[8:11], s58 offen offset:1024
L_hd_161:
  s_cmp_lt_u32 s6, 4
  s_cbranch_scc0 L_p4_B
  s_lshl_b32 s3, s6, 12
  v_add_u32 v56, s3, v2
  s_mov_b32 s59, 16384
  s_waitcnt vmcnt(2)
  ds_read_b128 v[16:19], v56 offset:32768
  ds_read_b128 v[20:23], v56 offset:33792
  ds_read_b128 v[24:27], v56 offset:34816
  ds_read_b128 v[28:31], v56 offset:35840
L_hc_c:
  s_waitcnt lgkmcnt(2)
  v_max3_u32 v58, v16, v17, v18
  v_max_u32 v58, v58, v19
  v_max3_u32 v58, v58, v20, v21
  v_max3_u32 v58, v58, v22, v23
  s_waitcnt lgkmcnt(0)
  v_max3_u32 v58, v58, v24, v25
  v_max3_u32 v58, v58, v26, v27
  v_max3_u32 v58, v58, v28, v29
  v_max3_u32 v58, v58, v30, v31
  v_cmp_eq_u32 vcc, -1, v58
  s_cbranch_vccnz L_hc_r
L_hc_k:
  v_mov_b32 v0, 161520
  s_mov_b64 exec, 2
  ds_add_u32 v0, v1
  s_mov_b64 exec, -1
  s_mov_b32 s59, 16384
L_lw_162:
  v_mov_b32 v0, 161520
  ds_read_b32 v0, v0
  s_waitcnt lgkmcnt(0)
  v_readfirstlane_b32 s61, v0
  s_nop 0
  s_cmp_ge_u32 s61, 8
  s_cbranch_scc0 L_lw_162_r
L_lw_162_ok:
  ds_read_b128 v[32:35], v2 offset:32768
  ds_read_b128 v[36:39], v2 offset:33792
  ds_read_b128 v[40:43], v2 offset:34816
  ds_read_b128 v[44:47], v2 offset:35840
  ds_read_b128 v[48:51], v2 offset:36864
  ds_read_b128 v[52:55], v2 offset:37888
  ds_read_b128 v[56:59], v2 offset:38912
  ds_read_b128 v[60:63], v2 offset:39936
  s_setprio 1
  s_cmp_lt_u32 s6, 4
  s_cbranch_scc0 L_pr_163
  s_setprio 1
L_pr_163:
  s_waitcnt lgkmcnt(7)
  v_mfma_f32_32x32x16_bf16 v[16:31], v[128:131], v[32:35], 0
  ds_read_b128 v[32:35], v2 offset:40960
  s_waitcnt lgkmcnt(7)
  v_mfma_f32_32x32x16_bf16 v[16:31], v[132:135], v[36:39], v[16:31]
  ds_read_b128 v[36:39], v2 offset:41984
  s_waitcnt lgkmcnt(7)
  v_mfma_f32_32x32x16_bf16 v[16:31], v[136:139], v[40:43], v[16:31]
  ds_read_b128 v[40:43], v2 offset:43008
  s_waitcnt lgkmcnt(7)
  v_mfma_f32_32x32x16_bf16 v[16:31], v[140:143], v[44:47], v[16:31]
  ds_read_b128 v[44:47], v2 offset:44032
  s_waitcnt lgkmcnt(7)
  v_mfma_f32_32x32x16_bf16 v[16:31], v[144:147], v[48:51], v[16:31]
  ds_read_b128 v[48:51], v2 offset:45056
  s_waitcnt lgkmcnt(7)
  v_mfma_f32_32x32x16_bf16 v[16:31], v[148:151], v[52:55], v[16:31]
  ds_read_b128 v[52:55], v2 offset:46080
  s_waitcnt lgkmcnt(7)
  v_mfma_f32_32x32x16_bf16 v[16:31], v[152:155], v[56:59], v[16:31]
  ds_read_b128 v[56:59], v2 offset:47104
  s_waitcnt lgkmcnt(7)
  v_mfma_f32_32x32x16_bf16 v[16:31], v[156:159], v[60:63], v[16:31]
  ds_read_b128 v[60:63], v2 offset:48128
  s_waitcnt lgkmcnt(7)
  v_mfma_f32_32x32x16_bf16 v[16:31], v[160:163], v[32:35], v[16:31]
  ds_read_b128 v[32:35], v2 offset:49152
  s_waitcnt lgkmcnt(7)
  v_mfma_f32_32x32x16_bf16 v[16:31], v[164:167], v[36:39], v[16:31]
  ds_read_b128 v[36:39], v2 offset:50176
  s_waitcnt lgkmcnt(7)
  v_mfma_f32_32x32x16_bf16 v[16:31], v[168:171], v[40:43], v[16:31]
  ds_read_b128 v[40:43], v2 offset:51200
  s_waitcnt lgkmcnt(7)
  v_mfma_f32_32x32x16_bf16 v[16:31], v[172:175], v[44:47], v[16:31]
  ds_read_b128 v[44:47], v2 offset:52224
  s_waitcnt lgkmcnt(7)
  v_mfma_f32_32x32x16_bf16 v[16:31], v[176:179], v[48:51], v[16:31]
  ds_read_b128 v[48:51], v2 offset:53248
  s_cmp_eq_u32 s6, 3
  s_cbranch_scc0 L_pace_164
  v_mov_b32 v0, 161492
  v_mov_b32 v15, 1
  ds_write_b32 v0, v15
L_pace_164:
  s_waitcnt lgkmcnt(7)
  v_mfma_f32_32x32x16_bf16 v[16:31], v[180:183], v[52:55], v[16:31]
  ds_read_b128 v[52:55], v2 offset:54272
  s_waitcnt lgkmcnt(7)
  v_mfma_f32_32x32x16_bf16 v[16:31], v[184:187], v[56:59], v[16:31]
  ds_read_b128 v[56:59], v2 offset:55296
  s_waitcnt lgkmcnt(7)
  v_mfma_f32_32x32x16_bf16 v[16:31], v[188:191], v[60:63], v[16:31]
  ds_read_b128 v[60:63], v2 offset:56320
  s_waitcnt lgkmcnt(7)
  v_mfma_f32_32x32x16_bf16 v[16:31], v[192:195], v[32:35], v[16:31]
  ds_read_b128 v[32:35], v2 offset:57344
  s_waitcnt lgkmcnt(7)
  v_mfma_f32_32x32x16_bf16 v[16:31], v[196:199], v[36:39], v[16:31]
  ds_read_b128 v[36:39], v2 offset:58368
  s_waitcnt lgkmcnt(7)
  v_mfma_f32_32x32x16_bf16 v[16:31], v[200:203], v[40:43], v[16:31]
  ds_read_b128 v[40:43], v2 offset:59392
  s_add_u32 s60, s54, 0
  buffer_load_dwordx4 v[128:131], v2, s[8:11], s60 offen offset:0 sc1
  s_waitcnt lgkmcnt(7)
  v_mfma_f32_32x32x16_bf16 v[16:31], v[204:207], v[44:47], v[16:31]
  ds_read_b128 v[44:47], v2 offset:60416
  buffer_load_dwordx4 v[132:135], v2, s[8:11], s60 offen offset:1024 sc1
  v_mov_b32 v0, 161524
  ds_read_b32 v0, v0
  ds_read_b32 v12, v14 offset:256
  ds_read_b32 v15, v14 offset:260
  s_waitcnt lgkmcnt(10)
  v_mfma_f32_32x32x16_bf16 v[16:31], v[208:211], v[48:51], v[16:31]
  ds_read_b128 v[48:51], v2 offset:61440
  buffer_load_dwordx4 v[136:139], v2, s[8:11], s60 offen offset:2048 sc1
  s_waitcnt lgkmcnt(10)
  v_mfma_f32_32x32x16_bf16 v[16:31], v[212:215], v[52:55], v[16:31]
  ds_read_b128 v[52:55], v2 offset:62464
  buffer_load_dwordx4 v[140:143], v2, s[8:11], s60 offen offset:3072 sc1
  s_waitcnt lgkmcnt(10)
  v_mfma_f32_32x32x16_bf16 v[16:31], v[216:219], v[56:59], v[16:31]
  ds_read_b128 v[56:59], v2 offset:63488
  s_add_u32 s60, s54, 4096
  buffer_load_dwordx4 v[144:147], v2, s[8:11], s60 offen offset:0 sc1
  s_waitcnt lgkmcnt(3)
  v_readfirstlane_b32 s61, v0
  s_nop 0
  s_cmp_ge_u32 s61, 10
  s_cbranch_scc0 L_sc_165_r
L_sc_165_ok:
  v_mfma_f32_32x32x16_bf16 v[16:31], v[220:223], v[60:63], v[16:31]
  ds_read_b128 v[60:63], v2 offset:64512
  buffer_load_dwordx4 v[148:151], v2, s[8:11], s60 offen offset:1024 sc1
  v_mul_f32 v8, 0x3b000000, v12
  v_mul_f32 v15, 0x3b000000, v15
  v_mfma_f32_32x32x16_bf16 v[16:31], v[224:227], v[32:35], v[16:31]
  buffer_load_dwordx4 v[152:155], v2, s[8:11], s60 offen offset:2048 sc1
  ds_read_b128 v[32:35], v13 offset:0
  v_fma_f32 v15, -v8, v8, v15
  v_max_f32 v15, 0, v15
  v_mfma_f32_32x32x16_bf16 v[16:31], v[228:231], v[36:39], v[16:31]
  buffer_load_dwordx4 v[156:159], v2, s[8:11], s60 offen offset:3072 sc1
  ds_read_b128 v[36:39], v13 offset:32
  v_cvt_pk_bf16_f32 v8, v8, v15
  v_and_b32 v15, 0xffff0000, v8
  v_mfma_f32_32x32x16_bf16 v[16:31], v[232:235], v[40:43], v[16:31]
  ds_read_b128 v[40:43], v13 offset:128
  v_lshlrev_b32 v8, 16, v8
  v_add_f32 v15, 0x3727c5ac, v15
  v_mfma_f32_32x32x16_bf16 v[16:31], v[236:239], v[44:47], v[16:31]
  ds_read_b128 v[44:47], v13 offset:160
  v_cvt_pk_bf16_f32 v15, v15, v15
  v_lshlrev_b32 v15, 16, v15
  s_waitcnt lgkmcnt(7)
  v_mfma_f32_32x32x16_bf16 v[16:31], v[240:243], v[48:51], v[16:31]
  ds_read_b128 v[48:51], v13 offset:64
  v_sqrt_f32 v15, v15
  s_nop 0
  v_cvt_pk_bf16_f32 v15, v15, v15
  s_waitcnt lgkmcnt(7)
  v_mfma_f32_32x32x16_bf16 v[16:31], v[244:247], v[52:55], v[16:31]
  ds_read_b128 v[52:55], v13 offset:96
  v_lshlrev_b32 v15, 16, v15
  v_rcp_f32 v9, v15
  s_waitcnt lgkmcnt(7)
  v_mfma_f32_32x32x16_bf16 v[16:31], v[248:251], v[56:59], v[16:31]
  ds_read_b128 v[56:59], v13 offset:192
  v_mul_f32 v8, v8, v9
  s_waitcnt lgkmcnt(7)
  v_mfma_f32_32x32x16_bf16 v[16:31], v[252:255], v[60:63], v[16:31]
  ds_read_b128 v[60:63], v13 offset:224
  s_setprio 0
  s_waitcnt lgkmcnt(0)
  v_fma_f32 v32, -v8, v32, v40
  v_fma_f32 v33, -v8, v33, v41
  v_fma_f32 v34, -v8, v34, v42
  v_fma_f32 v35, -v8, v35, v43
  v_fma_f32 v36, -v8, v36, v44
  v_fma_f32 v37, -v8, v37, v45
  v_fma_f32 v38, -v8, v38, v46
  v_fma_f32 v39, -v8, v39, v47
  v_fma_f32 v48, -v8, v48, v56
  v_fma_f32 v49, -v8, v49, v57
  v_fma_f32 v50, -v8, v50, v58
  v_fma_f32 v51, -v8, v51, v59
  v_fma_f32 v52, -v8, v52, v60
  v_fma_f32 v53, -v8, v53, v61
  v_fma_f32 v54, -v8, v54, v62
  v_fma_f32 v55, -v8, v55, v63
  v_fma_f32 v16, v16, v9, v32
  v_fma_f32 v17, v17, v9, v33
  v_fma_f32 v18, v18, v9, v34
  v_fma_f32 v19, v19, v9, v35
  v_fma_f32 v20, v20, v9, v36
  v_fma_f32 v21, v21, v9, v37
  v_fma_f32 v22, v22, v9, v38
  v_fma_f32 v23, v23, v9, v39
  v_fma_f32 v24, v24, v9, v48
  v_fma_f32 v25, v25, v9, v49
  v_fma_f32 v26, v26, v9, v50
  v_fma_f32 v27, v27, v9, v51
  v_fma_f32 v28, v28, v9, v52
  v_fma_f32 v29, v29, v9, v53
  v_fma_f32 v30, v30, v9, v54
  v_fma_f32 v31, v31, v9, v55
  v_max_f32 v32, 0, v16
  v_max_f32 v33, 0, v17
  v_max_f32 v34, 0, v18
  v_max_f32 v35, 0, v19
  v_max_f32 v36, 0, v20
  v_max_f32 v37, 0, v21
  v_max_f32 v38, 0, v22
  v_max_f32 v39, 0, v23
  v_max_f32 v48, 0, v24
  v_max_f32 v49, 0, v25
  v_max_f32 v50, 0, v26
  v_max_f32 v51, 0, v27
  v_max_f32 v52, 0, v28
  v_max_f32 v53, 0, v29
  v_max_f32 v54, 0, v30
  v_max_f32 v55, 0, v31
  v_mul_f32 v16, v16, v32
  v_mul_f32 v17, v17, v33
  v_mul_f32 v18, v18, v34
  v_mul_f32 v19, v19, v35
  v_mul_f32 v20, v20, v36
  v_mul_f32 v21, v21, v37
  v_mul_f32 v22, v22, v38
  v_mul_f32 v23, v23, v39
  v_mul_f32 v24, v24, v48
  v_mul_f32 v25, v25, v49
  v_mul_f32 v26, v26, v50
  v_mul_f32 v27, v27, v51
  v_mul_f32 v28, v28, v52
  v_mul_f32 v29, v29, v53
  v_mul_f32 v30, v30, v54
  v_mul_f32 v31, v31, v55
  v_cvt_pk_bf16_f32 v32, v16, v17
  v_cvt_pk_bf16_f32 v33, v18, v19
  v_cvt_pk_bf16_f32 v34, v20, v21
  v_cvt_pk_bf16_f32 v35, v22, v23
  v_cvt_pk_bf16_f32 v36, v24, v25
  v_cvt_pk_bf16_f32 v37, v26, v27
  v_cvt_pk_bf16_f32 v38, v28, v29
  v_cvt_pk_bf16_f32 v39, v30, v31
  v_min_u32 v32, -2, v32
  v_min_u32 v33, -2, v33
  v_min_u32 v34, -2, v34
  v_min_u32 v35, -2, v35
  v_min_u32 v36, -2, v36
  v_min_u32 v37, -2, v37
  v_min_u32 v38, -2, v38
  v_min_u32 v39, -2, v39
  s_add_u32 s58, s58, 114688
  s_cmp_eq_u32 s90, 1
  s_cbranch_scc0 L_hs_166
  buffer_store_dwordx4 v[32:35], v2, s[8:11], s58 offen
  buffer_store_dwordx4 v[36:39], v2, s[8:11], s58 offen offset:1024
L_hd_167:
  s_add_u32 s60, s54, 8192
  buffer_load_dwordx4 v[160:163], v2, s[8:11], s60 offen offset:0 sc1
  buffer_load_dwordx4 v[164:167], v2, s[8:11], s60 offen offset:1024 sc1
  buffer_load_dwordx4 v[168:171], v2, s[8:11], s60 offen offset:2048 sc1
  buffer_load_dwordx4 v[172:175], v2, s[8:11], s60 offen offset:3072 sc1
  s_add_u32 s60, s54, 12288
  buffer_load_dwordx4 v[176:179], v2, s[8:11], s60 offen offset:0 sc1
  buffer_load_dwordx4 v[180:183], v2, s[8:11], s60 offen offset:1024 sc1
  s_branch L_p4_done
L_p4_B:
  s_mov_b32 s59, 16384
L_lw_168:
  v_mov_b32 v0, 161520
  ds_read_b32 v0, v0
  s_waitcnt lgkmcnt(0)
  v_readfirstlane_b32 s61, v0
  s_nop 0
  s_cmp_ge_u32 s61, 8
  s_cbranch_scc0 L_lw_168_r
L_lw_168_ok:
  ds_read_b128 v[32:35], v2 offset:32768
  ds_read_b128 v[36:39], v2 offset:33792
  ds_read_b128 v[40:43], v2 offset:34816
  ds_read_b128 v[44:47], v2 offset:35840
  ds_read_b128 v[48:51], v2 offset:36864
  ds_read_b128 v[52:55], v2 offset:37888
  ds_read_b128 v[56:59], v2 offset:38912
  ds_read_b128 v[60:63], v2 offset:39936
  s_setprio 1
  s_cmp_lt_u32 s6, 4
  s_cbranch_scc0 L_pr_169
  s_setprio 1
L_pr_169:
  s_waitcnt lgkmcnt(7)
  v_mfma_f32_32x32x16_bf16 v[16:31], v[128:131], v[32:35], 0
  ds_read_b128 v[32:35], v2 offset:40960
  s_waitcnt lgkmcnt(7)
  v_mfma_f32_32x32x16_bf16 v[16:31], v[132:135], v[36:39], v[16:31]
  ds_read_b128 v[36:39], v2 offset:41984
  s_waitcnt lgkmcnt(7)
  v_mfma_f32_32x32x16_bf16 v[16:31], v[136:139], v[40:43], v[16:31]
  ds_read_b128 v[40:43], v2 offset:43008
  s_waitcnt lgkmcnt(7)
  v_mfma_f32_32x32x16_bf16 v[16:31], v[140:143], v[44:47], v[16:31]
  ds_read_b128 v[44:47], v2 offset:44032
  s_waitcnt lgkmcnt(7)
  v_mfma_f32_32x32x16_bf16 v[16:31], v[144:147], v[48:51], v[16:31]
  ds_read_b128 v[48:51], v2 offset:45056
  s_add_u32 s60, s54, 0
  buffer_load_dwordx4 v[128:131], v2, s[8:11], s60 offen offset:0 sc1
  s_waitcnt lgkmcnt(7)
  v_mfma_f32_32x32x16_bf16 v[16:31], v[148:151], v[52:55], v[16:31]
  ds_read_b128 v[52:55], v2 offset:46080
  buffer_load_dwordx4 v[132:135], v2, s[8:11], s60 offen offset:1024 sc1
  s_waitcnt lgkmcnt(7)
  v_mfma_f32_32x32x16_bf16 v[16:31], v[152:155], v[56:59], v[16:31]
  ds_read_b128 v[56:59], v2 offset:47104
  buffer_load_dwordx4 v[136:139], v2, s[8:11], s60 offen offset:2048 sc1
  s_waitcnt lgkmcnt(7)
  v_mfma_f32_32x32x16_bf16 v[16:31], v[156:159], v[60:63], v[16:31]
  ds_read_b128 v[60:63], v2 offset:48128
  buffer_load_dwordx4 v[140:143], v2, s[8:11], s60 offen offset:3072 sc1
  s_waitcnt lgkmcnt(7)
  v_mfma_f32_32x32x16_bf16 v[16:31], v[160:163], v[32:35], v[16:31]
  ds_read_b128 v[32:35], v2 offset:49152
  s_add_u32 s60, s54, 4096
  buffer_load_dwordx4 v[144:147], v2, s[8:11], s60 offen offset:0 sc1
  s_waitcnt lgkmcnt(7)
  v_mfma_f32_32x32x16_bf16 v[16:31], v[164:167], v[36:39], v[16:31]
  ds_read_b128 v[36:39], v2 offset:50176
  buffer_load_dwordx4 v[148:151], v2, s[8:11], s60 offen offset:1024 sc1
  s_waitcnt lgkmcnt(7)
  v_mfma_f32_32x32x16_bf16 v[16:31], v[168:171], v[40:43], v[16:31]
  ds_read_b128 v[40:43], v2 offset:51200
  buffer_load_dwordx4 v[152:155], v2, s[8:11], s60 offen offset:2048 sc1
  s_waitcnt lgkmcnt(7)
  v_mfma_f32_32x32x16_bf16 v[16:31], v[172:175], v[44:47], v[16:31]
  ds_read_b128 v[44:47], v2 offset:52224
  buffer_load_dwordx4 v[156:159], v2, s[8:11], s60 offen offset:3072 sc1
  s_waitcnt lgkmcnt(7)
  v_mfma_f32_32x32x16_bf16 v[16:31], v[176:179], v[48:51], v[16:31]
  ds_read_b128 v[48:51], v2 offset:53248
  s_waitcnt lgkmcnt(7)
  v_mfma_f32_32x32x16_bf16 v[16:31], v[180:183], v[52:55], v[16:31]
  ds_read_b128 v[52:55], v2 offset:54272
  s_waitcnt lgkmcnt(7)
  v_mfma_f32_32x32x16_bf16 v[16:31], v[184:187], v[56:59], v[16:31]
  ds_read_b128 v[56:59], v2 offset:55296
  s_waitcnt lgkmcnt(7)
  v_mfma_f32_32x32x16_bf16 v[16:31], v[188:191], v[60:63], v[16:31]
  ds_read_b128 v[60:63], v2 offset:56320
  s_waitcnt lgkmcnt(7)
  v_mfma_f32_32x32x16_bf16 v[16:31], v[192:195], v[32:35], v[16:31]
  ds_read_b128 v[32:35], v2 offset:57344
  s_waitcnt lgkmcnt(7)
  v_mfma_f32_32x32x16_bf16 v[16:31], v[196:199], v[36:39], v[16:31]
  ds_read_b128 v[36:39], v2 offset:58368
  s_waitcnt lgkmcnt(7)
  v_mfma_f32_32x32x16_bf16 v[16:31], v[200:203], v[40:43], v[16:31]
  ds_read_b128 v[40:43], v2 offset:59392
  s_waitcnt lgkmcnt(7)
  v_mfma_f32_32x32x16_bf16 v[16:31], v[204:207], v[44:47], v[16:31]
  ds_read_b128 v[44:47], v2 offset:60416
  v_mov_b32 v0, 161524
  ds_read_b32 v0, v0
  ds_read_b32 v12, v14 offset:256
  ds_read_b32 v15, v14 offset:260
  s_waitcnt lgkmcnt(10)
  v_mfma_f32_32x32x16_bf16 v[16:31], v[208:211], v[48:51], v[16:31]
  ds_read_b128 v[48:51], v2 offset:61440
  s_waitcnt lgkmcnt(10)
  v_mfma_f32_32x32x16_bf16 v[16:31], v[212:215], v[52:55], v[16:31]
  ds_read_b128 v[52:55], v2 offset:62464
  s_waitcnt lgkmcnt(10)
  v_mfma_f32_32x32x16_bf16 v[16:31], v[216:219], v[56:59], v[16:31]
  ds_read_b128 v[56:59], v2 offset:63488
  s_waitcnt lgkmcnt(3)
  v_readfirstlane_b32 s61, v0
  s_nop 0
  s_cmp_ge_u32 s61, 10
  s_cbranch_scc0 L_sc_170_r
L_sc_170_ok:
  v_mfma_f32_32x32x16_bf16 v[16:31], v[220:223], v[60:63], v[16:31]
  ds_read_b128 v[60:63], v2 offset:64512
  v_mul_f32 v8, 0x3b000000, v12
  v_mul_f32 v15, 0x3b000000, v15
  v_mfma_f32_32x32x16_bf16 v[16:31], v[224:227], v[32:35], v[16:31]
  s_add_u32 s60, s54, 8192
  buffer_load_dwordx4 v[160:163], v2, s[8:11], s60 offen offset:0 sc1
  ds_read_b128 v[32:35], v13 offset:0
  v_fma_f32 v15, -v8, v8, v15
  v_max_f32 v15, 0, v15
  v_mfma_f32_32x32x16_bf16 v[16:31], v[228:231], v[36:39], v[16:31]
  buffer_load_dwordx4 v[164:167], v2, s[8:11], s60 offen offset:1024 sc1
  ds_read_b128 v[36:39], v13 offset:32
  v_cvt_pk_bf16_f32 v8, v8, v15
  v_and_b32 v15, 0xffff0000, v8
  v_mfma_f32_32x32x16_bf16 v[16:31], v[232:235], v[40:43], v[16:31]
  buffer_load_dwordx4 v[168:171], v2, s[8:11], s60 offen offset:2048 sc1
  ds_read_b128 v[40:43], v13 offset:128
  v_lshlrev_b32 v8, 16, v8
  v_add_f32 v15, 0x3727c5ac, v15
  v_mfma_f32_32x32x16_bf16 v[16:31], v[236:239], v[44:47], v[16:31]
  buffer_load_dwordx4 v[172:175], v2, s[8:11], s60 offen offset:3072 sc1
  ds_read_b128 v[44:47], v13 offset:160
  v_cvt_pk_bf16_f32 v15, v15, v15
  v_lshlrev_b32 v15, 16, v15
  s_waitcnt lgkmcnt(7)
  v_mfma_f32_32x32x16_bf16 v[16:31], v[240:243], v[48:51], v[16:31]
  s_add_u32 s60, s54, 12288
  buffer_load_dwordx4 v[176:179], v2, s[8:11], s60 offen offset:0 sc1
  ds_read_b128 v[48:51], v13 offset:64
  v_sqrt_f32 v15, v15
  s_nop 0
  v_cvt_pk_bf16_f32 v15, v15, v15
  s_waitcnt lgkmcnt(7)
  v_mfma_f32_32x32x16_bf16 v[16:31], v[244:247], v[52:55], v[16:31]
  buffer_load_dwordx4 v[180:183], v2, s[8:11], s60 offen offset:1024 sc1
  ds_read_b128 v[52:55], v13 offset:96
  v_lshlrev_b32 v15, 16, v15
  v_rcp_f32 v9, v15
  s_waitcnt lgkmcnt(7)
  v_mfma_f32_32x32x16_bf16 v[16:31], v[248:251], v[56:59], v[16:31]
  ds_read_b128 v[56:59], v13 offset:192
  v_mul_f32 v8, v8, v9
  s_waitcnt lgkmcnt(7)
  v_mfma_f32_32x32x16_bf16 v[16:31], v[252:255], v[60:63], v[16:31]
  ds_read_b128 v[60:63], v13 offset:224
  s_setprio 0
  s_waitcnt lgkmcnt(0)
  v_fma_f32 v32, -v8, v32, v40
  v_fma_f32 v33, -v8, v33, v41
  v_fma_f32 v34, -v8, v34, v42
  v_fma_f32 v35, -v8, v35, v43
  v_fma_f32 v36, -v8, v36, v44
  v_fma_f32 v37, -v8, v37, v45
  v_fma_f32 v38, -v8, v38, v46
  v_fma_f32 v39, -v8, v39, v47
  v_fma_f32 v48, -v8, v48, v56
  v_fma_f32 v49, -v8, v49, v57
  v_fma_f32 v50, -v8, v50, v58
  v_fma_f32 v51, -v8, v51, v59
  v_fma_f32 v52, -v8, v52, v60
  v_fma_f32 v53, -v8, v53, v61
  v_fma_f32 v54, -v8, v54, v62
  v_fma_f32 v55, -v8, v55, v63
  v_fma_f32 v16, v16, v9, v32
  v_fma_f32 v17, v17, v9, v33
  v_fma_f32 v18, v18, v9, v34
  v_fma_f32 v19, v19, v9, v35
  v_fma_f32 v20, v20, v9, v36
  v_fma_f32 v21, v21, v9, v37
  v_fma_f32 v22, v22, v9, v38
  v_fma_f32 v23, v23, v9, v39
  v_fma_f32 v24, v24, v9, v48
  v_fma_f32 v25, v25, v9, v49
  v_fma_f32 v26, v26, v9, v50
  v_fma_f32 v27, v27, v9, v51
  v_fma_f32 v28, v28, v9, v52
  v_fma_f32 v29, v29, v9, v53
  v_fma_f32 v30, v30, v9, v54
  v_fma_f32 v31, v31, v9, v55
  v_max_f32 v32, 0, v16
  v_max_f32 v33, 0, v17
  v_max_f32 v34, 0, v18
  v_max_f32 v35, 0, v19
  v_max_f32 v36, 0, v20
  v_max_f32 v37, 0, v21
  v_max_f32 v38, 0, v22
  v_max_f32 v39, 0, v23
  v_max_f32 v48, 0, v24
  v_max_f32 v49, 0, v25
  v_max_f32 v50, 0, v26
  v_max_f32 v51, 0, v27
  v_max_f32 v52, 0, v28
  v_max_f32 v53, 0, v29
  v_max_f32 v54, 0, v30
  v_max_f32 v55, 0, v31
  v_mul_f32 v16, v16, v32
  v_mul_f32 v17, v17, v33
  v_mul_f32 v18, v18, v34
  v_mul_f32 v19, v19, v35
  v_mul_f32 v20, v20, v36
  v_mul_f32 v21, v21, v37
  v_mul_f32 v22, v22, v38
  v_mul_f32 v23, v23, v39
  v_mul_f32 v24, v24, v48
  v_mul_f32 v25, v25, v49
  v_mul_f32 v26, v26, v50
  v_mul_f32 v27, v27, v51
  v_mul_f32 v28, v28, v52
  v_mul_f32 v29, v29, v53
  v_mul_f32 v30, v30, v54
  v_mul_f32 v31, v31, v55
  v_cvt_pk_bf16_f32 v32, v16, v17
  v_cvt_pk_bf16_f32 v33, v18, v19
  v_cvt_pk_bf16_f32 v34, v20, v21
  v_cvt_pk_bf16_f32 v35, v22, v23
  v_cvt_pk_bf16_f32 v36, v24, v25
  v_cvt_pk_bf16_f32 v37, v26, v27
  v_cvt_pk_bf16_f32 v38, v28, v29
  v_cvt_pk_bf16_f32 v39, v30, v31
  v_min_u32 v32, -2, v32
  v_min_u32 v33, -2, v33
  v_min_u32 v34, -2, v34
  v_min_u32 v35, -2, v35
  v_min_u32 v36, -2, v36
  v_min_u32 v37, -2, v37
  v_min_u32 v38, -2, v38
  v_min_u32 v39, -2, v39
  s_add_u32 s58, s58, 114688
  s_cmp_eq_u32 s90, 1
  s_cbranch_scc0 L_hs_171
  buffer_store_dwordx4 v[32:35], v2, s[8:11], s58 offen
  buffer_store_dwordx4 v[36:39], v2, s[8:11], s58 offen offset:1024
L_hd_172:
  s_branch L_p4_done
L_p4_w7:
  s_setprio 2
  v_and_b32 v10, 7, v1
  v_lshlrev_b32 v10, 5, v10
  v_bfe_u32 v9, v1, 4, 1
  v_lshl_or_b32 v10, v9, 4, v10
  v_lshrrev_b32 v9, 5, v1
  v_lshl_or_b32 v10, v9, 3, v10
  v_bfe_u32 v9, v1, 3, 1
  v_lshl_or_b32 v10, v9, 2, v10
  v_add_u32 v10, 156672, v10
  s_mov_b32 s59, 16384
  s_waitcnt vmcnt(0)
L_st0_c:
  v_max3_u32 v9, v128, v129, v130
  v_max3_u32 v9, v9, v131, v132
  v_max3_u32 v9, v9, v133, v134
  v_max3_u32 v9, v9, v135, v136
  v_max3_u32 v9, v9, v137, v138
  v_max3_u32 v9, v9, v139, v140
  v_max3_u32 v9, v9, v141, v142
  v_max3_u32 v9, v9, v143, v144
  v_max3_u32 v9, v9, v145, v146
  v_max3_u32 v9, v9, v147, v148
  v_max3_u32 v9, v9, v149, v150
  v_max3_u32 v9, v9, v151, v152
  v_max3_u32 v9, v9, v153, v154
  v_max3_u32 v9, v9, v155, v156
  v_max3_u32 v9, v9, v157, v158
  v_max_u32 v9, v9, v159
  v_cmp_eq_u32 vcc, -1, v9
  s_cbranch_vccnz L_st0_r
L_st0_k:
  v_add_f32 v128, v128, v144
  v_add_f32 v129, v129, v145
  v_add_f32 v130, v130, v146
  v_add_f32 v131, v131, v147
  v_add_f32 v132, v132, v148
  v_add_f32 v133, v133, v149
  v_add_f32 v134, v134, v150
  v_add_f32 v135, v135, v151
  v_add_f32 v136, v136, v152
  v_add_f32 v137, v137, v153
  v_add_f32 v138, v138, v154
  v_add_f32 v139, v139, v155
  v_add_f32 v140, v140, v156
  v_add_f32 v141, v141, v157
  v_add_f32 v142, v142, v158
  v_add_f32 v143, v143, v159
  v_add_f32 v128, v128, v136
  v_add_f32 v129, v129, v137
  v_add_f32 v130, v130, v138
  v_add_f32 v131, v131, v139
  v_add_f32 v132, v132, v140
  v_add_f32 v133, v133, v141
  v_add_f32 v134, v134, v142
  v_add_f32 v135, v135, v143
  v_add_f32 v128, v128, v132
  v_add_f32 v129, v129, v133
  v_add_f32 v130, v130, v134
  v_add_f32 v131, v131, v135
  v_permlane32_swap_b32 v128, v129
  s_nop 0
  v_permlane32_swap_b32 v130, v131
  v_add_f32 v128, v128, v129
  v_add_f32 v130, v130, v131
  s_nop 1
  v_permlane16_swap_b32 v128, v130
  v_add_f32 v128, v128, v130
  ds_write_b32 v10, v128 offset:0
  v_mov_b32 v0, 161524
  s_mov_b64 exec, 2
  ds_add_u32 v0, v1
  s_mov_b64 exec, -1
  s_add_u32 s60, s93, 32768
  s_lshl_b32 m0, s6, 12
  s_add_u32 m0, m0, 32768
  s_nop 0
  buffer_load_dwordx4 v2, s[8:11], s60 offen offset:0 sc1 lds
  buffer_load_dwordx4 v2, s[8:11], s60 offen offset:1024 sc1 lds
  buffer_load_dwordx4 v2, s[8:11], s60 offen offset:2048 sc1 lds
  buffer_load_dwordx4 v2, s[8:11], s60 offen offset:3072 sc1 lds
  s_add_u32 s60, s58, 8192
  buffer_load_dwordx4 v[160:163], v2, s[8:11], s60 offen offset:0 sc1
  buffer_load_dwordx4 v[164:167], v2, s[8:11], s60 offen offset:1024 sc1
  buffer_load_dwordx4 v[168:171], v2, s[8:11], s60 offen offset:2048 sc1
  buffer_load_dwordx4 v[172:175], v2, s[8:11], s60 offen offset:3072 sc1
  s_add_u32 s60, s58, 12288
  buffer_load_dwordx4 v[176:179], v2, s[8:11], s60 offen offset:0 sc1
  buffer_load_dwordx4 v[180:183], v2, s[8:11], s60 offen offset:1024 sc1
  buffer_load_dwordx4 v[184:187], v2, s[8:11], s60 offen offset:2048 sc1
  buffer_load_dwordx4 v[188:191], v2, s[8:11], s60 offen offset:3072 sc1
  s_add_u32 s56, s97, 8192
  buffer_load_dwordx4 v[64:67], v2, s[8:11], s56 offen offset:0 sc1
  s_add_u32 s56, s97, 8192
  buffer_load_dwordx4 v[68:71], v2, s[8:11], s56 offen offset:1024 sc1
  s_add_u32 s56, s97, 8192
  buffer_load_dwordx4 v[72:75], v2, s[8:11], s56 offen offset:2048 sc1
  s_add_u32 s56, s97, 8192
  buffer_load_dwordx4 v[76:79], v2, s[8:11], s56 offen offset:3072 sc1
  s_add_u32 s56, s97, 12288
  buffer_load_dwordx4 v[80:83], v2, s[8:11], s56 offen offset:0 sc1
  s_add_u32 s56, s97, 12288
  buffer_load_dwordx4 v[84:87], v2, s[8:11], s56 offen offset:1024 sc1
  s_add_u32 s56, s97, 114688
  buffer_load_dwordx4 v[88:91], v2, s[8:11], s56 offen offset:0 sc1
  s_add_u32 s56, s97, 114688
  buffer_load_dwordx4 v[92:95], v2, s[8:11], s56 offen offset:1024 sc1
  s_mov_b32 s59, 16384
  s_waitcnt vmcnt(16)
  ds_read_b128 v[16:19], v56 offset:32768
  ds_read_b128 v[20:23], v56 offset:33792
  ds_read_b128 v[24:27], v56 offset:34816
  ds_read_b128 v[28:31], v56 offset:35840
L_hb7_c:
  s_waitcnt lgkmcnt(2)
  v_max3_u32 v58, v16, v17, v18
  v_max_u32 v58, v58, v19
  v_max3_u32 v58, v58, v20, v21
  v_max3_u32 v58, v58, v22, v23
  s_waitcnt lgkmcnt(0)
  v_max3_u32 v58, v58, v24, v25
  v_max3_u32 v58, v58, v26, v27
  v_max3_u32 v58, v58, v28, v29
  v_max3_u32 v58, v58, v30, v31
  v_cmp_eq_u32 vcc, -1, v58
  s_cbranch_vccnz L_hb7_r
L_hb7_k:
  v_mov_b32 v0, 161520
  s_mov_b64 exec, 2
  ds_add_u32 v0, v1
  s_mov_b64 exec, -1
  s_mul_i32 s54, s4, 224
  s_mul_i32 s55, s6, 14
  s_add_u32 s54, s54, s55
  s_lshl_b32 s54, s54, 10
  s_add_u32 s54, s54, 10485760
  s_add_u32 s55, s54, 114688
  s_setprio 0
  s_add_u32 s56, s97, 18432
  s_lshl_b32 s57, s6, 10
  s_add_u32 m0, s57, 74752
  s_nop 0
  buffer_load_dwordx4 v2, s[8:11], s56 offen sc1 lds
  s_add_u32 s56, s97, 32768
  s_lshl_b32 s57, s6, 10
  s_add_u32 m0, s57, 75776
  s_nop 0
  buffer_load_dwordx4 v2, s[8:11], s56 offen sc1 lds
  s_add_u32 s56, s97, 47104
  s_lshl_b32 s57, s6, 10
  s_add_u32 m0, s57, 76800
  s_nop 0
  buffer_load_dwordx4 v2, s[8:11], s56 offen sc1 lds
  s_add_u32 s56, s97, 61440
  s_lshl_b32 s57, s6, 10
  s_add_u32 m0, s57, 77824
  s_nop 0
  buffer_load_dwordx4 v2, s[8:11], s56 offen sc1 lds
  s_add_u32 s56, s97, 118784
  s_lshl_b32 s57, s6, 10
  s_add_u32 m0, s57, 81920
  s_nop 0
  buffer_load_dwordx4 v2, s[8:11], s56 offen sc1 lds
  s_add_u32 s56, s97, 19456
  s_lshl_b32 s57, s6, 10
  s_add_u32 m0, s57, 82944
  s_nop 0
  buffer_load_dwordx4 v2, s[8:11], s56 offen sc1 lds
  s_add_u32 s56, s97, 33792
  s_lshl_b32 s57, s6, 10
  s_add_u32 m0, s57, 83968
  s_nop 0
  buffer_load_dwordx4 v2, s[8:11], s56 offen sc1 lds
  s_add_u32 s56, s97, 48128
  s_lshl_b32 s57, s6, 10
  s_add_u32 m0, s57, 84992
  s_nop 0
  buffer_load_dwordx4 v2, s[8:11], s56 offen sc1 lds
  s_add_u32 s56, s97, 62464
  s_lshl_b32 s57, s6, 10
  s_add_u32 m0, s57, 86016
  s_nop 0
  buffer_load_dwordx4 v2, s[8:11], s56 offen sc1 lds
  s_add_u32 s56, s97, 119808
  s_lshl_b32 s57, s6, 10
  s_add_u32 m0, s57, 90112
  s_nop 0
  buffer_load_dwordx4 v2, s[8:11], s56 offen sc1 lds
  s_mov_b32 s59, 16384
  s_waitcnt vmcnt(18)
L_st1_c:
  v_max3_u32 v9, v160, v161, v162
  v_max3_u32 v9, v9, v163, v164
  v_max3_u32 v9, v9, v165, v166
  v_max3_u32 v9, v9, v167, v168
  v_max3_u32 v9, v9, v169, v170
  v_max3_u32 v9, v9, v171, v172
  v_max3_u32 v9, v9, v173, v174
  v_max3_u32 v9, v9, v175, v176
  v_max3_u32 v9, v9, v177, v178
  v_max3_u32 v9, v9, v179, v180
  v_max3_u32 v9, v9, v181, v182
  v_max3_u32 v9, v9, v183, v184
  v_max3_u32 v9, v9, v185, v186
  v_max3_u32 v9, v9, v187, v188
  v_max3_u32 v9, v9, v189, v190
  v_max_u32 v9, v9, v191
  v_cmp_eq_u32 vcc, -1, v9
  s_cbranch_vccnz L_st1_r
L_st1_k:
  v_add_f32 v160, v160, v176
  v_add_f32 v161, v161, v177
  v_add_f32 v162, v162, v178
  v_add_f32 v163, v163, v179
  v_add_f32 v164, v164, v180
  v_add_f32 v165, v165, v181
  v_add_f32 v166, v166, v182
  v_add_f32 v167, v167, v183
  v_add_f32 v168, v168, v184
  v_add_f32 v169, v169, v185
  v_add_f32 v170, v170, v186
  v_add_f32 v171, v171, v187
  v_add_f32 v172, v172, v188
  v_add_f32 v173, v173, v189
  v_add_f32 v174, v174, v190
  v_add_f32 v175, v175, v191
  v_add_f32 v160, v160, v168
  v_add_f32 v161, v161, v169
  v_add_f32 v162, v162, v170
  v_add_f32 v163, v163, v171
  v_add_f32 v164, v164, v172
  v_add_f32 v165, v165, v173
  v_add_f32 v166, v166, v174
  v_add_f32 v167, v167, v175
  v_add_f32 v160, v160, v164
  v_add_f32 v161, v161, v165
  v_add_f32 v162, v162, v166
  v_add_f32 v163, v163, v167
  v_permlane32_swap_b32 v160, v161
  s_nop 0
  v_permlane32_swap_b32 v162, v163
  v_add_f32 v160, v160, v161
  v_add_f32 v162, v162, v163
  s_nop 1
  v_permlane16_swap_b32 v160, v162
  v_add_f32 v160, v160, v162
  ds_write_b32 v10, v160 offset:256
  v_mov_b32 v0, 161524
  s_mov_b64 exec, 2
  ds_add_u32 v0, v1
  s_mov_b64 exec, -1
  s_add_u32 s56, s97, 20480
  s_lshl_b32 s57, s6, 10
  s_add_u32 m0, s57, 91136
  s_nop 0
  buffer_load_dwordx4 v2, s[8:11], s56 offen sc1 lds
  s_add_u32 s56, s97, 34816
  s_lshl_b32 s57, s6, 10
  s_add_u32 m0, s57, 92160
  s_nop 0
  buffer_load_dwordx4 v2, s[8:11], s56 offen sc1 lds
  s_add_u32 s56, s97, 49152
  s_lshl_b32 s57, s6, 10
  s_add_u32 m0, s57, 93184
  s_nop 0
  buffer_load_dwordx4 v2, s[8:11], s56 offen sc1 lds
  s_add_u32 s56, s97, 63488
  s_lshl_b32 s57, s6, 10
  s_add_u32 m0, s57, 94208
  s_nop 0
  buffer_load_dwordx4 v2, s[8:11], s56 offen sc1 lds
  s_add_u32 s56, s97, 120832
  s_lshl_b32 s57, s6, 10
  s_add_u32 m0, s57, 98304
  s_nop 0
  buffer_load_dwordx4 v2, s[8:11], s56 offen sc1 lds
  s_add_u32 s56, s97, 21504
  s_lshl_b32 s57, s6, 10
  s_add_u32 m0, s57, 99328
  s_nop 0
  buffer_load_dwordx4 v2, s[8:11], s56 offen sc1 lds
  s_add_u32 s56, s97, 35840
  s_lshl_b32 s57, s6, 10
  s_add_u32 m0, s57, 100352
  s_nop 0
  buffer_load_dwordx4 v2, s[8:11], s56 offen sc1 lds
  s_add_u32 s56, s97, 50176
  s_lshl_b32 s57, s6, 10
  s_add_u32 m0, s57, 101376
  s_nop 0
  buffer_load_dwordx4 v2, s[8:11], s56 offen sc1 lds
  s_add_u32 s56, s97, 64512
  s_lshl_b32 s57, s6, 10
  s_add_u32 m0, s57, 102400
  s_nop 0
  buffer_load_dwordx4 v2, s[8:11], s56 offen sc1 lds
  s_add_u32 s56, s97, 121856
  s_lshl_b32 s57, s6, 10
  s_add_u32 m0, s57, 106496
  s_nop 0
  buffer_load_dwordx4 v2, s[8:11], s56 offen sc1 lds
  s_add_u32 s56, s97, 22528
  s_lshl_b32 s57, s6, 10
  s_add_u32 m0, s57, 107520
  s_nop 0
  buffer_load_dwordx4 v2, s[8:11], s56 offen sc1 lds
  s_add_u32 s56, s97, 36864
  s_lshl_b32 s57, s6, 10
  s_add_u32 m0, s57, 108544
  s_nop 0
  buffer_load_dwordx4 v2, s[8:11], s56 offen sc1 lds
  s_add_u32 s56, s97, 51200
  s_lshl_b32 s57, s6, 10
  s_add_u32 m0, s57, 109568
  s_nop 0
  buffer_load_dwordx4 v2, s[8:11], s56 offen sc1 lds
  s_add_u32 s56, s97, 65536
  s_lshl_b32 s57, s6, 10
  s_add_u32 m0, s57, 110592
  s_nop 0
  buffer_load_dwordx4 v2, s[8:11], s56 offen sc1 lds
  s_add_u32 s56, s97, 122880
  s_lshl_b32 s57, s6, 10
  s_add_u32 m0, s57, 114688
  s_nop 0
  buffer_load_dwordx4 v2, s[8:11], s56 offen sc1 lds
  s_add_u32 s56, s97, 23552
  s_lshl_b32 s57, s6, 10
  s_add_u32 m0, s57, 115712
  s_nop 0
  buffer_load_dwordx4 v2, s[8:11], s56 offen sc1 lds
  s_add_u32 s56, s97, 37888
  s_lshl_b32 s57, s6, 10
  s_add_u32 m0, s57, 116736
  s_nop 0
  buffer_load_dwordx4 v2, s[8:11], s56 offen sc1 lds
  s_add_u32 s56, s97, 52224
  s_lshl_b32 s57, s6, 10
  s_add_u32 m0, s57, 117760
  s_nop 0
  buffer_load_dwordx4 v2, s[8:11], s56 offen sc1 lds
  s_add_u32 s56, s97, 66560
  s_lshl_b32 s57, s6, 10
  s_add_u32 m0, s57, 118784
  s_nop 0
  buffer_load_dwordx4 v2, s[8:11], s56 offen sc1 lds
  s_add_u32 s56, s97, 123904
  s_lshl_b32 s57, s6, 10
  s_add_u32 m0, s57, 122880
  s_nop 0
  buffer_load_dwordx4 v2, s[8:11], s56 offen sc1 lds
  s_add_u32 s56, s97, 24576
  s_lshl_b32 s57, s6, 10
  s_add_u32 m0, s57, 123904
  s_nop 0
  buffer_load_dwordx4 v2, s[8:11], s56 offen sc1 lds
  s_add_u32 s56, s97, 38912
  s_lshl_b32 s57, s6, 10
  s_add_u32 m0, s57, 124928
  s_nop 0
  buffer_load_dwordx4 v2, s[8:11], s56 offen sc1 lds
  s_add_u32 s56, s97, 53248
  s_lshl_b32 s57, s6, 10
  s_add_u32 m0, s57, 125952
  s_nop 0
  buffer_load_dwordx4 v2, s[8:11], s56 offen sc1 lds
  s_add_u32 s56, s97, 67584
  s_lshl_b32 s57, s6, 10
  s_add_u32 m0, s57, 126976
  s_nop 0
  buffer_load_dwordx4 v2, s[8:11], s56 offen sc1 lds
  s_add_u32 s56, s97, 124928
  s_lshl_b32 s57, s6, 10
  s_add_u32 m0, s57, 131072
  s_nop 0
  buffer_load_dwordx4 v2, s[8:11], s56 offen sc1 lds
  v_mov_b32 v14, 161492
  s_mov_b32 s59, 16384
L_lf_173:
  ds_read_b32 v15, v14
  s_waitcnt lgkmcnt(0)
  v_readfirstlane_b32 s56, v15
  s_nop 0
  s_cmp_ge_u32 s56, 1
  s_cbranch_scc1 L_lf_173_ok
  s_sub_u32 s59, s59, 1
  s_cmp_lg_u32 s59, 0
  s_cbranch_scc1 L_lf_173
  s_or_b32 s27, s27, 32
L_lf_173_ok:
  s_add_u32 s60, s54, 0
  buffer_load_dwordx4 v[128:131], v2, s[8:11], s60 offen offset:0 sc1
  buffer_load_dwordx4 v[132:135], v2, s[8:11], s60 offen offset:1024 sc1
  buffer_load_dwordx4 v[136:139], v2, s[8:11], s60 offen offset:2048 sc1
  buffer_load_dwordx4 v[140:143], v2, s[8:11], s60 offen offset:3072 sc1
  s_add_u32 s60, s54, 4096
  buffer_load_dwordx4 v[144:147], v2, s[8:11], s60 offen offset:0 sc1
  buffer_load_dwordx4 v[148:151], v2, s[8:11], s60 offen offset:1024 sc1
  buffer_load_dwordx4 v[152:155], v2, s[8:11], s60 offen offset:2048 sc1
  buffer_load_dwordx4 v[156:159], v2, s[8:11], s60 offen offset:3072 sc1
  s_add_u32 s60, s54, 8192
  buffer_load_dwordx4 v[160:163], v2, s[8:11], s60 offen offset:0 sc1
  buffer_load_dwordx4 v[164:167], v2, s[8:11], s60 offen offset:1024 sc1
  buffer_load_dwordx4 v[168:171], v2, s[8:11], s60 offen offset:2048 sc1
  buffer_load_dwordx4 v[172:175], v2, s[8:11], s60 offen offset:3072 sc1
  s_add_u32 s60, s54, 12288
  buffer_load_dwordx4 v[176:179], v2, s[8:11], s60 offen offset:0 sc1
  buffer_load_dwordx4 v[180:183], v2, s[8:11], s60 offen offset:1024 sc1
  s_waitcnt vmcnt(0)
L_p4_done:
  s_add_u32 s56, s97, 126976
  buffer_load_dwordx4 v[60:63], v2, s[8:11], s56 offen offset:1024 sc1
  s_mov_b32 s16, s46
  s_mov_b32 s17, s47
  s_mov_b32 s18, 1024
  s_mov_b32 s19, 0x20000
  v_lshrrev_b32 v10, 5, v1
  v_lshlrev_b32 v10, 3, v10
  s_lshl_b32 s56, s26, 4
  s_add_u32 s56, s56, s92
  buffer_load_dwordx2 v[14:15], v10, s[16:19], s56 offen
  s_lshl_b32 s57, s24, 1
  s_add_u32 s57, s57, s25
  s_lshl_b32 s56, s5, 2
  s_add_u32 s56, s56, s57
  s_lshl_b32 s56, s56, 10
  s_lshl_b32 s57, s26, 3
  s_add_u32 s56, s56, s57
  v_add_u32 v12, s56, v2
  ds_read_b64 v[8:9], v12 offset:32768
  ds_read_b64 v[48:49], v12
  s_lshl_b32 s56, s6, 10
  s_add_u32 s56, s56, 65536
  v_add_u32 v10, s56, v2
  v_add_u32 v11, 65536, v10
  s_waitcnt lgkmcnt(0)
  v_mov_b32 v0, 161520
  s_mov_b64 exec, 2
  ds_add_u32 v0, v1
  s_mov_b64 exec, -1
  s_lshl_b32 s56, s6, 11
  v_add_u32 v12, s56, v2
  s_mov_b32 s59, 16384
  s_mov_b32 s20, s48
  s_mov_b32 s21, s49
  s_mov_b32 s22, 2097152
  s_mov_b32 s23, 0x20000
  s_setprio 1
  s_waitcnt vmcnt(17)
L_h10_c0:
  v_max3_u32 v13, v128, v129, v130
  v_max_u32 v13, v13, v131
  v_cmp_eq_u32 vcc, -1, v13
  s_cbranch_vccnz L_h10_r0
L_h10_k0:
  v_mfma_f32_32x32x16_bf16 v[240:255], v[96:99], v[128:131], 0
  s_waitcnt vmcnt(16)
L_h10_c1:
  v_max3_u32 v13, v132, v133, v134
  v_max_u32 v13, v13, v135
  v_cmp_eq_u32 vcc, -1, v13
  s_cbranch_vccnz L_h10_r1
L_h10_k1:
  v_mfma_f32_32x32x16_bf16 v[240:255], v[100:103], v[132:135], v[240:255]
  s_waitcnt vmcnt(15)
L_h10_c2:
  v_max3_u32 v13, v136, v137, v138
  v_max_u32 v13, v13, v139
  v_cmp_eq_u32 vcc, -1, v13
  s_cbranch_vccnz L_h10_r2
L_h10_k2:
  v_mfma_f32_32x32x16_bf16 v[240:255], v[104:107], v[136:139], v[240:255]
  s_waitcnt vmcnt(14)
L_h10_c3:
  v_max3_u32 v13, v140, v141, v142
  v_max_u32 v13, v13, v143
  v_cmp_eq_u32 vcc, -1, v13
  s_cbranch_vccnz L_h10_r3
L_h10_k3:
  v_mfma_f32_32x32x16_bf16 v[240:255], v[108:111], v[140:143], v[240:255]
  s_waitcnt vmcnt(13)
L_h10_c4:
  v_max3_u32 v13, v144, v145, v146
  v_max_u32 v13, v13, v147
  v_cmp_eq_u32 vcc, -1, v13
  s_cbranch_vccnz L_h10_r4
L_h10_k4:
  v_mfma_f32_32x32x16_bf16 v[240:255], v[112:115], v[144:147], v[240:255]
  s_waitcnt vmcnt(12)
L_h10_c5:
  v_max3_u32 v13, v148, v149, v150
  v_max_u32 v13, v13, v151
  v_cmp_eq_u32 vcc, -1, v13
  s_cbranch_vccnz L_h10_r5
L_h10_k5:
  v_mfma_f32_32x32x16_bf16 v[240:255], v[116:119], v[148:151], v[240:255]
  s_waitcnt vmcnt(11)
L_h10_c6:
  v_max3_u32 v13, v152, v153, v154
  v_max_u32 v13, v13, v155
  v_cmp_eq_u32 vcc, -1, v13
  s_cbranch_vccnz L_h10_r6
L_h10_k6:
  v_mfma_f32_32x32x16_bf16 v[240:255], v[120:123], v[152:155], v[240:255]
  s_waitcnt vmcnt(10)
L_h10_c7:
  v_max3_u32 v13, v156, v157, v158
  v_max_u32 v13, v13, v159
  v_cmp_eq_u32 vcc, -1, v13
  s_cbranch_vccnz L_h10_r7
L_h10_k7:
  v_mfma_f32_32x32x16_bf16 v[240:255], v[124:127], v[156:159], v[240:255]
  s_waitcnt vmcnt(7)
L_h10_c8:
  v_max3_u32 v13, v160, v161, v162
  v_max_u32 v13, v13, v163
  v_cmp_eq_u32 vcc, -1, v13
  s_cbranch_vccnz L_h10_r8
L_h10_k8:
  v_mfma_f32_32x32x16_bf16 v[240:255], v[64:67], v[160:163], v[240:255]
  s_waitcnt vmcnt(6)
L_h10_c9:
  v_max3_u32 v13, v164, v165, v166
  v_max_u32 v13, v13, v167
  v_cmp_eq_u32 vcc, -1, v13
  s_cbranch_vccnz L_h10_r9
L_h10_k9:
  v_mfma_f32_32x32x16_bf16 v[240:255], v[68:71], v[164:167], v[240:255]
  s_waitcnt vmcnt(5)
L_h10_c10:
  v_max3_u32 v13, v168, v169, v170
  v_max_u32 v13, v13, v171
  v_cmp_eq_u32 vcc, -1, v13
  s_cbranch_vccnz L_h10_r10
L_h10_k10:
  v_mfma_f32_32x32x16_bf16 v[240:255], v[72:75], v[168:171], v[240:255]
  s_waitcnt vmcnt(4)
L_h10_c11:
  v_max3_u32 v13, v172, v173, v174
  v_max_u32 v13, v13, v175
  v_cmp_eq_u32 vcc, -1, v13
  s_cbranch_vccnz L_h10_r11
L_h10_k11:
  v_mfma_f32_32x32x16_bf16 v[240:255], v[76:79], v[172:175], v[240:255]
  s_waitcnt vmcnt(3)
L_h10_c12:
  v_max3_u32 v13, v176, v177, v178
  v_max_u32 v13, v13, v179
  v_cmp_eq_u32 vcc, -1, v13
  s_cbranch_vccnz L_h10_r12
L_h10_k12:
  s_mov_b32 s59, 16384
L_lw_174:
  v_mov_b32 v0, 161520
  ds_read_b32 v0, v0
  s_waitcnt lgkmcnt(0)
  v_readfirstlane_b32 s61, v0
  s_nop 0
  s_cmp_ge_u32 s61, 16
  s_cbranch_scc0 L_lw_174_r
L_lw_174_ok:
  ds_read_b128 v[32:35], v10 offset:0
  ds_read_b128 v[36:39], v10 offset:8192
  ds_read_b128 v[40:43], v10 offset:16384
  ds_read_b128 v[44:47], v10 offset:24576
  v_mfma_f32_32x32x16_bf16 v[240:255], v[80:83], v[176:179], v[240:255]
  s_waitcnt vmcnt(2)
L_h10_c13:
  v_max3_u32 v13, v180, v181, v182
  v_max_u32 v13, v13, v183
  v_cmp_eq_u32 vcc, -1, v13
  s_cbranch_vccnz L_h10_r13
L_h10_k13:
  v_mfma_f32_32x32x16_bf16 v[240:255], v[84:87], v[180:183], v[240:255]
  v_mfma_f32_32x32x16_bf16 v[16:31], v[88:91], v[128:131], 0
  s_add_u32 s3, s55, 0
  buffer_load_dwordx4 v[184:187], v2, s[8:11], s3 offen offset:0 sc1
  v_mfma_f32_32x32x16_bf16 v[16:31], v[92:95], v[132:135], v[16:31]
  buffer_load_dwordx4 v[188:191], v2, s[8:11], s3 offen offset:1024 sc1
  s_waitcnt lgkmcnt(3)
  v_mfma_f32_32x32x16_bf16 v[16:31], v[32:35], v[136:139], v[16:31]
  ds_read_b128 v[32:35], v10 offset:32768
  buffer_load_dwordx4 v[192:195], v2, s[8:11], s3 offen offset:2048 sc1
  s_nop 2
  ds_write_b128 v12, v[240:243] offset:0
  s_waitcnt lgkmcnt(4)
  v_mfma_f32_32x32x16_bf16 v[16:31], v[36:39], v[140:143], v[16:31]
  ds_read_b128 v[36:39], v10 offset:40960
  buffer_load_dwordx4 v[196:199], v2, s[8:11], s3 offen offset:3072 sc1
  s_waitcnt lgkmcnt(4)
  v_mfma_f32_32x32x16_bf16 v[16:31], v[40:43], v[144:147], v[16:31]
  ds_read_b128 v[40:43], v10 offset:49152
  s_add_u32 s3, s55, 4096
  buffer_load_dwordx4 v[200:203], v2, s[8:11], s3 offen offset:0 sc1
  ds_write_b128 v12, v[244:247] offset:1024
  s_waitcnt lgkmcnt(5)
  v_mfma_f32_32x32x16_bf16 v[16:31], v[44:47], v[148:151], v[16:31]
  ds_read_b128 v[44:47], v10 offset:57344
  buffer_load_dwordx4 v[204:207], v2, s[8:11], s3 offen offset:1024 sc1
  s_waitcnt lgkmcnt(5)
  v_mfma_f32_32x32x16_bf16 v[16:31], v[32:35], v[152:155], v[16:31]
  ds_read_b128 v[32:35], v11 offset:0
  buffer_load_dwordx4 v[208:211], v2, s[8:11], s3 offen offset:2048 sc1
  ds_write_b128 v12, v[248:251] offset:32768
  s_waitcnt lgkmcnt(5)
  v_mfma_f32_32x32x16_bf16 v[16:31], v[36:39], v[156:159], v[16:31]
  ds_read_b128 v[36:39], v11 offset:8192
  buffer_load_dwordx4 v[212:215], v2, s[8:11], s3 offen offset:3072 sc1
  s_waitcnt lgkmcnt(5)
  v_mfma_f32_32x32x16_bf16 v[16:31], v[40:43], v[160:163], v[16:31]
  ds_read_b128 v[40:43], v11 offset:16384
  ds_write_b128 v12, v[252:255] offset:33792
  s_waitcnt lgkmcnt(5)
  v_mfma_f32_32x32x16_bf16 v[16:31], v[44:47], v[164:167], v[16:31]
  s_waitcnt lgkmcnt(4)
  v_mfma_f32_32x32x16_bf16 v[16:31], v[32:35], v[168:171], v[16:31]
  s_add_u32 s3, s55, 8192
  buffer_load_dwordx4 v[216:219], v2, s[8:11], s3 offen offset:0 sc1
  s_waitcnt lgkmcnt(2)
  v_mfma_f32_32x32x16_bf16 v[16:31], v[36:39], v[172:175], v[16:31]
  buffer_load_dwordx4 v[220:223], v2, s[8:11], s3 offen offset:1024 sc1
  s_waitcnt lgkmcnt(1)
  v_mfma_f32_32x32x16_bf16 v[16:31], v[40:43], v[176:179], v[16:31]
  buffer_load_dwordx4 v[224:227], v2, s[8:11], s3 offen offset:2048 sc1
  s_waitcnt vmcnt(12)
  v_mfma_f32_32x32x16_bf16 v[16:31], v[60:63], v[180:183], v[16:31]
  buffer_load_dwordx4 v[228:231], v2, s[8:11], s3 offen offset:3072 sc1
  s_waitcnt vmcnt(11)
L_h11_c0:
  v_max3_u32 v13, v184, v185, v186
  v_max_u32 v13, v13, v187
  v_cmp_eq_u32 vcc, -1, v13
  s_cbranch_vccnz L_h11_r0
L_h11_k0:
  v_mfma_f32_32x32x16_bf16 v[128:143], v[96:99], v[184:187], 0
  s_add_u32 s3, s55, 12288
  buffer_load_dwordx4 v[232:235], v2, s[8:11], s3 offen offset:0 sc1
  s_waitcnt vmcnt(11)
L_h11_c1:
  v_max3_u32 v13, v188, v189, v190
  v_max_u32 v13, v13, v191
  v_cmp_eq_u32 vcc, -1, v13
  s_cbranch_vccnz L_h11_r1
L_h11_k1:
  v_mfma_f32_32x32x16_bf16 v[128:143], v[100:103], v[188:191], v[128:143]
  buffer_load_dwordx4 v[236:239], v2, s[8:11], s3 offen offset:1024 sc1
  s_waitcnt vmcnt(11)
L_h11_c2:
  v_max3_u32 v13, v192, v193, v194
  v_max_u32 v13, v13, v195
  v_cmp_eq_u32 vcc, -1, v13
  s_cbranch_vccnz L_h11_r2
L_h11_k2:
  v_mfma_f32_32x32x16_bf16 v[128:143], v[104:107], v[192:195], v[128:143]
  ds_write_b128 v12, v[16:19] offset:16384
  s_waitcnt vmcnt(10)
L_h11_c3:
  v_max3_u32 v13, v196, v197, v198
  v_max_u32 v13, v13, v199
  v_cmp_eq_u32 vcc, -1, v13
  s_cbranch_vccnz L_h11_r3
L_h11_k3:
  v_mfma_f32_32x32x16_bf16 v[128:143], v[108:111], v[196:199], v[128:143]
  s_waitcnt vmcnt(9)
L_h11_c4:
  v_max3_u32 v13, v200, v201, v202
  v_max_u32 v13, v13, v203
  v_cmp_eq_u32 vcc, -1, v13
  s_cbranch_vccnz L_h11_r4
L_h11_k4:
  v_mfma_f32_32x32x16_bf16 v[128:143], v[112:115], v[200:203], v[128:143]
  ds_write_b128 v12, v[20:23] offset:17408
  s_waitcnt vmcnt(8)
L_h11_c5:
  v_max3_u32 v13, v204, v205, v206
  v_max_u32 v13, v13, v207
  v_cmp_eq_u32 vcc, -1, v13
  s_cbranch_vccnz L_h11_r5
L_h11_k5:
  v_mfma_f32_32x32x16_bf16 v[128:143], v[116:119], v[204:207], v[128:143]
  s_waitcnt vmcnt(7)
L_h11_c6:
  v_max3_u32 v13, v208, v209, v210
  v_max_u32 v13, v13, v211
  v_cmp_eq_u32 vcc, -1, v13
  s_cbranch_vccnz L_h11_r6
L_h11_k6:
  v_mfma_f32_32x32x16_bf16 v[128:143], v[120:123], v[208:211], v[128:143]
  ds_write_b128 v12, v[24:27] offset:49152
  s_waitcnt vmcnt(6)
L_h11_c7:
  v_max3_u32 v13, v212, v213, v214
  v_max_u32 v13, v13, v215
  v_cmp_eq_u32 vcc, -1, v13
  s_cbranch_vccnz L_h11_r7
L_h11_k7:
  v_mfma_f32_32x32x16_bf16 v[128:143], v[124:127], v[212:215], v[128:143]
  s_waitcnt vmcnt(5)
L_h11_c8:
  v_max3_u32 v13, v216, v217, v218
  v_max_u32 v13, v13, v219
  v_cmp_eq_u32 vcc, -1, v13
  s_cbranch_vccnz L_h11_r8
L_h11_k8:
  v_mfma_f32_32x32x16_bf16 v[128:143], v[64:67], v[216:219], v[128:143]
  ds_write_b128 v12, v[28:31] offset:50176
  s_waitcnt vmcnt(4)
L_h11_c9:
  v_max3_u32 v13, v220, v221, v222
  v_max_u32 v13, v13, v223
  v_cmp_eq_u32 vcc, -1, v13
  s_cbranch_vccnz L_h11_r9
L_h11_k9:
  v_mfma_f32_32x32x16_bf16 v[128:143], v[68:71], v[220:223], v[128:143]
  s_waitcnt vmcnt(3)
L_h11_c10:
  v_max3_u32 v13, v224, v225, v226
  v_max_u32 v13, v13, v227
  v_cmp_eq_u32 vcc, -1, v13
  s_cbranch_vccnz L_h11_r10
L_h11_k10:
  v_mfma_f32_32x32x16_bf16 v[128:143], v[72:75], v[224:227], v[128:143]
  s_waitcnt lgkmcnt(0)
  s_barrier
  s_waitcnt vmcnt(2)
L_h11_c11:
  v_max3_u32 v13, v228, v229, v230
  v_max_u32 v13, v13, v231
  v_cmp_eq_u32 vcc, -1, v13
  s_cbranch_vccnz L_h11_r11
L_h11_k11:
  v_mfma_f32_32x32x16_bf16 v[128:143], v[76:79], v[228:231], v[128:143]
  s_lshl_b32 s56, s100, 14
  s_lshl_b32 s57, s26, 10
  s_add_u32 s56, s56, s57
  v_add_u32 v52, s56, v2
  ds_read_b128 v[160:163], v52 offset:0
  ds_read_b128 v[164:167], v52 offset:2048
  ds_read_b128 v[168:171], v52 offset:4096
  v_lshlrev_b32 v16, 16, v48
  v_and_b32 v17, 0xffff0000, v48
  v_lshlrev_b32 v18, 16, v49
  v_and_b32 v19, 0xffff0000, v49
  s_waitcnt vmcnt(1)
L_h11_c12:
  v_max3_u32 v13, v232, v233, v234
  v_max_u32 v13, v13, v235
  v_cmp_eq_u32 vcc, -1, v13
  s_cbranch_vccnz L_h11_r12
L_h11_k12:
  ds_read_b128 v[32:35], v10 offset:0
  ds_read_b128 v[36:39], v10 offset:8192
  ds_read_b128 v[40:43], v10 offset:16384
  ds_read_b128 v[44:47], v10 offset:24576
  v_mfma_f32_32x32x16_bf16 v[128:143], v[80:83], v[232:235], v[128:143]
  v_lshlrev_b32 v24, 16, v14
  v_and_b32 v25, 0xffff0000, v14
  v_lshlrev_b32 v26, 16, v15
  v_and_b32 v27, 0xffff0000, v15
  v_add_f32 v16, v16, v24
  v_add_f32 v17, v17, v25
  v_add_f32 v18, v18, v26
  v_add_f32 v19, v19, v27
  s_lshl_b32 s56, s26, 15
  v_subrev_u32 v53, s56, v3
  s_waitcnt vmcnt(0)
L_h11_c13:
  v_max3_u32 v13, v236, v237, v238
  v_max_u32 v13, v13, v239
  v_cmp_eq_u32 vcc, -1, v13
  s_cbranch_vccnz L_h11_r13
L_h11_k13:
  v_mfma_f32_32x32x16_bf16 v[128:143], v[84:87], v[236:239], v[128:143]
  s_waitcnt lgkmcnt(6)
  v_add_f32 v16, v16, v160
  v_add_f32 v17, v17, v161
  v_add_f32 v18, v18, v162
  v_add_f32 v19, v19, v163
  ds_read_b128 v[160:163], v52 offset:6144
  v_mfma_f32_32x32x16_bf16 v[144:159], v[88:91], v[184:187], 0
  v_mfma_f32_32x32x16_bf16 v[144:159], v[92:95], v[188:191], v[144:159]
  s_waitcnt lgkmcnt(6)
  v_add_f32 v16, v16, v164
  v_add_f32 v17, v17, v165
  v_add_f32 v18, v18, v166
  v_add_f32 v19, v19, v167
  ds_read_b128 v[164:167], v52 offset:8192
  s_waitcnt lgkmcnt(5)
  v_mfma_f32_32x32x16_bf16 v[144:159], v[32:35], v[192:195], v[144:159]
  ds_read_b128 v[32:35], v10 offset:32768
  s_waitcnt lgkmcnt(5)
  v_mfma_f32_32x32x16_bf16 v[144:159], v[36:39], v[196:199], v[144:159]
  ds_read_b128 v[36:39], v10 offset:40960
  v_add_f32 v16, v16, v168
  v_add_f32 v17, v17, v169
  v_add_f32 v18, v18, v170
  v_add_f32 v19, v19, v171
  ds_read_b128 v[168:171], v52 offset:10240
  s_waitcnt lgkmcnt(6)
  v_mfma_f32_32x32x16_bf16 v[144:159], v[40:43], v[200:203], v[144:159]
  ds_read_b128 v[40:43], v10 offset:49152
  s_waitcnt lgkmcnt(6)
  v_mfma_f32_32x32x16_bf16 v[144:159], v[44:47], v[204:207], v[144:159]
  ds_read_b128 v[44:47], v10 offset:57344
  s_waitcnt lgkmcnt(6)
  v_add_f32 v16, v16, v160
  v_add_f32 v17, v17, v161
  v_add_f32 v18, v18, v162
  v_add_f32 v19, v19, v163
  ds_read_b128 v[160:163], v52 offset:12288
  s_waitcnt lgkmcnt(5)
  v_mfma_f32_32x32x16_bf16 v[144:159], v[32:35], v[208:211], v[144:159]
  ds_read_b128 v[32:35], v11 offset:0
  ds_write_b128 v10, v[128:131] offset:0
  s_waitcnt lgkmcnt(6)
  v_mfma_f32_32x32x16_bf16 v[144:159], v[36:39], v[212:215], v[144:159]
  ds_read_b128 v[36:39], v11 offset:8192
  v_add_f32 v16, v16, v164
  v_add_f32 v17, v17, v165
  v_add_f32 v18, v18, v166
  v_add_f32 v19, v19, v167
  ds_read_b128 v[164:167], v52 offset:14336
  s_waitcnt lgkmcnt(6)
  v_mfma_f32_32x32x16_bf16 v[144:159], v[40:43], v[216:219], v[144:159]
  ds_read_b128 v[40:43], v11 offset:16384
  ds_write_b128 v10, v[132:135] offset:8192
  s_waitcnt lgkmcnt(7)
  v_mfma_f32_32x32x16_bf16 v[144:159], v[44:47], v[220:223], v[144:159]
  v_add_f32 v16, v16, v168
  v_add_f32 v17, v17, v169
  v_add_f32 v18, v18, v170
  v_add_f32 v19, v19, v171
  s_waitcnt lgkmcnt(5)
  v_mfma_f32_32x32x16_bf16 v[144:159], v[32:35], v[224:227], v[144:159]
  ds_write_b128 v10, v[136:139] offset:16384
  s_waitcnt lgkmcnt(4)
  v_mfma_f32_32x32x16_bf16 v[144:159], v[36:39], v[228:231], v[144:159]
  v_add_f32 v16, v16, v160
  v_add_f32 v17, v17, v161
  v_add_f32 v18, v18, v162
  v_add_f32 v19, v19, v163
  s_waitcnt lgkmcnt(2)
  v_mfma_f32_32x32x16_bf16 v[144:159], v[40:43], v[232:235], v[144:159]
  ds_write_b128 v10, v[140:143] offset:24576
  v_mfma_f32_32x32x16_bf16 v[144:159], v[60:63], v[236:239], v[144:159]
  v_add_f32 v16, v16, v164
  v_add_f32 v17, v17, v165
  v_add_f32 v18, v18, v166
  v_add_f32 v19, v19, v167
  v_cvt_pk_bf16_f32 v16, v16, v17
  v_cvt_pk_bf16_f32 v17, v18, v19
  s_lshl_b32 s57, s26, 4
  s_add_u32 s57, s57, s92
  buffer_store_dwordx2 v[16:17], v53, s[20:23], s57 offen
L_p5_fin:
  s_nop 7
  s_nop 3
  s_setprio 0
  ds_write_b128 v10, v[144:147] offset:32768
  ds_write_b128 v10, v[148:151] offset:40960
  ds_write_b128 v10, v[152:155] offset:49152
  ds_write_b128 v10, v[156:159] offset:57344
  s_lshl_b32 s56, s24, 2
  s_lshl_b32 s57, s25, 1
  s_add_u32 s56, s56, s57
  s_add_u32 s56, s56, s26
  s_lshl_b32 s56, s56, 13
  s_add_u32 s56, s56, 65536
  v_add_u32 v13, s56, v2
  s_lshl_b32 s57, s26, 4
  s_add_u32 s57, s57, s92
  s_cmp_eq_u32 s26, 0
  s_cselect_b32 s56, 32768, 0
  s_add_u32 s57, s57, s56
  v_lshlrev_b32 v24, 16, v8
  v_and_b32 v25, 0xffff0000, v8
  v_lshlrev_b32 v28, 16, v14
  v_and_b32 v29, 0xffff0000, v14
  v_lshlrev_b32 v26, 16, v9
  v_and_b32 v27, 0xffff0000, v9
  v_lshlrev_b32 v30, 16, v15
  v_and_b32 v31, 0xffff0000, v15
  v_add_f32 v24, v24, v28
  v_add_f32 v25, v25, v29
  v_add_f32 v26, v26, v30
  v_add_f32 v27, v27, v31
  s_waitcnt lgkmcnt(0)
  s_barrier
  ds_read_b128 v[64:67], v13 offset:0
  ds_read_b128 v[68:71], v13 offset:1024
  ds_read_b128 v[72:75], v13 offset:2048
  ds_read_b128 v[76:79], v13 offset:3072
  ds_read_b128 v[80:83], v13 offset:4096
  ds_read_b128 v[84:87], v13 offset:5120
  ds_read_b128 v[88:91], v13 offset:6144
  ds_read_b128 v[92:95], v13 offset:7168
  s_waitcnt lgkmcnt(6)
  v_add_f32 v64, v64, v68
  v_add_f32 v65, v65, v69
  v_add_f32 v66, v66, v70
  v_add_f32 v67, v67, v71
  v_add_f32 v24, v24, v64
  v_add_f32 v25, v25, v65
  v_add_f32 v26, v26, v66
  v_add_f32 v27, v27, v67
  s_waitcnt lgkmcnt(4)
  v_add_f32 v72, v72, v76
  v_add_f32 v73, v73, v77
  v_add_f32 v74, v74, v78
  v_add_f32 v75, v75, v79
  v_add_f32 v24, v24, v72
  v_add_f32 v25, v25, v73
  v_add_f32 v26, v26, v74
  v_add_f32 v27, v27, v75
  s_waitcnt lgkmcnt(2)
  v_add_f32 v80, v80, v84
  v_add_f32 v81, v81, v85
  v_add_f32 v82, v82, v86
  v_add_f32 v83, v83, v87
  v_add_f32 v24, v24, v80
  v_add_f32 v25, v25, v81
  v_add_f32 v26, v26, v82
  v_add_f32 v27, v27, v83
  s_waitcnt lgkmcnt(0)
  v_add_f32 v88, v88, v92
  v_add_f32 v89, v89, v93
  v_add_f32 v90, v90, v94
  v_add_f32 v91, v91, v95
  v_add_f32 v24, v24, v88
  v_add_f32 v25, v25, v89
  v_add_f32 v26, v26, v90
  v_add_f32 v27, v27, v91
  v_cvt_pk_bf16_f32 v24, v24, v25
  v_cvt_pk_bf16_f32 v25, v26, v27
  buffer_store_dwordx2 v[24:25], v3, s[20:23], s57 offen
  s_cmp_eq_u32 s27, 0
  s_cbranch_scc1 L_noerr
  s_mov_b32 s16, s50
  s_mov_b32 s17, s51
  s_mov_b32 s18, 256
  s_mov_b32 s19, 0x20000
  v_mov_b32 v10, s27
  v_mov_b32 v11, 0
  buffer_atomic_or v10, v11, s[16:19], 0 offen
L_noerr:
L_end:
  s_endpgm
L_lw_31_r:
  s_sub_u32 s59, s59, 1
  s_cmp_lg_u32 s59, 0
  s_cbranch_scc1 L_lw_31
  s_or_b32 s27, s27, 64
  s_branch L_lw_31_ok
L_lw_32_r:
  s_sub_u32 s59, s59, 1
  s_cmp_lg_u32 s59, 0
  s_cbranch_scc1 L_lw_32
  s_or_b32 s27, s27, 2
  s_branch L_lw_32_ok
L_hs_33:
  buffer_store_dwordx4 v[116:119], v2, s[8:11], s56 offen offset:0 sc1
  buffer_store_dwordx4 v[116:119], v2, s[8:11], s56 offen offset:1024 sc1
  s_branch L_hd_34
L_hs_35:
  buffer_store_dwordx4 v[116:119], v2, s[8:11], s56 offen offset:0 sc1
  buffer_store_dwordx4 v[116:119], v2, s[8:11], s56 offen offset:1024 sc1
  s_branch L_hd_36
L_hs_37:
  buffer_store_dwordx4 v[116:119], v2, s[8:11], s56 offen sc1
  s_branch L_hd_38
L_hs_39:
  buffer_store_dwordx4 v[116:119], v2, s[8:11], s56 offen offset:0 sc1
  s_branch L_hd_40
L_hs_41:
  buffer_store_dwordx4 v[116:119], v2, s[8:11], s56 offen offset:0 sc1
  buffer_store_dwordx4 v[116:119], v2, s[8:11], s56 offen offset:1024 sc1
  s_branch L_hd_42
L_hs_43:
  buffer_store_dwordx4 v[116:119], v2, s[8:11], s56 offen offset:0 sc1
  buffer_store_dwordx4 v[116:119], v2, s[8:11], s56 offen offset:1024 sc1
  s_branch L_hd_44
L_hs_45:
  buffer_store_dwordx4 v[116:119], v2, s[8:11], s56 offen offset:0 sc1
  buffer_store_dwordx4 v[116:119], v2, s[8:11], s56 offen offset:1024 sc1
  s_branch L_hd_46
L_lw_48_r:
  s_sub_u32 s59, s59, 1
  s_cmp_lg_u32 s59, 0
  s_cbranch_scc1 L_lw_48
  s_or_b32 s27, s27, 128
  s_branch L_lw_48_ok
L_lw_50_r:
  s_sub_u32 s59, s59, 1
  s_cmp_lg_u32 s59, 0
  s_cbranch_scc1 L_lw_50
  s_or_b32 s27, s27, 2
  s_branch L_lw_50_ok
L_w7_52:
  v_and_b32 v14, 31, v1
  s_lshl_b32 s56, s5, 5
  v_add_u32 v14, s56, v14
  v_lshlrev_b32 v120, 7, v14
  s_mov_b32 s56, 22020096
  s_mov_b32 s101, 0
  s_mov_b32 exec_lo, 0xffffffff
  s_mov_b32 exec_hi, 0x0
  buffer_load_dword v122, v120, s[8:11], s56 offen sc1
  s_mov_b64 exec, -1
  s_branch L_w7b_53
L_w7_54:
  s_cmp_eq_u32 s101, 1
  s_cbranch_scc1 L_rdy_175_x
  s_mov_b32 exec_lo, 0xffffffff
  s_mov_b32 exec_hi, 0x0
L_rdy_175:
  s_waitcnt vmcnt(0)
  v_cmp_ne_u32 vcc, s7, v122
  s_cbranch_vccz L_rdy_175_ok
  s_mov_b32 s56, 22020096
  buffer_load_dword v122, v120, s[8:11], s56 offen sc1
  s_mov_b64 exec, -1
  s_branch L_rdy_175_x
L_rdy_175_ok:
  s_mov_b64 exec, -1
  v_mov_b32 v12, 161504
  v_mov_b32 v13, 1
  ds_write_b32 v12, v13
  s_mov_b32 s101, 1
L_rdy_175_x:
  s_branch L_w7b_55
L_w7_56:
  s_cmp_eq_u32 s101, 1
  s_cbranch_scc1 L_rdy_176_x
  s_mov_b32 exec_lo, 0xffffffff
  s_mov_b32 exec_hi, 0x0
L_rdy_176:
  s_waitcnt vmcnt(0)
  v_cmp_ne_u32 vcc, s7, v122
  s_cbranch_vccz L_rdy_176_ok
  s_mov_b32 s56, 22020096
  buffer_load_dword v122, v120, s[8:11], s56 offen sc1
  s_mov_b64 exec, -1
  s_branch L_rdy_176_x
L_rdy_176_ok:
  s_mov_b64 exec, -1
  v_mov_b32 v12, 161504
  v_mov_b32 v13, 1
  ds_write_b32 v12, v13
  s_mov_b32 s101, 1
L_rdy_176_x:
  s_branch L_w7b_57
L_w7_58:
  s_cmp_eq_u32 s101, 1
  s_cbranch_scc1 L_rdy_177_x
  s_mov_b32 exec_lo, 0xffffffff
  s_mov_b32 exec_hi, 0x0
L_rdy_177:
  s_waitcnt vmcnt(0)
  v_cmp_ne_u32 vcc, s7, v122
  s_cbranch_vccz L_rdy_177_ok
  s_mov_b32 s56, 22020096
  buffer_load_dword v122, v120, s[8:11], s56 offen sc1
  s_mov_b64 exec, -1
  s_branch L_rdy_177_x
L_rdy_177_ok:
  s_mov_b64 exec, -1
  v_mov_b32 v12, 161504
  v_mov_b32 v13, 1
  ds_write_b32 v12, v13
  s_mov_b32 s101, 1
L_rdy_177_x:
  s_branch L_w7b_59
L_lw_62_r:
  s_sub_u32 s59, s59, 1
  s_cmp_lg_u32 s59, 0
  s_cbranch_scc1 L_lw_62
  s_or_b32 s27, s27, 2
  s_branch L_lw_62_ok
L_w7_60:
  s_cmp_eq_u32 s101, 1
  s_cbranch_scc1 L_rdy_178_x
  s_mov_b32 exec_lo, 0xffffffff
  s_mov_b32 exec_hi, 0x0
L_rdy_178:
  s_waitcnt vmcnt(0)
  v_cmp_ne_u32 vcc, s7, v122
  s_cbranch_vccz L_rdy_178_ok
  s_mov_b32 s56, 22020096
  buffer_load_dword v122, v120, s[8:11], s56 offen sc1
  s_mov_b64 exec, -1
  s_branch L_rdy_178_x
L_rdy_178_ok:
  s_mov_b64 exec, -1
  v_mov_b32 v12, 161504
  v_mov_b32 v13, 1
  ds_write_b32 v12, v13
  s_mov_b32 s101, 1
L_rdy_178_x:
  s_branch L_w7b_61
L_w7_63:
  s_cmp_eq_u32 s101, 1
  s_cbranch_scc1 L_rdy_179_x
  s_mov_b32 exec_lo, 0xffffffff
  s_mov_b32 exec_hi, 0x0
L_rdy_179:
  s_waitcnt vmcnt(0)
  v_cmp_ne_u32 vcc, s7, v122
  s_cbranch_vccz L_rdy_179_ok
  s_mov_b32 s56, 22020096
  buffer_load_dword v122, v120, s[8:11], s56 offen sc1
  s_mov_b64 exec, -1
  s_branch L_rdy_179_x
L_rdy_179_ok:
  s_mov_b64 exec, -1
  v_mov_b32 v12, 161504
  v_mov_b32 v13, 1
  ds_write_b32 v12, v13
  s_mov_b32 s101, 1
L_rdy_179_x:
  s_branch L_w7b_64
L_w7_65:
  s_cmp_eq_u32 s101, 1
  s_cbranch_scc1 L_rdy_180_x
  s_mov_b32 exec_lo, 0xffffffff
  s_mov_b32 exec_hi, 0x0
L_rdy_180:
  s_waitcnt vmcnt(0)
  v_cmp_ne_u32 vcc, s7, v122
  s_cbranch_vccz L_rdy_180_ok
  s_mov_b32 s56, 22020096
  buffer_load_dword v122, v120, s[8:11], s56 offen sc1
  s_mov_b64 exec, -1
  s_branch L_rdy_180_x
L_rdy_180_ok:
  s_mov_b64 exec, -1
  v_mov_b32 v12, 161504
  v_mov_b32 v13, 1
  ds_write_b32 v12, v13
  s_mov_b32 s101, 1
L_rdy_180_x:
  s_branch L_w7b_66
L_w7_67:
  s_cmp_eq_u32 s101, 1
  s_cbranch_scc1 L_rdy_181_x
  s_mov_b32 exec_lo, 0xffffffff
  s_mov_b32 exec_hi, 0x0
L_rdy_181:
  s_waitcnt vmcnt(0)
  v_cmp_ne_u32 vcc, s7, v122
  s_cbranch_vccz L_rdy_181_ok
  s_mov_b32 s56, 22020096
  buffer_load_dword v122, v120, s[8:11], s56 offen sc1
  s_mov_b64 exec, -1
  s_branch L_rdy_181_x
L_rdy_181_ok:
  s_mov_b64 exec, -1
  v_mov_b32 v12, 161504
  v_mov_b32 v13, 1
  ds_write_b32 v12, v13
  s_mov_b32 s101, 1
L_rdy_181_x:
  s_branch L_w7b_68
L_w7_69:
  s_cmp_eq_u32 s101, 1
  s_cbranch_scc1 L_rdy_182_x
  s_mov_b32 exec_lo, 0xffffffff
  s_mov_b32 exec_hi, 0x0
L_rdy_182:
  s_waitcnt vmcnt(0)
  v_cmp_ne_u32 vcc, s7, v122
  s_cbranch_vccz L_rdy_182_ok
  s_mov_b32 s56, 22020096
  buffer_load_dword v122, v120, s[8:11], s56 offen sc1
  s_mov_b64 exec, -1
  s_branch L_rdy_182_x
L_rdy_182_ok:
  s_mov_b64 exec, -1
  v_mov_b32 v12, 161504
  v_mov_b32 v13, 1
  ds_write_b32 v12, v13
  s_mov_b32 s101, 1
L_rdy_182_x:
  s_branch L_w7b_70
L_w7_71:
  s_cmp_eq_u32 s101, 1
  s_cbranch_scc1 L_rdy_183_x
  s_mov_b32 exec_lo, 0xffffffff
  s_mov_b32 exec_hi, 0x0
L_rdy_183:
  s_waitcnt vmcnt(0)
  v_cmp_ne_u32 vcc, s7, v122
  s_cbranch_vccz L_rdy_183_ok
  s_mov_b32 s56, 22020096
  buffer_load_dword v122, v120, s[8:11], s56 offen sc1
  s_mov_b64 exec, -1
  s_branch L_rdy_183_x
L_rdy_183_ok:
  s_mov_b64 exec, -1
  v_mov_b32 v12, 161504
  v_mov_b32 v13, 1
  ds_write_b32 v12, v13
  s_mov_b32 s101, 1
L_rdy_183_x:
  s_branch L_w7b_72
L_lw_73_r:
  s_sub_u32 s59, s59, 1
  s_cmp_lg_u32 s59, 0
  s_cbranch_scc1 L_lw_73
  s_or_b32 s27, s27, 64
  s_branch L_lw_73_ok
L_w7_76:
  s_cmp_eq_u32 s101, 1
  s_cbranch_scc1 L_rdy_184_x
  s_mov_b32 exec_lo, 0xffffffff
  s_mov_b32 exec_hi, 0x0
L_rdy_184:
  s_waitcnt vmcnt(0)
  v_cmp_ne_u32 vcc, s7, v122
  s_cbranch_vccz L_rdy_184_ok
  s_mov_b32 s56, 22020096
  buffer_load_dword v122, v120, s[8:11], s56 offen sc1
  s_mov_b64 exec, -1
  s_branch L_rdy_184_x
L_rdy_184_ok:
  s_mov_b64 exec, -1
  v_mov_b32 v12, 161504
  v_mov_b32 v13, 1
  ds_write_b32 v12, v13
  s_mov_b32 s101, 1
L_rdy_184_x:
  s_branch L_w7b_77
L_w7_78:
  s_cmp_eq_u32 s101, 1
  s_cbranch_scc1 L_rdy_185_x
  s_mov_b32 exec_lo, 0xffffffff
  s_mov_b32 exec_hi, 0x0
L_rdy_185:
  s_waitcnt vmcnt(0)
  v_cmp_ne_u32 vcc, s7, v122
  s_cbranch_vccz L_rdy_185_ok
  s_mov_b32 s56, 22020096
  buffer_load_dword v122, v120, s[8:11], s56 offen sc1
  s_mov_b64 exec, -1
  s_branch L_rdy_185_x
L_rdy_185_ok:
  s_mov_b64 exec, -1
  v_mov_b32 v12, 161504
  v_mov_b32 v13, 1
  ds_write_b32 v12, v13
  s_mov_b32 s101, 1
L_rdy_185_x:
  s_branch L_w7b_79
L_w7_80:
  s_cmp_eq_u32 s101, 1
  s_cbranch_scc1 L_rdy_186_x
  s_mov_b32 exec_lo, 0xffffffff
  s_mov_b32 exec_hi, 0x0
L_rdy_186:
  s_waitcnt vmcnt(0)
  v_cmp_ne_u32 vcc, s7, v122
  s_cbranch_vccz L_rdy_186_ok
  s_mov_b32 s56, 22020096
  buffer_load_dword v122, v120, s[8:11], s56 offen sc1
  s_mov_b64 exec, -1
  s_branch L_rdy_186_x
L_rdy_186_ok:
  s_mov_b64 exec, -1
  v_mov_b32 v12, 161504
  v_mov_b32 v13, 1
  ds_write_b32 v12, v13
  s_mov_b32 s101, 1
L_rdy_186_x:
  s_branch L_w7b_81
L_w7_82:
  s_cmp_eq_u32 s101, 1
  s_cbranch_scc1 L_rdy_187_x
  s_mov_b32 exec_lo, 0xffffffff
  s_mov_b32 exec_hi, 0x0
L_rdy_187:
  s_waitcnt vmcnt(0)
  v_cmp_ne_u32 vcc, s7, v122
  s_cbranch_vccz L_rdy_187_ok
  s_mov_b32 s56, 22020096
  buffer_load_dword v122, v120, s[8:11], s56 offen sc1
  s_mov_b64 exec, -1
  s_branch L_rdy_187_x
L_rdy_187_ok:
  s_mov_b64 exec, -1
  v_mov_b32 v12, 161504
  v_mov_b32 v13, 1
  ds_write_b32 v12, v13
  s_mov_b32 s101, 1
L_rdy_187_x:
  s_branch L_w7b_83
L_w7_84:
  s_cmp_eq_u32 s101, 1
  s_cbranch_scc1 L_rdy_188_x
  s_mov_b32 exec_lo, 0xffffffff
  s_mov_b32 exec_hi, 0x0
L_rdy_188:
  s_waitcnt vmcnt(0)
  v_cmp_ne_u32 vcc, s7, v122
  s_cbranch_vccz L_rdy_188_ok
  s_mov_b32 s56, 22020096
  buffer_load_dword v122, v120, s[8:11], s56 offen sc1
  s_mov_b64 exec, -1
  s_branch L_rdy_188_x
L_rdy_188_ok:
  s_mov_b64 exec, -1
  v_mov_b32 v12, 161504
  v_mov_b32 v13, 1
  ds_write_b32 v12, v13
  s_mov_b32 s101, 1
L_rdy_188_x:
  s_branch L_w7b_85
L_w7_86:
  s_cmp_eq_u32 s101, 1
  s_cbranch_scc1 L_rdy_189_x
  s_mov_b32 exec_lo, 0xffffffff
  s_mov_b32 exec_hi, 0x0
L_rdy_189:
  s_waitcnt vmcnt(0)
  v_cmp_ne_u32 vcc, s7, v122
  s_cbranch_vccz L_rdy_189_ok
  s_mov_b32 s56, 22020096
  buffer_load_dword v122, v120, s[8:11], s56 offen sc1
  s_mov_b64 exec, -1
  s_branch L_rdy_189_x
L_rdy_189_ok:
  s_mov_b64 exec, -1
  v_mov_b32 v12, 161504
  v_mov_b32 v13, 1
  ds_write_b32 v12, v13
  s_mov_b32 s101, 1
L_rdy_189_x:
  s_branch L_w7b_87
L_w7_88:
  s_cmp_eq_u32 s101, 1
  s_cbranch_scc1 L_rdy_190_x
  s_mov_b32 exec_lo, 0xffffffff
  s_mov_b32 exec_hi, 0x0
L_rdy_190:
  s_waitcnt vmcnt(0)
  v_cmp_ne_u32 vcc, s7, v122
  s_cbranch_vccz L_rdy_190_ok
  s_mov_b32 s56, 22020096
  buffer_load_dword v122, v120, s[8:11], s56 offen sc1
  s_mov_b64 exec, -1
  s_branch L_rdy_190_x
L_rdy_190_ok:
  s_mov_b64 exec, -1
  v_mov_b32 v12, 161504
  v_mov_b32 v13, 1
  ds_write_b32 v12, v13
  s_mov_b32 s101, 1
L_rdy_190_x:
  s_branch L_w7b_89
L_w7_90:
  s_cmp_eq_u32 s101, 1
  s_cbranch_scc1 L_rdy_191_x
  s_mov_b32 exec_lo, 0xffffffff
  s_mov_b32 exec_hi, 0x0
L_rdy_191:
  s_waitcnt vmcnt(0)
  v_cmp_ne_u32 vcc, s7, v122
  s_cbranch_vccz L_rdy_191_ok
  s_mov_b32 s56, 22020096
  buffer_load_dword v122, v120, s[8:11], s56 offen sc1
  s_mov_b64 exec, -1
  s_branch L_rdy_191_x
L_rdy_191_ok:
  s_mov_b64 exec, -1
  v_mov_b32 v12, 161504
  v_mov_b32 v13, 1
  ds_write_b32 v12, v13
  s_mov_b32 s101, 1
L_rdy_191_x:
  s_branch L_w7b_91
L_w7_92:
  s_cmp_eq_u32 s101, 1
  s_cbranch_scc1 L_rdy_192_x
  s_mov_b32 exec_lo, 0xffffffff
  s_mov_b32 exec_hi, 0x0
L_rdy_192:
  s_waitcnt vmcnt(0)
  v_cmp_ne_u32 vcc, s7, v122
  s_cbranch_vccz L_rdy_192_ok
  s_mov_b32 s56, 22020096
  buffer_load_dword v122, v120, s[8:11], s56 offen sc1
  s_mov_b64 exec, -1
  s_branch L_rdy_192_x
L_rdy_192_ok:
  s_mov_b64 exec, -1
  v_mov_b32 v12, 161504
  v_mov_b32 v13, 1
  ds_write_b32 v12, v13
  s_mov_b32 s101, 1
L_rdy_192_x:
  s_branch L_w7b_93
L_w7_94:
  s_cmp_eq_u32 s101, 1
  s_cbranch_scc1 L_rdy_193_x
  s_mov_b32 exec_lo, 0xffffffff
  s_mov_b32 exec_hi, 0x0
L_rdy_193:
  s_waitcnt vmcnt(0)
  v_cmp_ne_u32 vcc, s7, v122
  s_cbranch_vccz L_rdy_193_ok
  s_mov_b32 s56, 22020096
  buffer_load_dword v122, v120, s[8:11], s56 offen sc1
  s_mov_b64 exec, -1
  s_branch L_rdy_193_x
L_rdy_193_ok:
  s_mov_b64 exec, -1
  v_mov_b32 v12, 161504
  v_mov_b32 v13, 1
  ds_write_b32 v12, v13
  s_mov_b32 s101, 1
L_rdy_193_x:
  s_branch L_w7b_95
L_w7_96:
  s_cmp_eq_u32 s101, 1
  s_cbranch_scc1 L_rdy_194_x
  s_mov_b32 exec_lo, 0xffffffff
  s_mov_b32 exec_hi, 0x0
L_rdy_194:
  s_waitcnt vmcnt(0)
  v_cmp_ne_u32 vcc, s7, v122
  s_cbranch_vccz L_rdy_194_ok
  s_mov_b32 s56, 22020096
  buffer_load_dword v122, v120, s[8:11], s56 offen sc1
  s_mov_b64 exec, -1
  s_branch L_rdy_194_x
L_rdy_194_ok:
  s_mov_b64 exec, -1
  v_mov_b32 v12, 161504
  v_mov_b32 v13, 1
  ds_write_b32 v12, v13
  s_mov_b32 s101, 1
L_rdy_194_x:
  s_branch L_w7b_97
L_w7_98:
  s_cmp_eq_u32 s101, 1
  s_cbranch_scc1 L_rdy_195_x
  s_mov_b32 exec_lo, 0xffffffff
  s_mov_b32 exec_hi, 0x0
L_rdy_195:
  s_waitcnt vmcnt(0)
  v_cmp_ne_u32 vcc, s7, v122
  s_cbranch_vccz L_rdy_195_ok
  s_mov_b32 s56, 22020096
  buffer_load_dword v122, v120, s[8:11], s56 offen sc1
  s_mov_b64 exec, -1
  s_branch L_rdy_195_x
L_rdy_195_ok:
  s_mov_b64 exec, -1
  v_mov_b32 v12, 161504
  v_mov_b32 v13, 1
  ds_write_b32 v12, v13
  s_mov_b32 s101, 1
L_rdy_195_x:
  s_branch L_w7b_99
L_w7_100:
  s_cmp_eq_u32 s101, 1
  s_cbranch_scc1 L_rdy_196_x
  s_mov_b32 s59, 16384
  s_mov_b32 exec_lo, 0xffffffff
  s_mov_b32 exec_hi, 0x0
L_rdy_196:
  s_waitcnt vmcnt(0)
  v_cmp_ne_u32 vcc, s7, v122
  s_cbranch_vccz L_rdy_196_ok
  s_mov_b32 s56, 22020096
  buffer_load_dword v122, v120, s[8:11], s56 offen sc1
  s_sub_u32 s59, s59, 1
  s_cmp_lg_u32 s59, 0
  s_cbranch_scc1 L_rdy_196
  s_or_b32 s27, s27, 2
  s_waitcnt vmcnt(0)
L_rdy_196_ok:
  s_mov_b64 exec, -1
  v_mov_b32 v12, 161504
  v_mov_b32 v13, 1
  ds_write_b32 v12, v13
  s_mov_b32 s101, 1
L_rdy_196_x:
  s_branch L_w7b_101
L_lw_106_r:
  s_sub_u32 s59, s59, 1
  s_cmp_lg_u32 s59, 0
  s_cbranch_scc1 L_lw_106
  s_or_b32 s27, s27, 128
  s_branch L_lw_106_ok
L_w7_111:
  s_cmp_lg_u32 s2, 0
  s_cbranch_scc1 L_gen_197_skip
  s_mov_b32 s59, 16384
  v_lshlrev_b32 v100, 7, v1
L_gen_197:
  s_mov_b32 s56, 22020096
  buffer_load_dword v96, v100, s[8:11], s56 offen sc1
  s_mov_b32 s56, 22028288
  buffer_load_dword v97, v100, s[8:11], s56 offen sc1
  s_mov_b32 s56, 22036480
  buffer_load_dword v98, v100, s[8:11], s56 offen sc1
  s_mov_b32 s56, 22044672
  buffer_load_dword v99, v100, s[8:11], s56 offen sc1
  s_waitcnt vmcnt(0)
  v_xor_b32 v96, s7, v96
  v_xor_b32 v97, s7, v97
  v_xor_b32 v98, s7, v98
  v_xor_b32 v99, s7, v99
  v_or3_b32 v96, v96, v97, v98
  v_or_b32 v96, v96, v99
  v_cmp_ne_u32 vcc, 0, v96
  s_cbranch_vccz L_gen_197_ok
  s_sub_u32 s59, s59, 1
  s_cmp_lg_u32 s59, 0
  s_cbranch_scc1 L_gen_197
  s_or_b32 s27, s27, 4
L_gen_197_ok:
  v_mov_b32 v14, s7
  v_mov_b32 v15, 0
  s_mov_b32 s56, 0
  s_mov_b64 exec, 1
  buffer_store_dword v14, v15, s[8:11], s56 offen sc1
  s_mov_b64 exec, -1
L_gen_197_skip:
  s_branch L_w7b_112
L_w7_113:
  v_and_b32 v14, 7, v1
  v_lshlrev_b32 v14, 5, v14
  v_add_u32 v14, s4, v14
  v_lshlrev_b32 v120, 7, v14
  s_mov_b32 s56, 22085632
  s_mov_b32 s101, 0
  s_mov_b32 exec_lo, 0xff
  s_mov_b32 exec_hi, 0x0
  buffer_load_dword v122, v120, s[8:11], s56 offen sc1
  s_mov_b64 exec, -1
  s_branch L_w7b_114
L_w7_117:
  s_cmp_eq_u32 s101, 1
  s_cbranch_scc1 L_rdy_198_x
  s_mov_b32 s59, 16384
  s_mov_b32 exec_lo, 0xff
  s_mov_b32 exec_hi, 0x0
L_rdy_198:
  s_waitcnt vmcnt(0)
  v_cmp_ne_u32 vcc, s7, v122
  s_cbranch_vccz L_rdy_198_ok
  s_mov_b32 s56, 22085632
  buffer_load_dword v122, v120, s[8:11], s56 offen sc1
  s_sub_u32 s59, s59, 1
  s_cmp_lg_u32 s59, 0
  s_cbranch_scc1 L_rdy_198
  s_or_b32 s27, s27, 2
  s_waitcnt vmcnt(0)
L_rdy_198_ok:
  s_mov_b64 exec, -1
  v_mov_b32 v12, 161508
  v_mov_b32 v13, 1
  ds_write_b32 v12, v13
  s_mov_b32 s101, 1
L_rdy_198_x:
  s_branch L_w7b_118
L_lw_123_r:
  s_sub_u32 s59, s59, 1
  s_cmp_lg_u32 s59, 0
  s_cbranch_scc1 L_lw_123
  s_or_b32 s27, s27, 256
  s_branch L_lw_123_ok
L_w7_124:
  s_add_u32 s56, s97, 0
  buffer_load_dwordx4 v[96:99], v2, s[8:11], s56 offen offset:0 sc1
  s_branch L_w7b_125
L_w7_126:
  s_add_u32 s56, s97, 0
  buffer_load_dwordx4 v[100:103], v2, s[8:11], s56 offen offset:1024 sc1
  s_branch L_w7b_127
L_w7_128:
  s_add_u32 s56, s97, 0
  buffer_load_dwordx4 v[104:107], v2, s[8:11], s56 offen offset:2048 sc1
  s_branch L_w7b_129
L_w7_130:
  s_add_u32 s56, s97, 0
  buffer_load_dwordx4 v[108:111], v2, s[8:11], s56 offen offset:3072 sc1
  s_branch L_w7b_131
L_w7_132:
  s_add_u32 s56, s97, 4096
  buffer_load_dwordx4 v[112:115], v2, s[8:11], s56 offen offset:0 sc1
  s_branch L_w7b_133
L_w7_134:
  s_add_u32 s56, s97, 4096
  buffer_load_dwordx4 v[116:119], v2, s[8:11], s56 offen offset:1024 sc1
  s_branch L_w7b_135
L_w7_136:
  s_add_u32 s56, s97, 4096
  buffer_load_dwordx4 v[120:123], v2, s[8:11], s56 offen offset:2048 sc1
  s_branch L_w7b_137
L_w7_138:
  s_add_u32 s56, s97, 4096
  buffer_load_dwordx4 v[124:127], v2, s[8:11], s56 offen offset:3072 sc1
  s_branch L_w7b_139
L_lw_140_r:
  s_sub_u32 s59, s59, 1
  s_cmp_lg_u32 s59, 0
  s_cbranch_scc1 L_lw_140
  s_or_b32 s27, s27, 2
  s_branch L_lw_140_ok
L_hs_141:
  buffer_store_dwordx4 v[20:23], v2, s[8:11], s56 offen sc1
  s_branch L_hd_142
L_lw_144_r:
  s_sub_u32 s59, s59, 1
  s_cmp_lg_u32 s59, 0
  s_cbranch_scc1 L_lw_144
  s_or_b32 s27, s27, 16384
  s_branch L_lw_144_ok
L_lw_145_r:
  s_sub_u32 s59, s59, 1
  s_cmp_lg_u32 s59, 0
  s_cbranch_scc1 L_lw_145
  s_or_b32 s27, s27, 512
  s_branch L_lw_145_ok
L_o_r0:
  s_sub_u32 s59, s59, 1
  s_cmp_eq_u32 s59, 0
  s_cbranch_scc1 L_o_r0_to
  s_add_u32 s60, s54, 0
  buffer_load_dwordx4 v[64:67], v2, s[8:11], s60 offen offset:0 sc1
  buffer_load_dwordx4 v[68:71], v2, s[8:11], s60 offen offset:2048 sc1
  s_add_u32 s60, s54, 4096
  buffer_load_dwordx4 v[72:75], v2, s[8:11], s60 offen offset:0 sc1
  buffer_load_dwordx4 v[76:79], v2, s[8:11], s60 offen offset:2048 sc1
  s_add_u32 s60, s54, 8192
  buffer_load_dwordx4 v[80:83], v2, s[8:11], s60 offen offset:0 sc1
  buffer_load_dwordx4 v[84:87], v2, s[8:11], s60 offen offset:2048 sc1
  s_add_u32 s60, s54, 12288
  buffer_load_dwordx4 v[88:91], v2, s[8:11], s60 offen offset:0 sc1
  buffer_load_dwordx4 v[92:95], v2, s[8:11], s60 offen offset:2048 sc1
  s_waitcnt vmcnt(0)
  s_branch L_o_c0
L_o_r0_to:
  s_mov_b32 s59, 1
  s_or_b32 s27, s27, 8
  s_branch L_o_k0
L_o_r1:
  s_sub_u32 s59, s59, 1
  s_cmp_eq_u32 s59, 0
  s_cbranch_scc1 L_o_r1_to
  s_add_u32 s60, s54, 0
  buffer_load_dwordx4 v[68:71], v2, s[8:11], s60 offen offset:2048 sc1
  s_add_u32 s60, s54, 4096
  buffer_load_dwordx4 v[72:75], v2, s[8:11], s60 offen offset:0 sc1
  buffer_load_dwordx4 v[76:79], v2, s[8:11], s60 offen offset:2048 sc1
  s_add_u32 s60, s54, 8192
  buffer_load_dwordx4 v[80:83], v2, s[8:11], s60 offen offset:0 sc1
  buffer_load_dwordx4 v[84:87], v2, s[8:11], s60 offen offset:2048 sc1
  s_add_u32 s60, s54, 12288
  buffer_load_dwordx4 v[88:91], v2, s[8:11], s60 offen offset:0 sc1
  buffer_load_dwordx4 v[92:95], v2, s[8:11], s60 offen offset:2048 sc1
  s_waitcnt vmcnt(0)
  s_branch L_o_c1
L_o_r1_to:
  s_mov_b32 s59, 1
  s_or_b32 s27, s27, 8
  s_branch L_o_k1
L_o_r2:
  s_sub_u32 s59, s59, 1
  s_cmp_eq_u32 s59, 0
  s_cbranch_scc1 L_o_r2_to
  s_add_u32 s60, s54, 4096
  buffer_load_dwordx4 v[72:75], v2, s[8:11], s60 offen offset:0 sc1
  buffer_load_dwordx4 v[76:79], v2, s[8:11], s60 offen offset:2048 sc1
  s_add_u32 s60, s54, 8192
  buffer_load_dwordx4 v[80:83], v2, s[8:11], s60 offen offset:0 sc1
  buffer_load_dwordx4 v[84:87], v2, s[8:11], s60 offen offset:2048 sc1
  s_add_u32 s60, s54, 12288
  buffer_load_dwordx4 v[88:91], v2, s[8:11], s60 offen offset:0 sc1
  buffer_load_dwordx4 v[92:95], v2, s[8:11], s60 offen offset:2048 sc1
  s_waitcnt vmcnt(0)
  s_branch L_o_c2
L_o_r2_to:
  s_mov_b32 s59, 1
  s_or_b32 s27, s27, 8
  s_branch L_o_k2
L_o_r3:
  s_sub_u32 s59, s59, 1
  s_cmp_eq_u32 s59, 0
  s_cbranch_scc1 L_o_r3_to
  s_add_u32 s60, s54, 4096
  buffer_load_dwordx4 v[76:79], v2, s[8:11], s60 offen offset:2048 sc1
  s_add_u32 s60, s54, 8192
  buffer_load_dwordx4 v[80:83], v2, s[8:11], s60 offen offset:0 sc1
  buffer_load_dwordx4 v[84:87], v2, s[8:11], s60 offen offset:2048 sc1
  s_add_u32 s60, s54, 12288
  buffer_load_dwordx4 v[88:91], v2, s[8:11], s60 offen offset:0 sc1
  buffer_load_dwordx4 v[92:95], v2, s[8:11], s60 offen offset:2048 sc1
  s_waitcnt vmcnt(0)
  s_branch L_o_c3
L_o_r3_to:
  s_mov_b32 s59, 1
  s_or_b32 s27, s27, 8
  s_branch L_o_k3
L_o_r4:
  s_sub_u32 s59, s59, 1
  s_cmp_eq_u32 s59, 0
  s_cbranch_scc1 L_o_r4_to
  s_add_u32 s60, s54, 8192
  buffer_load_dwordx4 v[80:83], v2, s[8:11], s60 offen offset:0 sc1
  buffer_load_dwordx4 v[84:87], v2, s[8:11], s60 offen offset:2048 sc1
  s_add_u32 s60, s54, 12288
  buffer_load_dwordx4 v[88:91], v2, s[8:11], s60 offen offset:0 sc1
  buffer_load_dwordx4 v[92:95], v2, s[8:11], s60 offen offset:2048 sc1
  s_waitcnt vmcnt(0)
  s_branch L_o_c4
L_o_r4_to:
  s_mov_b32 s59, 1
  s_or_b32 s27, s27, 8
  s_branch L_o_k4
L_o_r5:
  s_sub_u32 s59, s59, 1
  s_cmp_eq_u32 s59, 0
  s_cbranch_scc1 L_o_r5_to
  s_add_u32 s60, s54, 8192
  buffer_load_dwordx4 v[84:87], v2, s[8:11], s60 offen offset:2048 sc1
  s_add_u32 s60, s54, 12288
  buffer_load_dwordx4 v[88:91], v2, s[8:11], s60 offen offset:0 sc1
  buffer_load_dwordx4 v[92:95], v2, s[8:11], s60 offen offset:2048 sc1
  s_waitcnt vmcnt(0)
  s_branch L_o_c5
L_o_r5_to:
  s_mov_b32 s59, 1
  s_or_b32 s27, s27, 8
  s_branch L_o_k5
L_o_r6:
  s_sub_u32 s59, s59, 1
  s_cmp_eq_u32 s59, 0
  s_cbranch_scc1 L_o_r6_to
  s_add_u32 s60, s54, 12288
  buffer_load_dwordx4 v[88:91], v2, s[8:11], s60 offen offset:0 sc1
  buffer_load_dwordx4 v[92:95], v2, s[8:11], s60 offen offset:2048 sc1
  s_waitcnt vmcnt(0)
  s_branch L_o_c6
L_o_r6_to:
  s_mov_b32 s59, 1
  s_or_b32 s27, s27, 8
  s_branch L_o_k6
L_o_r7:
  s_sub_u32 s59, s59, 1
  s_cmp_eq_u32 s59, 0
  s_cbranch_scc1 L_o_r7_to
  s_add_u32 s60, s54, 12288
  buffer_load_dwordx4 v[92:95], v2, s[8:11], s60 offen offset:2048 sc1
  s_waitcnt vmcnt(0)
  s_branch L_o_c7
L_o_r7_to:
  s_mov_b32 s59, 1
  s_or_b32 s27, s27, 8
  s_branch L_o_k7
L_own_146:
  v_mov_b32 v48, v16
  v_mov_b32 v49, v17
  v_mov_b32 v50, v18
  v_mov_b32 v51, v19
  v_mov_b32 v52, v20
  v_mov_b32 v53, v21
  v_mov_b32 v54, v22
  v_mov_b32 v55, v23
  s_branch L_nxt_147
L_own_148:
  v_mov_b32 v48, v32
  v_mov_b32 v49, v33
  v_mov_b32 v50, v34
  v_mov_b32 v51, v35
  v_mov_b32 v52, v36
  v_mov_b32 v53, v37
  v_mov_b32 v54, v38
  v_mov_b32 v55, v39
  s_branch L_nxt_149
L_own_150:
  v_mov_b32 v48, v24
  v_mov_b32 v49, v25
  v_mov_b32 v50, v26
  v_mov_b32 v51, v27
  v_mov_b32 v52, v28
  v_mov_b32 v53, v29
  v_mov_b32 v54, v30
  v_mov_b32 v55, v31
  s_branch L_nxt_151
L_own_152:
  v_mov_b32 v48, v40
  v_mov_b32 v49, v41
  v_mov_b32 v50, v42
  v_mov_b32 v51, v43
  v_mov_b32 v52, v44
  v_mov_b32 v53, v45
  v_mov_b32 v54, v46
  v_mov_b32 v55, v47
  s_branch L_nxt_153
L_hs_154:
  buffer_store_dwordx4 v[4:7], v2, s[8:11], s56 offen sc1
  s_branch L_hd_155
L_hs_156:
  buffer_store_dword v26, v25, s[8:11], s56 offen sc1
  s_branch L_hd_157
L_ha_r:
  s_sub_u32 s59, s59, 1
  s_cmp_eq_u32 s59, 0
  s_cbranch_scc1 L_ha_r_to
  s_add_u32 s60, s93, 0
  s_lshl_b32 m0, s6, 12
  s_nop 0
  buffer_load_dwordx4 v2, s[8:11], s60 offen offset:0 sc1 lds
  buffer_load_dwordx4 v2, s[8:11], s60 offen offset:1024 sc1 lds
  buffer_load_dwordx4 v2, s[8:11], s60 offen offset:2048 sc1 lds
  buffer_load_dwordx4 v2, s[8:11], s60 offen offset:3072 sc1 lds
  s_waitcnt vmcnt(0)
  ds_read_b128 v[16:19], v56 offset:0
  ds_read_b128 v[20:23], v56 offset:1024
  ds_read_b128 v[24:27], v56 offset:2048
  ds_read_b128 v[28:31], v56 offset:3072
  s_branch L_ha_c
L_ha_r_to:
  s_or_b32 s27, s27, 16
  s_branch L_ha_k
L_ha7_r:
  s_sub_u32 s59, s59, 1
  s_cmp_eq_u32 s59, 0
  s_cbranch_scc1 L_ha7_r_to
  s_add_u32 s60, s93, 0
  s_lshl_b32 m0, s6, 12
  s_nop 0
  buffer_load_dwordx4 v2, s[8:11], s60 offen offset:0 sc1 lds
  buffer_load_dwordx4 v2, s[8:11], s60 offen offset:1024 sc1 lds
  buffer_load_dwordx4 v2, s[8:11], s60 offen offset:2048 sc1 lds
  buffer_load_dwordx4 v2, s[8:11], s60 offen offset:3072 sc1 lds
  s_waitcnt vmcnt(0)
  ds_read_b128 v[16:19], v56 offset:0
  ds_read_b128 v[20:23], v56 offset:1024
  ds_read_b128 v[24:27], v56 offset:2048
  ds_read_b128 v[28:31], v56 offset:3072
  s_branch L_ha7_c
L_ha7_r_to:
  s_or_b32 s27, s27, 16
  s_branch L_ha7_k
L_h_preB:
  s_cmp_eq_u32 s6, 7
  s_cbranch_scc1 L_p4_w7
  s_add_u32 s60, s93, 32768
  s_lshl_b32 m0, s6, 12
  s_add_u32 m0, m0, 32768
  s_nop 0
  buffer_load_dwordx4 v2, s[8:11], s60 offen offset:0 sc1 lds
  buffer_load_dwordx4 v2, s[8:11], s60 offen offset:1024 sc1 lds
  buffer_load_dwordx4 v2, s[8:11], s60 offen offset:2048 sc1 lds
  buffer_load_dwordx4 v2, s[8:11], s60 offen offset:3072 sc1 lds
  s_add_u32 s56, s97, 8192
  buffer_load_dwordx4 v[64:67], v2, s[8:11], s56 offen offset:0 sc1
  s_add_u32 s56, s97, 8192
  buffer_load_dwordx4 v[68:71], v2, s[8:11], s56 offen offset:1024 sc1
  s_add_u32 s56, s97, 8192
  buffer_load_dwordx4 v[72:75], v2, s[8:11], s56 offen offset:2048 sc1
  s_add_u32 s56, s97, 8192
  buffer_load_dwordx4 v[76:79], v2, s[8:11], s56 offen offset:3072 sc1
  s_add_u32 s56, s97, 12288
  buffer_load_dwordx4 v[80:83], v2, s[8:11], s56 offen offset:0 sc1
  s_add_u32 s56, s97, 12288
  buffer_load_dwordx4 v[84:87], v2, s[8:11], s56 offen offset:1024 sc1
  s_add_u32 s56, s97, 114688
  buffer_load_dwordx4 v[88:91], v2, s[8:11], s56 offen offset:0 sc1
  s_add_u32 s56, s97, 114688
  buffer_load_dwordx4 v[92:95], v2, s[8:11], s56 offen offset:1024 sc1
  s_add_u32 s56, s97, 118784
  s_lshl_b32 s57, s6, 10
  s_add_u32 m0, s57, 81920
  s_nop 0
  buffer_load_dwordx4 v2, s[8:11], s56 offen sc1 lds
  s_add_u32 s56, s97, 119808
  s_lshl_b32 s57, s6, 10
  s_add_u32 m0, s57, 90112
  s_nop 0
  buffer_load_dwordx4 v2, s[8:11], s56 offen sc1 lds
  s_add_u32 s56, s97, 120832
  s_lshl_b32 s57, s6, 10
  s_add_u32 m0, s57, 98304
  s_nop 0
  buffer_load_dwordx4 v2, s[8:11], s56 offen sc1 lds
  s_add_u32 s56, s97, 121856
  s_lshl_b32 s57, s6, 10
  s_add_u32 m0, s57, 106496
  s_nop 0
  buffer_load_dwordx4 v2, s[8:11], s56 offen sc1 lds
  s_add_u32 s56, s97, 122880
  s_lshl_b32 s57, s6, 10
  s_add_u32 m0, s57, 114688
  s_nop 0
  buffer_load_dwordx4 v2, s[8:11], s56 offen sc1 lds
  s_add_u32 s56, s97, 123904
  s_lshl_b32 s57, s6, 10
  s_add_u32 m0, s57, 122880
  s_nop 0
  buffer_load_dwordx4 v2, s[8:11], s56 offen sc1 lds
  s_add_u32 s56, s97, 124928
  s_lshl_b32 s57, s6, 10
  s_add_u32 m0, s57, 131072
  s_nop 0
  buffer_load_dwordx4 v2, s[8:11], s56 offen sc1 lds
  s_mov_b32 s59, 16384
  s_waitcnt vmcnt(15)
  ds_read_b128 v[16:19], v56 offset:32768
  ds_read_b128 v[20:23], v56 offset:33792
  ds_read_b128 v[24:27], v56 offset:34816
  ds_read_b128 v[28:31], v56 offset:35840
L_hb_c:
  s_waitcnt lgkmcnt(2)
  v_max3_u32 v58, v16, v17, v18
  v_max_u32 v58, v58, v19
  v_max3_u32 v58, v58, v20, v21
  v_max3_u32 v58, v58, v22, v23
  s_waitcnt lgkmcnt(0)
  v_max3_u32 v58, v58, v24, v25
  v_max3_u32 v58, v58, v26, v27
  v_max3_u32 v58, v58, v28, v29
  v_max3_u32 v58, v58, v30, v31
  v_cmp_eq_u32 vcc, -1, v58
  s_cbranch_vccnz L_hb_r
L_hb_k:
  v_mov_b32 v0, 161520
  s_mov_b64 exec, 2
  ds_add_u32 v0, v1
  s_mov_b64 exec, -1
  s_branch L_h_skipB
L_sc_159_r:
  s_mov_b32 s59, 16384
L_sc_159_l:
  v_mov_b32 v0, 161524
  ds_read_b32 v0, v0
  ds_read_b32 v12, v14 offset:0
  ds_read_b32 v15, v14 offset:4
  s_waitcnt lgkmcnt(0)
  v_readfirstlane_b32 s61, v0
  s_nop 0
  s_cmp_ge_u32 s61, 9
  s_cbranch_scc1 L_sc_159_ok
  s_sub_u32 s59, s59, 1
  s_cmp_lg_u32 s59, 0
  s_cbranch_scc1 L_sc_159_l
  s_or_b32 s27, s27, 2048
  s_branch L_sc_159_ok
L_hs_160:
  buffer_store_dwordx4 v[32:35], v2, s[8:11], s58 offen sc1
  buffer_store_dwordx4 v[36:39], v2, s[8:11], s58 offen offset:1024 sc1
  s_branch L_hd_161
L_hc_r:
  s_sub_u32 s59, s59, 1
  s_cmp_eq_u32 s59, 0
  s_cbranch_scc1 L_hc_r_to
  s_add_u32 s60, s93, 32768
  s_lshl_b32 m0, s6, 12
  s_add_u32 m0, m0, 32768
  s_nop 0
  buffer_load_dwordx4 v2, s[8:11], s60 offen offset:0 sc1 lds
  buffer_load_dwordx4 v2, s[8:11], s60 offen offset:1024 sc1 lds
  buffer_load_dwordx4 v2, s[8:11], s60 offen offset:2048 sc1 lds
  buffer_load_dwordx4 v2, s[8:11], s60 offen offset:3072 sc1 lds
  s_waitcnt vmcnt(0)
  ds_read_b128 v[16:19], v56 offset:32768
  ds_read_b128 v[20:23], v56 offset:33792
  ds_read_b128 v[24:27], v56 offset:34816
  ds_read_b128 v[28:31], v56 offset:35840
  s_branch L_hc_c
L_hc_r_to:
  s_or_b32 s27, s27, 16
  s_branch L_hc_k
L_lw_162_r:
  s_sub_u32 s59, s59, 1
  s_cmp_lg_u32 s59, 0
  s_cbranch_scc1 L_lw_162
  s_or_b32 s27, s27, 1024
  s_branch L_lw_162_ok
L_sc_165_r:
  s_mov_b32 s59, 16384
L_sc_165_l:
  v_mov_b32 v0, 161524
  ds_read_b32 v0, v0
  ds_read_b32 v12, v14 offset:256
  ds_read_b32 v15, v14 offset:260
  s_waitcnt lgkmcnt(0)
  v_readfirstlane_b32 s61, v0
  s_nop 0
  s_cmp_ge_u32 s61, 10
  s_cbranch_scc1 L_sc_165_ok
  s_sub_u32 s59, s59, 1
  s_cmp_lg_u32 s59, 0
  s_cbranch_scc1 L_sc_165_l
  s_or_b32 s27, s27, 2048
  s_branch L_sc_165_ok
L_hs_166:
  buffer_store_dwordx4 v[32:35], v2, s[8:11], s58 offen sc1
  buffer_store_dwordx4 v[36:39], v2, s[8:11], s58 offen offset:1024 sc1
  s_branch L_hd_167
L_lw_168_r:
  s_sub_u32 s59, s59, 1
  s_cmp_lg_u32 s59, 0
  s_cbranch_scc1 L_lw_168
  s_or_b32 s27, s27, 1024
  s_branch L_lw_168_ok
L_sc_170_r:
  s_mov_b32 s59, 16384
L_sc_170_l:
  v_mov_b32 v0, 161524
  ds_read_b32 v0, v0
  ds_read_b32 v12, v14 offset:256
  ds_read_b32 v15, v14 offset:260
  s_waitcnt lgkmcnt(0)
  v_readfirstlane_b32 s61, v0
  s_nop 0
  s_cmp_ge_u32 s61, 10
  s_cbranch_scc1 L_sc_170_ok
  s_sub_u32 s59, s59, 1
  s_cmp_lg_u32 s59, 0
  s_cbranch_scc1 L_sc_170_l
  s_or_b32 s27, s27, 2048
  s_branch L_sc_170_ok
L_hs_171:
  buffer_store_dwordx4 v[32:35], v2, s[8:11], s58 offen sc1
  buffer_store_dwordx4 v[36:39], v2, s[8:11], s58 offen offset:1024 sc1
  s_branch L_hd_172
L_st0_r:
  s_sub_u32 s59, s59, 1
  s_cmp_eq_u32 s59, 0
  s_cbranch_scc1 L_st0_to
  s_add_u32 s60, s58, 0
  buffer_load_dwordx4 v[128:131], v2, s[8:11], s60 offen offset:0 sc1
  buffer_load_dwordx4 v[132:135], v2, s[8:11], s60 offen offset:1024 sc1
  buffer_load_dwordx4 v[136:139], v2, s[8:11], s60 offen offset:2048 sc1
  buffer_load_dwordx4 v[140:143], v2, s[8:11], s60 offen offset:3072 sc1
  s_add_u32 s60, s58, 4096
  buffer_load_dwordx4 v[144:147], v2, s[8:11], s60 offen offset:0 sc1
  buffer_load_dwordx4 v[148:151], v2, s[8:11], s60 offen offset:1024 sc1
  buffer_load_dwordx4 v[152:155], v2, s[8:11], s60 offen offset:2048 sc1
  buffer_load_dwordx4 v[156:159], v2, s[8:11], s60 offen offset:3072 sc1
  s_waitcnt vmcnt(0)
  s_branch L_st0_c
L_st0_to:
  s_or_b32 s27, s27, 4096
  s_branch L_st0_k
L_hb7_r:
  s_sub_u32 s59, s59, 1
  s_cmp_eq_u32 s59, 0
  s_cbranch_scc1 L_hb7_r_to
  s_add_u32 s60, s93, 32768
  s_lshl_b32 m0, s6, 12
  s_add_u32 m0, m0, 32768
  s_nop 0
  buffer_load_dwordx4 v2, s[8:11], s60 offen offset:0 sc1 lds
  buffer_load_dwordx4 v2, s[8:11], s60 offen offset:1024 sc1 lds
  buffer_load_dwordx4 v2, s[8:11], s60 offen offset:2048 sc1 lds
  buffer_load_dwordx4 v2, s[8:11], s60 offen offset:3072 sc1 lds
  s_waitcnt vmcnt(0)
  ds_read_b128 v[16:19], v56 offset:32768
  ds_read_b128 v[20:23], v56 offset:33792
  ds_read_b128 v[24:27], v56 offset:34816
  ds_read_b128 v[28:31], v56 offset:35840
  s_branch L_hb7_c
L_hb7_r_to:
  s_or_b32 s27, s27, 16
  s_branch L_hb7_k
L_st1_r:
  s_sub_u32 s59, s59, 1
  s_cmp_eq_u32 s59, 0
  s_cbranch_scc1 L_st1_to
  s_add_u32 s60, s58, 8192
  buffer_load_dwordx4 v[160:163], v2, s[8:11], s60 offen offset:0 sc1
  buffer_load_dwordx4 v[164:167], v2, s[8:11], s60 offen offset:1024 sc1
  buffer_load_dwordx4 v[168:171], v2, s[8:11], s60 offen offset:2048 sc1
  buffer_load_dwordx4 v[172:175], v2, s[8:11], s60 offen offset:3072 sc1
  s_add_u32 s60, s58, 12288
  buffer_load_dwordx4 v[176:179], v2, s[8:11], s60 offen offset:0 sc1
  buffer_load_dwordx4 v[180:183], v2, s[8:11], s60 offen offset:1024 sc1
  buffer_load_dwordx4 v[184:187], v2, s[8:11], s60 offen offset:2048 sc1
  buffer_load_dwordx4 v[188:191], v2, s[8:11], s60 offen offset:3072 sc1
  s_waitcnt vmcnt(0)
  s_branch L_st1_c
L_st1_to:
  s_or_b32 s27, s27, 4096
  s_branch L_st1_k
L_h10_r0:
  s_sub_u32 s59, s59, 1
  s_cmp_eq_u32 s59, 0
  s_cbranch_scc1 L_h10_r0_to
  s_add_u32 s60, s54, 0
  buffer_load_dwordx4 v[128:131], v2, s[8:11], s60 offen offset:0 sc1
  buffer_load_dwordx4 v[132:135], v2, s[8:11], s60 offen offset:1024 sc1
  buffer_load_dwordx4 v[136:139], v2, s[8:11], s60 offen offset:2048 sc1
  buffer_load_dwordx4 v[140:143], v2, s[8:11], s60 offen offset:3072 sc1
  s_add_u32 s60, s54, 4096
  buffer_load_dwordx4 v[144:147], v2, s[8:11], s60 offen offset:0 sc1
  buffer_load_dwordx4 v[148:151], v2, s[8:11], s60 offen offset:1024 sc1
  buffer_load_dwordx4 v[152:155], v2, s[8:11], s60 offen offset:2048 sc1
  buffer_load_dwordx4 v[156:159], v2, s[8:11], s60 offen offset:3072 sc1
  s_add_u32 s60, s54, 8192
  buffer_load_dwordx4 v[160:163], v2, s[8:11], s60 offen offset:0 sc1
  buffer_load_dwordx4 v[164:167], v2, s[8:11], s60 offen offset:1024 sc1
  buffer_load_dwordx4 v[168:171], v2, s[8:11], s60 offen offset:2048 sc1
  buffer_load_dwordx4 v[172:175], v2, s[8:11], s60 offen offset:3072 sc1
  s_add_u32 s60, s54, 12288
  buffer_load_dwordx4 v[176:179], v2, s[8:11], s60 offen offset:0 sc1
  buffer_load_dwordx4 v[180:183], v2, s[8:11], s60 offen offset:1024 sc1
  s_waitcnt vmcnt(0)
  s_branch L_h10_c0
L_h10_r0_to:
  s_mov_b32 s59, 1
  s_or_b32 s27, s27, 64
  s_branch L_h10_k0
L_h10_r1:
  s_sub_u32 s59, s59, 1
  s_cmp_eq_u32 s59, 0
  s_cbranch_scc1 L_h10_r1_to
  s_add_u32 s60, s54, 0
  buffer_load_dwordx4 v[132:135], v2, s[8:11], s60 offen offset:1024 sc1
  buffer_load_dwordx4 v[136:139], v2, s[8:11], s60 offen offset:2048 sc1
  buffer_load_dwordx4 v[140:143], v2, s[8:11], s60 offen offset:3072 sc1
  s_add_u32 s60, s54, 4096
  buffer_load_dwordx4 v[144:147], v2, s[8:11], s60 offen offset:0 sc1
  buffer_load_dwordx4 v[148:151], v2, s[8:11], s60 offen offset:1024 sc1
  buffer_load_dwordx4 v[152:155], v2, s[8:11], s60 offen offset:2048 sc1
  buffer_load_dwordx4 v[156:159], v2, s[8:11], s60 offen offset:3072 sc1
  s_add_u32 s60, s54, 8192
  buffer_load_dwordx4 v[160:163], v2, s[8:11], s60 offen offset:0 sc1
  buffer_load_dwordx4 v[164:167], v2, s[8:11], s60 offen offset:1024 sc1
  buffer_load_dwordx4 v[168:171], v2, s[8:11], s60 offen offset:2048 sc1
  buffer_load_dwordx4 v[172:175], v2, s[8:11], s60 offen offset:3072 sc1
  s_add_u32 s60, s54, 12288
  buffer_load_dwordx4 v[176:179], v2, s[8:11], s60 offen offset:0 sc1
  buffer_load_dwordx4 v[180:183], v2, s[8:11], s60 offen offset:1024 sc1
  s_waitcnt vmcnt(0)
  s_branch L_h10_c1
L_h10_r1_to:
  s_mov_b32 s59, 1
  s_or_b32 s27, s27, 64
  s_branch L_h10_k1
L_h10_r2:
  s_sub_u32 s59, s59, 1
  s_cmp_eq_u32 s59, 0
  s_cbranch_scc1 L_h10_r2_to
  s_add_u32 s60, s54, 0
  buffer_load_dwordx4 v[136:139], v2, s[8:11], s60 offen offset:2048 sc1
  buffer_load_dwordx4 v[140:143], v2, s[8:11], s60 offen offset:3072 sc1
  s_add_u32 s60, s54, 4096
  buffer_load_dwordx4 v[144:147], v2, s[8:11], s60 offen offset:0 sc1
  buffer_load_dwordx4 v[148:151], v2, s[8:11], s60 offen offset:1024 sc1
  buffer_load_dwordx4 v[152:155], v2, s[8:11], s60 offen offset:2048 sc1
  buffer_load_dwordx4 v[156:159], v2, s[8:11], s60 offen offset:3072 sc1
  s_add_u32 s60, s54, 8192
  buffer_load_dwordx4 v[160:163], v2, s[8:11], s60 offen offset:0 sc1
  buffer_load_dwordx4 v[164:167], v2, s[8:11], s60 offen offset:1024 sc1
  buffer_load_dwordx4 v[168:171], v2, s[8:11], s60 offen offset:2048 sc1
  buffer_load_dwordx4 v[172:175], v2, s[8:11], s60 offen offset:3072 sc1
  s_add_u32 s60, s54, 12288
  buffer_load_dwordx4 v[176:179], v2, s[8:11], s60 offen offset:0 sc1
  buffer_load_dwordx4 v[180:183], v2, s[8:11], s60 offen offset:1024 sc1
  s_waitcnt vmcnt(0)
  s_branch L_h10_c2
L_h10_r2_to:
  s_mov_b32 s59, 1
  s_or_b32 s27, s27, 64
  s_branch L_h10_k2
L_h10_r3:
  s_sub_u32 s59, s59, 1
  s_cmp_eq_u32 s59, 0
  s_cbranch_scc1 L_h10_r3_to
  s_add_u32 s60, s54, 0
  buffer_load_dwordx4 v[140:143], v2, s[8:11], s60 offen offset:3072 sc1
  s_add_u32 s60, s54, 4096
  buffer_load_dwordx4 v[144:147], v2, s[8:11], s60 offen offset:0 sc1
  buffer_load_dwordx4 v[148:151], v2, s[8:11], s60 offen offset:1024 sc1
  buffer_load_dwordx4 v[152:155], v2, s[8:11], s60 offen offset:2048 sc1
  buffer_load_dwordx4 v[156:159], v2, s[8:11], s60 offen offset:3072 sc1
  s_add_u32 s60, s54, 8192
  buffer_load_dwordx4 v[160:163], v2, s[8:11], s60 offen offset:0 sc1
  buffer_load_dwordx4 v[164:167], v2, s[8:11], s60 offen offset:1024 sc1
  buffer_load_dwordx4 v[168:171], v2, s[8:11], s60 offen offset:2048 sc1
  buffer_load_dwordx4 v[172:175], v2, s[8:11], s60 offen offset:3072 sc1
  s_add_u32 s60, s54, 12288
  buffer_load_dwordx4 v[176:179], v2, s[8:11], s60 offen offset:0 sc1
  buffer_load_dwordx4 v[180:183], v2, s[8:11], s60 offen offset:1024 sc1
  s_waitcnt vmcnt(0)
  s_branch L_h10_c3
L_h10_r3_to:
  s_mov_b32 s59, 1
  s_or_b32 s27, s27, 64
  s_branch L_h10_k3
L_h10_r4:
  s_sub_u32 s59, s59, 1
  s_cmp_eq_u32 s59, 0
  s_cbranch_scc1 L_h10_r4_to
  s_add_u32 s60, s54, 4096
  buffer_load_dwordx4 v[144:147], v2, s[8:11], s60 offen offset:0 sc1
  buffer_load_dwordx4 v[148:151], v2, s[8:11], s60 offen offset:1024 sc1
  buffer_load_dwordx4 v[152:155], v2, s[8:11], s60 offen offset:2048 sc1
  buffer_load_dwordx4 v[156:159], v2, s[8:11], s60 offen offset:3072 sc1
  s_add_u32 s60, s54, 8192
  buffer_load_dwordx4 v[160:163], v2, s[8:11], s60 offen offset:0 sc1
  buffer_load_dwordx4 v[164:167], v2, s[8:11], s60 offen offset:1024 sc1
  buffer_load_dwordx4 v[168:171], v2, s[8:11], s60 offen offset:2048 sc1
  buffer_load_dwordx4 v[172:175], v2, s[8:11], s60 offen offset:3072 sc1
  s_add_u32 s60, s54, 12288
  buffer_load_dwordx4 v[176:179], v2, s[8:11], s60 offen offset:0 sc1
  buffer_load_dwordx4 v[180:183], v2, s[8:11], s60 offen offset:1024 sc1
  s_waitcnt vmcnt(0)
  s_branch L_h10_c4
L_h10_r4_to:
  s_mov_b32 s59, 1
  s_or_b32 s27, s27, 64
  s_branch L_h10_k4
L_h10_r5:
  s_sub_u32 s59, s59, 1
  s_cmp_eq_u32 s59, 0
  s_cbranch_scc1 L_h10_r5_to
  s_add_u32 s60, s54, 4096
  buffer_load_dwordx4 v[148:151], v2, s[8:11], s60 offen offset:1024 sc1
  buffer_load_dwordx4 v[152:155], v2, s[8:11], s60 offen offset:2048 sc1
  buffer_load_dwordx4 v[156:159], v2, s[8:11], s60 offen offset:3072 sc1
  s_add_u32 s60, s54, 8192
  buffer_load_dwordx4 v[160:163], v2, s[8:11], s60 offen offset:0 sc1
  buffer_load_dwordx4 v[164:167], v2, s[8:11], s60 offen offset:1024 sc1
  buffer_load_dwordx4 v[168:171], v2, s[8:11], s60 offen offset:2048 sc1
  buffer_load_dwordx4 v[172:175], v2, s[8:11], s60 offen offset:3072 sc1
  s_add_u32 s60, s54, 12288
  buffer_load_dwordx4 v[176:179], v2, s[8:11], s60 offen offset:0 sc1
  buffer_load_dwordx4 v[180:183], v2, s[8:11], s60 offen offset:1024 sc1
  s_waitcnt vmcnt(0)
  s_branch L_h10_c5
L_h10_r5_to:
  s_mov_b32 s59, 1
  s_or_b32 s27, s27, 64
  s_branch L_h10_k5
L_h10_r6:
  s_sub_u32 s59, s59, 1
  s_cmp_eq_u32 s59, 0
  s_cbranch_scc1 L_h10_r6_to
  s_add_u32 s60, s54, 4096
  buffer_load_dwordx4 v[152:155], v2, s[8:11], s60 offen offset:2048 sc1
  buffer_load_dwordx4 v[156:159], v2, s[8:11], s60 offen offset:3072 sc1
  s_add_u32 s60, s54, 8192
  buffer_load_dwordx4 v[160:163], v2, s[8:11], s60 offen offset:0 sc1
  buffer_load_dwordx4 v[164:167], v2, s[8:11], s60 offen offset:1024 sc1
  buffer_load_dwordx4 v[168:171], v2, s[8:11], s60 offen offset:2048 sc1
  buffer_load_dwordx4 v[172:175], v2, s[8:11], s60 offen offset:3072 sc1
  s_add_u32 s60, s54, 12288
  buffer_load_dwordx4 v[176:179], v2, s[8:11], s60 offen offset:0 sc1
  buffer_load_dwordx4 v[180:183], v2, s[8:11], s60 offen offset:1024 sc1
  s_waitcnt vmcnt(0)
  s_branch L_h10_c6
L_h10_r6_to:
  s_mov_b32 s59, 1
  s_or_b32 s27, s27, 64
  s_branch L_h10_k6
L_h10_r7:
  s_sub_u32 s59, s59, 1
  s_cmp_eq_u32 s59, 0
  s_cbranch_scc1 L_h10_r7_to
  s_add_u32 s60, s54, 4096
  buffer_load_dwordx4 v[156:159], v2, s[8:11], s60 offen offset:3072 sc1
  s_add_u32 s60, s54, 8192
  buffer_load_dwordx4 v[160:163], v2, s[8:11], s60 offen offset:0 sc1
  buffer_load_dwordx4 v[164:167], v2, s[8:11], s60 offen offset:1024 sc1
  buffer_load_dwordx4 v[168:171], v2, s[8:11], s60 offen offset:2048 sc1
  buffer_load_dwordx4 v[172:175], v2, s[8:11], s60 offen offset:3072 sc1
  s_add_u32 s60, s54, 12288
  buffer_load_dwordx4 v[176:179], v2, s[8:11], s60 offen offset:0 sc1
  buffer_load_dwordx4 v[180:183], v2, s[8:11], s60 offen offset:1024 sc1
  s_waitcnt vmcnt(0)
  s_branch L_h10_c7
L_h10_r7_to:
  s_mov_b32 s59, 1
  s_or_b32 s27, s27, 64
  s_branch L_h10_k7
L_h10_r8:
  s_sub_u32 s59, s59, 1
  s_cmp_eq_u32 s59, 0
  s_cbranch_scc1 L_h10_r8_to
  s_add_u32 s60, s54, 8192
  buffer_load_dwordx4 v[160:163], v2, s[8:11], s60 offen offset:0 sc1
  buffer_load_dwordx4 v[164:167], v2, s[8:11], s60 offen offset:1024 sc1
  buffer_load_dwordx4 v[168:171], v2, s[8:11], s60 offen offset:2048 sc1
  buffer_load_dwordx4 v[172:175], v2, s[8:11], s60 offen offset:3072 sc1
  s_add_u32 s60, s54, 12288
  buffer_load_dwordx4 v[176:179], v2, s[8:11], s60 offen offset:0 sc1
  buffer_load_dwordx4 v[180:183], v2, s[8:11], s60 offen offset:1024 sc1
  s_waitcnt vmcnt(0)
  s_branch L_h10_c8
L_h10_r8_to:
  s_mov_b32 s59, 1
  s_or_b32 s27, s27, 64
  s_branch L_h10_k8
L_h10_r9:
  s_sub_u32 s59, s59, 1
  s_cmp_eq_u32 s59, 0
  s_cbranch_scc1 L_h10_r9_to
  s_add_u32 s60, s54, 8192
  buffer_load_dwordx4 v[164:167], v2, s[8:11], s60 offen offset:1024 sc1
  buffer_load_dwordx4 v[168:171], v2, s[8:11], s60 offen offset:2048 sc1
  buffer_load_dwordx4 v[172:175], v2, s[8:11], s60 offen offset:3072 sc1
  s_add_u32 s60, s54, 12288
  buffer_load_dwordx4 v[176:179], v2, s[8:11], s60 offen offset:0 sc1
  buffer_load_dwordx4 v[180:183], v2, s[8:11], s60 offen offset:1024 sc1
  s_waitcnt vmcnt(0)
  s_branch L_h10_c9
L_h10_r9_to:
  s_mov_b32 s59, 1
  s_or_b32 s27, s27, 64
  s_branch L_h10_k9
L_h10_r10:
  s_sub_u32 s59, s59, 1
  s_cmp_eq_u32 s59, 0
  s_cbranch_scc1 L_h10_r10_to
  s_add_u32 s60, s54, 8192
  buffer_load_dwordx4 v[168:171], v2, s[8:11], s60 offen offset:2048 sc1
  buffer_load_dwordx4 v[172:175], v2, s[8:11], s60 offen offset:3072 sc1
  s_add_u32 s60, s54, 12288
  buffer_load_dwordx4 v[176:179], v2, s[8:11], s60 offen offset:0 sc1
  buffer_load_dwordx4 v[180:183], v2, s[8:11], s60 offen offset:1024 sc1
  s_waitcnt vmcnt(0)
  s_branch L_h10_c10
L_h10_r10_to:
  s_mov_b32 s59, 1
  s_or_b32 s27, s27, 64
  s_branch L_h10_k10
L_h10_r11:
  s_sub_u32 s59, s59, 1
  s_cmp_eq_u32 s59, 0
  s_cbranch_scc1 L_h10_r11_to
  s_add_u32 s60, s54, 8192
  buffer_load_dwordx4 v[172:175], v2, s[8:11], s60 offen offset:3072 sc1
  s_add_u32 s60, s54, 12288
  buffer_load_dwordx4 v[176:179], v2, s[8:11], s60 offen offset:0 sc1
  buffer_load_dwordx4 v[180:183], v2, s[8:11], s60 offen offset:1024 sc1
  s_waitcnt vmcnt(0)
  s_branch L_h10_c11
L_h10_r11_to:
  s_mov_b32 s59, 1
  s_or_b32 s27, s27, 64
  s_branch L_h10_k11
L_h10_r12:
  s_sub_u32 s59, s59, 1
  s_cmp_eq_u32 s59, 0
  s_cbranch_scc1 L_h10_r12_to
  s_add_u32 s60, s54, 12288
  buffer_load_dwordx4 v[176:179], v2, s[8:11], s60 offen offset:0 sc1
  buffer_load_dwordx4 v[180:183], v2, s[8:11], s60 offen offset:1024 sc1
  s_waitcnt vmcnt(0)
  s_branch L_h10_c12
L_h10_r12_to:
  s_mov_b32 s59, 1
  s_or_b32 s27, s27, 64
  s_branch L_h10_k12
L_lw_174_r:
  s_sub_u32 s59, s59, 1
  s_cmp_lg_u32 s59, 0
  s_cbranch_scc1 L_lw_174
  s_or_b32 s27, s27, 8192
  s_branch L_lw_174_ok
L_h10_r13:
  s_sub_u32 s59, s59, 1
  s_cmp_eq_u32 s59, 0
  s_cbranch_scc1 L_h10_r13_to
  s_add_u32 s60, s54, 12288
  buffer_load_dwordx4 v[180:183], v2, s[8:11], s60 offen offset:1024 sc1
  s_waitcnt vmcnt(0)
  s_branch L_h10_c13
L_h10_r13_to:
  s_mov_b32 s59, 1
  s_or_b32 s27, s27, 64
  s_branch L_h10_k13
L_h11_r0:
  s_sub_u32 s59, s59, 1
  s_cmp_eq_u32 s59, 0
  s_cbranch_scc1 L_h11_r0_to
  s_add_u32 s60, s55, 0
  buffer_load_dwordx4 v[184:187], v2, s[8:11], s60 offen offset:0 sc1
  buffer_load_dwordx4 v[188:191], v2, s[8:11], s60 offen offset:1024 sc1
  buffer_load_dwordx4 v[192:195], v2, s[8:11], s60 offen offset:2048 sc1
  buffer_load_dwordx4 v[196:199], v2, s[8:11], s60 offen offset:3072 sc1
  s_add_u32 s60, s55, 4096
  buffer_load_dwordx4 v[200:203], v2, s[8:11], s60 offen offset:0 sc1
  buffer_load_dwordx4 v[204:207], v2, s[8:11], s60 offen offset:1024 sc1
  buffer_load_dwordx4 v[208:211], v2, s[8:11], s60 offen offset:2048 sc1
  buffer_load_dwordx4 v[212:215], v2, s[8:11], s60 offen offset:3072 sc1
  s_add_u32 s60, s55, 8192
  buffer_load_dwordx4 v[216:219], v2, s[8:11], s60 offen offset:0 sc1
  buffer_load_dwordx4 v[220:223], v2, s[8:11], s60 offen offset:1024 sc1
  buffer_load_dwordx4 v[224:227], v2, s[8:11], s60 offen offset:2048 sc1
  buffer_load_dwordx4 v[228:231], v2, s[8:11], s60 offen offset:3072 sc1
  s_add_u32 s60, s55, 12288
  buffer_load_dwordx4 v[232:235], v2, s[8:11], s60 offen offset:0 sc1
  buffer_load_dwordx4 v[236:239], v2, s[8:11], s60 offen offset:1024 sc1
  s_waitcnt vmcnt(0)
  s_branch L_h11_c0
L_h11_r0_to:
  s_mov_b32 s59, 1
  s_or_b32 s27, s27, 128
  s_branch L_h11_k0
L_h11_r1:
  s_sub_u32 s59, s59, 1
  s_cmp_eq_u32 s59, 0
  s_cbranch_scc1 L_h11_r1_to
  s_add_u32 s60, s55, 0
  buffer_load_dwordx4 v[188:191], v2, s[8:11], s60 offen offset:1024 sc1
  buffer_load_dwordx4 v[192:195], v2, s[8:11], s60 offen offset:2048 sc1
  buffer_load_dwordx4 v[196:199], v2, s[8:11], s60 offen offset:3072 sc1
  s_add_u32 s60, s55, 4096
  buffer_load_dwordx4 v[200:203], v2, s[8:11], s60 offen offset:0 sc1
  buffer_load_dwordx4 v[204:207], v2, s[8:11], s60 offen offset:1024 sc1
  buffer_load_dwordx4 v[208:211], v2, s[8:11], s60 offen offset:2048 sc1
  buffer_load_dwordx4 v[212:215], v2, s[8:11], s60 offen offset:3072 sc1
  s_add_u32 s60, s55, 8192
  buffer_load_dwordx4 v[216:219], v2, s[8:11], s60 offen offset:0 sc1
  buffer_load_dwordx4 v[220:223], v2, s[8:11], s60 offen offset:1024 sc1
  buffer_load_dwordx4 v[224:227], v2, s[8:11], s60 offen offset:2048 sc1
  buffer_load_dwordx4 v[228:231], v2, s[8:11], s60 offen offset:3072 sc1
  s_add_u32 s60, s55, 12288
  buffer_load_dwordx4 v[232:235], v2, s[8:11], s60 offen offset:0 sc1
  buffer_load_dwordx4 v[236:239], v2, s[8:11], s60 offen offset:1024 sc1
  s_waitcnt vmcnt(0)
  s_branch L_h11_c1
L_h11_r1_to:
  s_mov_b32 s59, 1
  s_or_b32 s27, s27, 128
  s_branch L_h11_k1
L_h11_r2:
  s_sub_u32 s59, s59, 1
  s_cmp_eq_u32 s59, 0
  s_cbranch_scc1 L_h11_r2_to
  s_add_u32 s60, s55, 0
  buffer_load_dwordx4 v[192:195], v2, s[8:11], s60 offen offset:2048 sc1
  buffer_load_dwordx4 v[196:199], v2, s[8:11], s60 offen offset:3072 sc1
  s_add_u32 s60, s55, 4096
  buffer_load_dwordx4 v[200:203], v2, s[8:11], s60 offen offset:0 sc1
  buffer_load_dwordx4 v[204:207], v2, s[8:11], s60 offen offset:1024 sc1
  buffer_load_dwordx4 v[208:211], v2, s[8:11], s60 offen offset:2048 sc1
  buffer_load_dwordx4 v[212:215], v2, s[8:11], s60 offen offset:3072 sc1
  s_add_u32 s60, s55, 8192
  buffer_load_dwordx4 v[216:219], v2, s[8:11], s60 offen offset:0 sc1
  buffer_load_dwordx4 v[220:223], v2, s[8:11], s60 offen offset:1024 sc1
  buffer_load_dwordx4 v[224:227], v2, s[8:11], s60 offen offset:2048 sc1
  buffer_load_dwordx4 v[228:231], v2, s[8:11], s60 offen offset:3072 sc1
  s_add_u32 s60, s55, 12288
  buffer_load_dwordx4 v[232:235], v2, s[8:11], s60 offen offset:0 sc1
  buffer_load_dwordx4 v[236:239], v2, s[8:11], s60 offen offset:1024 sc1
  s_waitcnt vmcnt(0)
  s_branch L_h11_c2
L_h11_r2_to:
  s_mov_b32 s59, 1
  s_or_b32 s27, s27, 128
  s_branch L_h11_k2
L_h11_r3:
  s_sub_u32 s59, s59, 1
  s_cmp_eq_u32 s59, 0
  s_cbranch_scc1 L_h11_r3_to
  s_add_u32 s60, s55, 0
  buffer_load_dwordx4 v[196:199], v2, s[8:11], s60 offen offset:3072 sc1
  s_add_u32 s60, s55, 4096
  buffer_load_dwordx4 v[200:203], v2, s[8:11], s60 offen offset:0 sc1
  buffer_load_dwordx4 v[204:207], v2, s[8:11], s60 offen offset:1024 sc1
  buffer_load_dwordx4 v[208:211], v2, s[8:11], s60 offen offset:2048 sc1
  buffer_load_dwordx4 v[212:215], v2, s[8:11], s60 offen offset:3072 sc1
  s_add_u32 s60, s55, 8192
  buffer_load_dwordx4 v[216:219], v2, s[8:11], s60 offen offset:0 sc1
  buffer_load_dwordx4 v[220:223], v2, s[8:11], s60 offen offset:1024 sc1
  buffer_load_dwordx4 v[224:227], v2, s[8:11], s60 offen offset:2048 sc1
  buffer_load_dwordx4 v[228:231], v2, s[8:11], s60 offen offset:3072 sc1
  s_add_u32 s60, s55, 12288
  buffer_load_dwordx4 v[232:235], v2, s[8:11], s60 offen offset:0 sc1
  buffer_load_dwordx4 v[236:239], v2, s[8:11], s60 offen offset:1024 sc1
  s_waitcnt vmcnt(0)
  s_branch L_h11_c3
L_h11_r3_to:
  s_mov_b32 s59, 1
  s_or_b32 s27, s27, 128
  s_branch L_h11_k3
L_h11_r4:
  s_sub_u32 s59, s59, 1
  s_cmp_eq_u32 s59, 0
  s_cbranch_scc1 L_h11_r4_to
  s_add_u32 s60, s55, 4096
  buffer_load_dwordx4 v[200:203], v2, s[8:11], s60 offen offset:0 sc1
  buffer_load_dwordx4 v[204:207], v2, s[8:11], s60 offen offset:1024 sc1
  buffer_load_dwordx4 v[208:211], v2, s[8:11], s60 offen offset:2048 sc1
  buffer_load_dwordx4 v[212:215], v2, s[8:11], s60 offen offset:3072 sc1
  s_add_u32 s60, s55, 8192
  buffer_load_dwordx4 v[216:219], v2, s[8:11], s60 offen offset:0 sc1
  buffer_load_dwordx4 v[220:223], v2, s[8:11], s60 offen offset:1024 sc1
  buffer_load_dwordx4 v[224:227], v2, s[8:11], s60 offen offset:2048 sc1
  buffer_load_dwordx4 v[228:231], v2, s[8:11], s60 offen offset:3072 sc1
  s_add_u32 s60, s55, 12288
  buffer_load_dwordx4 v[232:235], v2, s[8:11], s60 offen offset:0 sc1
  buffer_load_dwordx4 v[236:239], v2, s[8:11], s60 offen offset:1024 sc1
  s_waitcnt vmcnt(0)
  s_branch L_h11_c4
L_h11_r4_to:
  s_mov_b32 s59, 1
  s_or_b32 s27, s27, 128
  s_branch L_h11_k4
L_h11_r5:
  s_sub_u32 s59, s59, 1
  s_cmp_eq_u32 s59, 0
  s_cbranch_scc1 L_h11_r5_to
  s_add_u32 s60, s55, 4096
  buffer_load_dwordx4 v[204:207], v2, s[8:11], s60 offen offset:1024 sc1
  buffer_load_dwordx4 v[208:211], v2, s[8:11], s60 offen offset:2048 sc1
  buffer_load_dwordx4 v[212:215], v2, s[8:11], s60 offen offset:3072 sc1
  s_add_u32 s60, s55, 8192
  buffer_load_dwordx4 v[216:219], v2, s[8:11], s60 offen offset:0 sc1
  buffer_load_dwordx4 v[220:223], v2, s[8:11], s60 offen offset:1024 sc1
  buffer_load_dwordx4 v[224:227], v2, s[8:11], s60 offen offset:2048 sc1
  buffer_load_dwordx4 v[228:231], v2, s[8:11], s60 offen offset:3072 sc1
  s_add_u32 s60, s55, 12288
  buffer_load_dwordx4 v[232:235], v2, s[8:11], s60 offen offset:0 sc1
  buffer_load_dwordx4 v[236:239], v2, s[8:11], s60 offen offset:1024 sc1
  s_waitcnt vmcnt(0)
  s_branch L_h11_c5
L_h11_r5_to:
  s_mov_b32 s59, 1
  s_or_b32 s27, s27, 128
  s_branch L_h11_k5
L_h11_r6:
  s_sub_u32 s59, s59, 1
  s_cmp_eq_u32 s59, 0
  s_cbranch_scc1 L_h11_r6_to
  s_add_u32 s60, s55, 4096
  buffer_load_dwordx4 v[208:211], v2, s[8:11], s60 offen offset:2048 sc1
  buffer_load_dwordx4 v[212:215], v2, s[8:11], s60 offen offset:3072 sc1
  s_add_u32 s60, s55, 8192
  buffer_load_dwordx4 v[216:219], v2, s[8:11], s60 offen offset:0 sc1
  buffer_load_dwordx4 v[220:223], v2, s[8:11], s60 offen offset:1024 sc1
  buffer_load_dwordx4 v[224:227], v2, s[8:11], s60 offen offset:2048 sc1
  buffer_load_dwordx4 v[228:231], v2, s[8:11], s60 offen offset:3072 sc1
  s_add_u32 s60, s55, 12288
  buffer_load_dwordx4 v[232:235], v2, s[8:11], s60 offen offset:0 sc1
  buffer_load_dwordx4 v[236:239], v2, s[8:11], s60 offen offset:1024 sc1
  s_waitcnt vmcnt(0)
  s_branch L_h11_c6
L_h11_r6_to:
  s_mov_b32 s59, 1
  s_or_b32 s27, s27, 128
  s_branch L_h11_k6
L_h11_r7:
  s_sub_u32 s59, s59, 1
  s_cmp_eq_u32 s59, 0
  s_cbranch_scc1 L_h11_r7_to
  s_add_u32 s60, s55, 4096
  buffer_load_dwordx4 v[212:215], v2, s[8:11], s60 offen offset:3072 sc1
  s_add_u32 s60, s55, 8192
  buffer_load_dwordx4 v[216:219], v2, s[8:11], s60 offen offset:0 sc1
  buffer_load_dwordx4 v[220:223], v2, s[8:11], s60 offen offset:1024 sc1
  buffer_load_dwordx4 v[224:227], v2, s[8:11], s60 offen offset:2048 sc1
  buffer_load_dwordx4 v[228:231], v2, s[8:11], s60 offen offset:3072 sc1
  s_add_u32 s60, s55, 12288
  buffer_load_dwordx4 v[232:235], v2, s[8:11], s60 offen offset:0 sc1
  buffer_load_dwordx4 v[236:239], v2, s[8:11], s60 offen offset:1024 sc1
  s_waitcnt vmcnt(0)
  s_branch L_h11_c7
L_h11_r7_to:
  s_mov_b32 s59, 1
  s_or_b32 s27, s27, 128
  s_branch L_h11_k7
L_h11_r8:
  s_sub_u32 s59, s59, 1
  s_cmp_eq_u32 s59, 0
  s_cbranch_scc1 L_h11_r8_to
  s_add_u32 s60, s55, 8192
  buffer_load_dwordx4 v[216:219], v2, s[8:11], s60 offen offset:0 sc1
  buffer_load_dwordx4 v[220:223], v2, s[8:11], s60 offen offset:1024 sc1
  buffer_load_dwordx4 v[224:227], v2, s[8:11], s60 offen offset:2048 sc1
  buffer_load_dwordx4 v[228:231], v2, s[8:11], s60 offen offset:3072 sc1
  s_add_u32 s60, s55, 12288
  buffer_load_dwordx4 v[232:235], v2, s[8:11], s60 offen offset:0 sc1
  buffer_load_dwordx4 v[236:239], v2, s[8:11], s60 offen offset:1024 sc1
  s_waitcnt vmcnt(0)
  s_branch L_h11_c8
L_h11_r8_to:
  s_mov_b32 s59, 1
  s_or_b32 s27, s27, 128
  s_branch L_h11_k8
L_h11_r9:
  s_sub_u32 s59, s59, 1
  s_cmp_eq_u32 s59, 0
  s_cbranch_scc1 L_h11_r9_to
  s_add_u32 s60, s55, 8192
  buffer_load_dwordx4 v[220:223], v2, s[8:11], s60 offen offset:1024 sc1
  buffer_load_dwordx4 v[224:227], v2, s[8:11], s60 offen offset:2048 sc1
  buffer_load_dwordx4 v[228:231], v2, s[8:11], s60 offen offset:3072 sc1
  s_add_u32 s60, s55, 12288
  buffer_load_dwordx4 v[232:235], v2, s[8:11], s60 offen offset:0 sc1
  buffer_load_dwordx4 v[236:239], v2, s[8:11], s60 offen offset:1024 sc1
  s_waitcnt vmcnt(0)
  s_branch L_h11_c9
L_h11_r9_to:
  s_mov_b32 s59, 1
  s_or_b32 s27, s27, 128
  s_branch L_h11_k9
L_h11_r10:
  s_sub_u32 s59, s59, 1
  s_cmp_eq_u32 s59, 0
  s_cbranch_scc1 L_h11_r10_to
  s_add_u32 s60, s55, 8192
  buffer_load_dwordx4 v[224:227], v2, s[8:11], s60 offen offset:2048 sc1
  buffer_load_dwordx4 v[228:231], v2, s[8:11], s60 offen offset:3072 sc1
  s_add_u32 s60, s55, 12288
  buffer_load_dwordx4 v[232:235], v2, s[8:11], s60 offen offset:0 sc1
  buffer_load_dwordx4 v[236:239], v2, s[8:11], s60 offen offset:1024 sc1
  s_waitcnt vmcnt(0)
  s_branch L_h11_c10
L_h11_r10_to:
  s_mov_b32 s59, 1
  s_or_b32 s27, s27, 128
  s_branch L_h11_k10
L_h11_r11:
  s_sub_u32 s59, s59, 1
  s_cmp_eq_u32 s59, 0
  s_cbranch_scc1 L_h11_r11_to
  s_add_u32 s60, s55, 8192
  buffer_load_dwordx4 v[228:231], v2, s[8:11], s60 offen offset:3072 sc1
  s_add_u32 s60, s55, 12288
  buffer_load_dwordx4 v[232:235], v2, s[8:11], s60 offen offset:0 sc1
  buffer_load_dwordx4 v[236:239], v2, s[8:11], s60 offen offset:1024 sc1
  s_waitcnt vmcnt(0)
  s_branch L_h11_c11
L_h11_r11_to:
  s_mov_b32 s59, 1
  s_or_b32 s27, s27, 128
  s_branch L_h11_k11
L_h11_r12:
  s_sub_u32 s59, s59, 1
  s_cmp_eq_u32 s59, 0
  s_cbranch_scc1 L_h11_r12_to
  s_add_u32 s60, s55, 12288
  buffer_load_dwordx4 v[232:235], v2, s[8:11], s60 offen offset:0 sc1
  buffer_load_dwordx4 v[236:239], v2, s[8:11], s60 offen offset:1024 sc1
  s_waitcnt vmcnt(0)
  s_branch L_h11_c12
L_h11_r12_to:
  s_mov_b32 s59, 1
  s_or_b32 s27, s27, 128
  s_branch L_h11_k12
L_h11_r13:
  s_sub_u32 s59, s59, 1
  s_cmp_eq_u32 s59, 0
  s_cbranch_scc1 L_h11_r13_to
  s_add_u32 s60, s55, 12288
  buffer_load_dwordx4 v[236:239], v2, s[8:11], s60 offen offset:1024 sc1
  s_waitcnt vmcnt(0)
  s_branch L_h11_c13
L_h11_r13_to:
  s_mov_b32 s59, 1
  s_or_b32 s27, s27, 128
  s_branch L_h11_k13
L_hb_r:
  s_sub_u32 s59, s59, 1
  s_cmp_eq_u32 s59, 0
  s_cbranch_scc1 L_hb_r_to
  s_add_u32 s60, s93, 32768
  s_lshl_b32 m0, s6, 12
  s_add_u32 m0, m0, 32768
  s_nop 0
  buffer_load_dwordx4 v2, s[8:11], s60 offen offset:0 sc1 lds
  buffer_load_dwordx4 v2, s[8:11], s60 offen offset:1024 sc1 lds
  buffer_load_dwordx4 v2, s[8:11], s60 offen offset:2048 sc1 lds
  buffer_load_dwordx4 v2, s[8:11], s60 offen offset:3072 sc1 lds
  s_waitcnt vmcnt(0)
  ds_read_b128 v[16:19], v56 offset:32768
  ds_read_b128 v[20:23], v56 offset:33792
  ds_read_b128 v[24:27], v56 offset:34816
  ds_read_b128 v[28:31], v56 offset:35840
  s_branch L_hb_c
L_hb_r_to:
  s_or_b32 s27, s27, 16
  s_branch L_hb_k
.section .rodata,"a"
.p2align 6
.amdhsa_kernel sequential_preLN__grouped_kv_mqa__dense_activation_squared_relu__prompt_kernel
  .amdhsa_next_free_vgpr 256
  .amdhsa_next_free_sgpr 102
  .amdhsa_accum_offset 256
  .amdhsa_group_segment_fixed_size 0
  .amdhsa_kernarg_size 104
  .amdhsa_user_sgpr_count 2
  .amdhsa_user_sgpr_kernarg_segment_ptr 1
  .amdhsa_system_sgpr_workgroup_id_x 1
  .amdhsa_float_denorm_mode_32 3
.end_amdhsa_kernel
```
